```python
import torch

def _softmax(x, axis=-1):
    return torch.softmax(x, dim=axis)
def _gelu(x):
    return torch.nn.functional.gelu(x, approximate="tanh")
def _silu(x):
    return torch.nn.functional.silu(x)
def _sigmoid(x):
    return torch.sigmoid(x)
def _layernorm(x, axis=-1, eps=1e-5):
    m = x.mean(dim=axis, keepdim=True)
    v = x.var(dim=axis, keepdim=True, unbiased=False)
    return (x - m) / torch.sqrt(v + eps)
def _scatter_add(tgt, idx, src, axis=0):
    return tgt.clone().index_add_(axis, idx, src)
def _segment_sum(src, seg, n):
    out = torch.zeros((n,) + src.shape[1:], dtype=src.dtype)
    return out.index_add_(0, seg, src)
def _pad(x, pw):
    flat = tuple(v for pair in reversed(pw) for v in pair)
    return torch.nn.functional.pad(x, flat)

kernel_name = 'interleave_layers__spectral_gfnet__sliding_block__prompt'

def setup_inputs():

    _w = (lambda a: (lambda t: t.to(torch.bfloat16) if t.is_floating_point() else t)(torch.as_tensor(a)))
    def _A_setup():
        B, S, D = 1, 2048, 512
        Df = D // 2 + 1
        return {
            "x": _w((lambda *s: torch.randn(*s, dtype=torch.bfloat16) * 0.05)(B, S, D)),
            "w_r": _w((lambda *s: torch.randn(*s, dtype=torch.bfloat16) * 1.6)(S, Df) * 0.02),
            "w_i": _w((lambda *s: torch.randn(*s, dtype=torch.bfloat16) * 1.6)(S, Df) * 0.02),
        }
    _A_in = _A_setup()

    def _B_setup():
        B, S, D = 1, 2048, 512
        return {
            "x": _w((lambda *s: torch.randn(*s, dtype=torch.bfloat16) * 0.05)(B, S, D)),
            "wqkv": _w((lambda *s: torch.randn(*s, dtype=torch.bfloat16) * 0.05)(D, 3 * D)),
            "wo": _w((lambda *s: torch.randn(*s, dtype=torch.bfloat16) * 0.05)(D, D)),
        }
    _B_in = _B_setup()

    return {
        "A_x": _A_in["x"],
        "A_w_r": _A_in["w_r"],
        "A_w_i": _A_in["w_i"],
        "B_x": _B_in["x"],
        "B_wqkv": _B_in["wqkv"],
        "B_wo": _B_in["wo"],
    }

def reference(A_x, A_w_r, A_w_i, B_x, B_wqkv, B_wo):
    def _A_ref(x, w_r, w_i):
        B, S, D = x.shape
        X = (lambda x, axes=(-2,-1): torch.fft.rfft2(x.float(), dim=axes))(x, axes=(-2, -1))
        W = w_r + 1j * w_i
        X = X * W
        y = (lambda x, s, axes=(-2,-1): torch.fft.irfft2(x, s=s, dim=axes).to(torch.bfloat16))(X, (S, D), axes=(-2, -1))
        return y

    def _B_ref(x, wqkv, wo):
        B, S, D = x.shape
        H = 32; Dh = D // H; W = 256
        qkv = (lambda x, *d: x.permute(*d))((x @ wqkv).reshape(B, S, 3, H, Dh), 2, 0, 3, 1, 4)
        q, k, v = qkv[0], qkv[1], qkv[2]
        scores = torch.einsum("bhqd,bhkd->bhqk", q, k) * (Dh ** -0.5)
        idx = torch.arange(S)
        mask = (idx[:, None] - idx[None, :] >= 0) & (idx[:, None] - idx[None, :] < W)
        scores = torch.where(mask[None, None], scores, -1e9)
        p = _softmax(scores, axis=-1)
        o = torch.einsum("bhqk,bhkd->bhqd", p, v)
        return (lambda x, *d: x.permute(*d))(o, 0, 2, 1, 3).reshape(B, S, D) @ wo

    x = A_x
    x = x + _A_ref(_layernorm(x, axis=-1), A_w_r, A_w_i)
    x = x + _B_ref(_layernorm(x, axis=-1), B_wqkv, B_wo)
    x = x + _A_ref(_layernorm(x, axis=-1), A_w_r, A_w_i)
    x = x + _B_ref(_layernorm(x, axis=-1), B_wqkv, B_wo)
    return x
```

```asm
; @launch grid=(256,1,1) block=(256,1,1) lds=163840
.amdgcn_target "amdgcn-amd-amdhsa--gfx950"
.text
.globl interleave_layers__spectral_gfnet__sliding_block__prompt_kernel
.p2align 8
.type interleave_layers__spectral_gfnet__sliding_block__prompt_kernel,@function
interleave_layers__spectral_gfnet__sliding_block__prompt_kernel:
    s_load_dwordx16 s[4:19], s[0:1], 0
    s_load_dwordx2 s[20:21], s[0:1], 64
    s_getpc_b64 s[32:33]
L_pc:
    s_mov_b32 s34, L_end-L_pc
    s_mov_b32 s35, 0x20000
    v_lshlrev_b32 v4, 4, v0
    s_cmp_ge_u32 s2, 256
    s_cbranch_scc1 L_end
    s_cmp_lt_u32 s2, 128
    s_cbranch_scc1 L_nocpf
    buffer_load_dwordx4 v[8:11], v4, s[32:35], 0 offen
    s_bfe_u32 s53, s2, 0x40003
    s_add_u32 s53, s53, 1
    s_lshl_b32 s53, s53, 12
    buffer_load_dwordx4 v[8:11], v4, s[32:35], s53 offen
L_nocpf:
    v_and_b32 v1, 63, v0
    v_lshrrev_b32 v3, 6, v0
    v_and_b32 v2, 15, v0
    v_readfirstlane_b32 s46, v3
    v_lshlrev_b32 v5, 4, v1
    v_bfe_u32 v6, v1, 2, 3
    v_mul_u32_u24 v6, 3072, v6
    v_and_b32 v144, 3, v1
    v_lshl_add_u32 v6, v144, 7, v6
    s_bfe_u32 s52, s2, 262147
    s_lshl_b32 s52, s52, 2
    s_add_u32 s52, s52, s46
    s_mul_i32 s52, s52, 24576
    s_and_b32 s53, s2, 7
    s_mul_i32 s53, s53, 384
    s_add_u32 s53, s53, s52
    s_mov_b32 s38, 1572864
    s_mov_b32 s39, 0x20000
    s_mov_b32 s31, 0x20000
    s_sub_u32 s50, s2, 128
    s_cmp_lt_u32 s50, 96
    s_cbranch_scc1 L_p1_ldq
    s_sub_u32 s50, s2, 224
    s_cmp_lt_u32 s2, 128
    s_cselect_b32 s50, s2, s50
    s_mov_b32 s30, 524288
    s_cselect_b32 s30, 2097152, s30
    s_lshl_b32 s50, s50, 14
    s_lshl_b32 s51, s46, 12
    s_add_u32 s50, s50, s51
    s_mul_i32 s51, s46, 4160
    s_cmp_lt_u32 s2, 128
    s_add_u32 m0, s51, 16384
    s_cmp_lt_u32 s2, 128
    s_waitcnt lgkmcnt(0)
    s_cselect_b32 s28, s4, s14
    s_cselect_b32 s29, s5, s15
    buffer_load_dwordx4 v5, s[28:31], s50 offen offset:0 lds
    s_add_u32 m0, m0, 16
    s_cmp_lt_u32 s2, 128
    buffer_load_dwordx4 v5, s[28:31], s50 offen offset:1024 lds
    s_add_u32 m0, m0, 16
    s_cmp_lt_u32 s2, 128
    buffer_load_dwordx4 v5, s[28:31], s50 offen offset:2048 lds
    s_add_u32 m0, m0, 16
    s_cmp_lt_u32 s2, 128
    buffer_load_dwordx4 v5, s[28:31], s50 offen offset:3072 lds
    s_cbranch_scc1 L_p1_ld2
    s_mov_b32 s36, s12
    s_mov_b32 s37, s13
    buffer_load_dword v8, v6, s[36:39], s53 offen
    s_branch L_p1_ld2
L_p1_ldq:
    v_lshrrev_b32 v7, 1, v1
    v_lshrrev_b32 v144, 4, v7
    v_lshlrev_b32 v144, 2, v144
    v_xor_b32 v7, v7, v144
    v_mul_u32_u24 v7, 3072, v7
    v_and_b32 v144, 1, v0
    v_lshl_add_u32 v7, v144, 4, v7
    s_lshr_b32 s50, s50, 3
    s_and_b32 s51, s2, 7
    s_mul_i32 s51, s51, 12
    s_add_u32 s49, s50, s51
    s_lshl_b32 s50, s49, 5
    s_mul_i32 s51, s46, 393216
    s_add_u32 s50, s50, s51
    s_mul_i32 s51, s46, 5120
    s_and_b32 s52, s46, 1
    s_lshl_b32 s52, s52, 6
    s_add_u32 s51, s51, s52
    s_add_u32 m0, s51, 16384
    s_mov_b32 s30, 1572864
    s_waitcnt lgkmcnt(0)
    s_mov_b32 s28, s12
    s_mov_b32 s29, s13
    s_mov_b32 s36, s12
    s_mov_b32 s37, s13
    buffer_load_dword v8, v6, s[36:39], s53 offen
    buffer_load_dwordx4 v7, s[28:31], s50 offen lds
    s_add_u32 s50, s50, 98304
    s_add_u32 m0, m0, 1312
    s_nop 0
    buffer_load_dwordx4 v7, s[28:31], s50 offen lds
    s_add_u32 s50, s50, 98304
    s_add_u32 m0, m0, 1248
    s_nop 0
    buffer_load_dwordx4 v7, s[28:31], s50 offen lds
    s_add_u32 s50, s50, 98304
    s_add_u32 m0, m0, 1312
    s_nop 0
    buffer_load_dwordx4 v7, s[28:31], s50 offen lds
L_p1_ld2:
    s_mov_b32 s24, s20
    s_mov_b32 s25, s21
    s_mov_b32 s26, 29360128
    s_mov_b32 s27, 0x20000
    v_bfe_u32 v3, v0, 4, 2
    s_bfe_u32 s47, s2, 0x20001
    s_lshl_b32 s47, s47, 3
    s_lshr_b32 s50, s2, 5
    s_add_u32 s47, s47, s50
    s_and_b32 s48, s2, 1
    s_lshl_b32 s48, s48, 2
    s_bfe_u32 s50, s2, 0x20003
    s_add_u32 s48, s48, s50
    s_and_b32 s54, s46, 1
    s_lshr_b32 s55, s46, 1
    s_mov_b32 s40, s18
    s_mov_b32 s41, s19
    s_mov_b32 s42, 256
    s_mov_b32 s43, 0x20000
    s_or_b32 s53, s2, s46
    s_cmp_lg_u32 s53, 0
    s_cbranch_scc1 L_p1_nononce
    s_memrealtime s[60:61]
    s_waitcnt lgkmcnt(0)
    s_or_b32 s53, s60, 1
    v_mov_b32 v6, s53
    v_mov_b32 v7, 0
    s_mov_b64 exec, 1
    buffer_store_dword v6, v7, s[40:43], 0 offen sc1
    s_mov_b64 exec, -1
L_p1_nononce:
    v_mov_b32 v252, -1
    v_mov_b32 v253, -1
    v_mov_b32 v254, -1
    v_mov_b32 v255, -1
    v_lshrrev_b32 v158, 2, v2
    v_lshlrev_b32 v158, 2, v158
    v_bfe_u32 v155, v2, 1, 1
    v_add_u32 v158, v158, v155
    v_lshlrev_b32 v158, 5, v158
    v_and_b32 v159, 1, v3
    v_lshlrev_b32 v159, 3, v159
    v_cvt_f32_u32 v159, v159
    v_lshrrev_b32 v146, 1, v3
    v_lshrrev_b32 v147, 3, v2
    v_lshlrev_b32 v148, 1, v147
    v_sub_u32 v149, 1, v148
    v_cmp_eq_u32 vcc, 1, v146
    v_sub_u32 v151, 0, v146
    v_and_b32 v150, 1, v2
    v_cndmask_b32 v149, v149, v148, vcc
    v_cmp_eq_u32 vcc, 1, v150
    s_lshl_b32 s50, s46, 2
    s_mov_b32 s51, 0x3b000000
    v_cndmask_b32 v156, v151, v149, vcc
    v_cvt_f32_i32 v156, v156
    v_mul_f32 v156, 0x3e800000, v156
    s_add_u32 s52, s50, 1
    v_add_u32 v154, s52, v158
    v_cvt_f32_u32 v154, v154
    v_mul_f32 v154, s51, v154
    v_add_f32 v112, 0x3e000000, v154
    v_fma_f32 v155, v159, v154, v156
    v_fma_f32 v113, v159, v112, v156
    v_cos_f32 v146, v155
    v_cos_f32 v114, v113
    v_add_f32 v155, v155, v154
    v_add_f32 v113, v113, v112
    v_cos_f32 v153, v154
    v_cos_f32 v121, v112
    v_cos_f32 v147, v155
    v_cos_f32 v115, v113
    v_add_f32 v155, v153, v153
    v_add_f32 v113, v121, v121
    v_fma_f32 v148, v155, v147, -v146
    v_fma_f32 v116, v113, v115, -v114
    v_fma_f32 v149, v155, v148, -v147
    v_fma_f32 v117, v113, v116, -v115
    v_fma_f32 v150, v155, v149, -v148
    v_fma_f32 v118, v113, v117, -v116
    v_fma_f32 v151, v155, v150, -v149
    v_fma_f32 v119, v113, v118, -v117
    v_fma_f32 v152, v155, v151, -v150
    v_fma_f32 v120, v113, v119, -v118
    v_fma_f32 v153, v155, v152, -v151
    v_fma_f32 v121, v113, v120, -v119
    v_cvt_pk_bf16_f32 v88, v146, v147
    v_cvt_pk_bf16_f32 v92, v114, v115
    v_cvt_pk_bf16_f32 v89, v148, v149
    v_cvt_pk_bf16_f32 v93, v116, v117
    v_cvt_pk_bf16_f32 v90, v150, v151
    v_cvt_pk_bf16_f32 v94, v118, v119
    v_cvt_pk_bf16_f32 v91, v152, v153
    v_cvt_pk_bf16_f32 v95, v120, v121
    s_add_u32 s52, s50, 2
    v_add_u32 v154, s52, v158
    v_cvt_f32_u32 v154, v154
    v_mul_f32 v154, s51, v154
    v_add_f32 v112, 0x3e000000, v154
    v_fma_f32 v155, v159, v154, v156
    v_fma_f32 v113, v159, v112, v156
    v_cos_f32 v146, v155
    v_cos_f32 v114, v113
    v_add_f32 v155, v155, v154
    v_add_f32 v113, v113, v112
    v_cos_f32 v153, v154
    v_cos_f32 v121, v112
    v_cos_f32 v147, v155
    v_cos_f32 v115, v113
    v_add_f32 v155, v153, v153
    v_add_f32 v113, v121, v121
    v_fma_f32 v148, v155, v147, -v146
    v_fma_f32 v116, v113, v115, -v114
    v_fma_f32 v149, v155, v148, -v147
    v_fma_f32 v117, v113, v116, -v115
    v_fma_f32 v150, v155, v149, -v148
    v_fma_f32 v118, v113, v117, -v116
    v_fma_f32 v151, v155, v150, -v149
    v_fma_f32 v119, v113, v118, -v117
    v_fma_f32 v152, v155, v151, -v150
    v_fma_f32 v120, v113, v119, -v118
    v_fma_f32 v153, v155, v152, -v151
    v_fma_f32 v121, v113, v120, -v119
    v_cvt_pk_bf16_f32 v96, v146, v147
    v_cvt_pk_bf16_f32 v100, v114, v115
    v_cvt_pk_bf16_f32 v97, v148, v149
    v_cvt_pk_bf16_f32 v101, v116, v117
    v_cvt_pk_bf16_f32 v98, v150, v151
    v_cvt_pk_bf16_f32 v102, v118, v119
    v_cvt_pk_bf16_f32 v99, v152, v153
    v_cvt_pk_bf16_f32 v103, v120, v121
    s_add_u32 s52, s50, 3
    v_add_u32 v154, s52, v158
    v_cvt_f32_u32 v154, v154
    v_mul_f32 v154, s51, v154
    v_add_f32 v112, 0x3e000000, v154
    v_fma_f32 v155, v159, v154, v156
    v_fma_f32 v113, v159, v112, v156
    v_cos_f32 v146, v155
    v_cos_f32 v114, v113
    v_add_f32 v155, v155, v154
    v_add_f32 v113, v113, v112
    v_cos_f32 v153, v154
    v_cos_f32 v121, v112
    v_cos_f32 v147, v155
    v_cos_f32 v115, v113
    v_add_f32 v155, v153, v153
    v_add_f32 v113, v121, v121
    v_fma_f32 v148, v155, v147, -v146
    v_fma_f32 v116, v113, v115, -v114
    v_fma_f32 v149, v155, v148, -v147
    v_fma_f32 v117, v113, v116, -v115
    v_fma_f32 v150, v155, v149, -v148
    v_fma_f32 v118, v113, v117, -v116
    v_fma_f32 v151, v155, v150, -v149
    v_fma_f32 v119, v113, v118, -v117
    v_fma_f32 v152, v155, v151, -v150
    v_fma_f32 v120, v113, v119, -v118
    v_fma_f32 v153, v155, v152, -v151
    v_fma_f32 v121, v113, v120, -v119
    v_cvt_pk_bf16_f32 v104, v146, v147
    v_cvt_pk_bf16_f32 v108, v114, v115
    v_cvt_pk_bf16_f32 v105, v148, v149
    v_cvt_pk_bf16_f32 v109, v116, v117
    v_cvt_pk_bf16_f32 v106, v150, v151
    v_cvt_pk_bf16_f32 v110, v118, v119
    v_cvt_pk_bf16_f32 v107, v152, v153
    v_cvt_pk_bf16_f32 v111, v120, v121
    s_add_u32 s52, s50, 0
    v_add_u32 v154, s52, v158
    v_mov_b32 v157, 1.0
    s_cmp_lg_u32 s46, 0
    s_cbranch_scc1 L_t2b0_1
    v_lshrrev_b32 v146, 3, v2
    v_mul_u32_u24 v147, 240, v146
    v_sub_u32 v154, v154, v147
    v_lshrrev_b32 v147, 1, v3
    v_cmp_eq_u32 vcc, v146, v147
    s_nop 1
    v_cndmask_b32 v157, 0, v157, vcc
    v_and_b32 v146, 1, v2
    v_cvt_f32_u32 v156, v146
    v_mul_f32 v156, 0x3e800000, v156
    v_cmp_gt_u32 vcc, 2, v2
    v_lshlrev_b32 v146, 8, v146
    s_nop 0
    v_cndmask_b32 v154, v154, v146, vcc
    v_cndmask_b32 v156, v156, 0, vcc
    v_mul_f32 v146, 0x3f3504f3, v157
    v_cndmask_b32 v157, v157, v146, vcc
L_t2b0_1:
    v_cvt_f32_u32 v154, v154
    v_mul_f32 v154, s51, v154
    v_fma_f32 v155, v159, v154, v156
    v_cos_f32 v146, v155
    v_add_f32 v155, v155, v154
    v_cos_f32 v153, v154
    v_cos_f32 v147, v155
    v_add_f32 v155, v153, v153
    v_fma_f32 v148, v155, v147, -v146
    v_fma_f32 v149, v155, v148, -v147
    v_fma_f32 v150, v155, v149, -v148
    v_fma_f32 v151, v155, v150, -v149
    v_fma_f32 v152, v155, v151, -v150
    v_fma_f32 v153, v155, v152, -v151
    v_mul_f32 v146, v157, v146
    v_mul_f32 v147, v157, v147
    v_mul_f32 v148, v157, v148
    v_mul_f32 v149, v157, v149
    v_mul_f32 v150, v157, v150
    v_mul_f32 v151, v157, v151
    v_mul_f32 v152, v157, v152
    v_mul_f32 v153, v157, v153
    v_cvt_pk_bf16_f32 v80, v146, v147
    v_cvt_pk_bf16_f32 v81, v148, v149
    v_cvt_pk_bf16_f32 v82, v150, v151
    v_cvt_pk_bf16_f32 v83, v152, v153
    v_lshrrev_b32 v7, 5, v1
    v_and_b32 v144, 31, v1
    v_lshlrev_b32 v145, 1, v7
    v_xor_b32 v144, v144, v145
    v_mul_u32_u24 v7, 514, v7
    v_lshl_add_u32 v7, v144, 4, v7
    s_and_b32 s22, s2, 127
    s_mul_i32 s22, s22, 8224
    s_mul_i32 s62, s46, 2056
    s_add_u32 s22, s22, s62
    s_add_u32 s22, s22, 2
    s_mul_i32 s62, s46, 2176
    s_add_u32 s63, s22, 1028
    s_mov_b32 s34, 1052672
    s_mov_b32 s35, 0x20000
    s_cmp_lt_u32 s2, 128
    s_cselect_b64 exec, -1, 0
    s_mov_b32 s32, s6
    s_add_u32 m0, s62, 65536
    s_mov_b32 s33, s7
    buffer_load_dwordx4 v7, s[32:35], s22 offen lds
    s_add_u32 m0, m0, 1088
    s_nop 0
    buffer_load_dwordx4 v7, s[32:35], s63 offen lds
    s_mov_b32 s32, s8
    s_add_u32 m0, s62, 74752
    s_mov_b32 s33, s9
    buffer_load_dwordx4 v7, s[32:35], s22 offen lds
    s_add_u32 m0, m0, 1088
    s_nop 0
    buffer_load_dwordx4 v7, s[32:35], s63 offen lds
    s_mov_b64 exec, -1
    s_add_u32 s52, s50, 64
    v_add_u32 v154, s52, v158
    v_mov_b32 v157, 1.0
    s_cmp_lg_u32 s46, 0
    s_cbranch_scc1 L_t2b0_2
    v_lshrrev_b32 v146, 3, v2
    v_mul_u32_u24 v147, 240, v146
    v_sub_u32 v154, v154, v147
    v_lshrrev_b32 v147, 1, v3
    v_cmp_eq_u32 vcc, v146, v147
    s_nop 1
    v_cndmask_b32 v157, 0, v157, vcc
    v_and_b32 v146, 1, v2
    v_cvt_f32_u32 v156, v146
    v_mul_f32 v156, 0x3e800000, v156
L_t2b0_2:
    v_cvt_f32_u32 v154, v154
    v_mul_f32 v154, s51, v154
    v_fma_f32 v155, v159, v154, v156
    v_cos_f32 v146, v155
    v_add_f32 v155, v155, v154
    v_cos_f32 v153, v154
    v_cos_f32 v147, v155
    v_add_f32 v155, v153, v153
    v_fma_f32 v148, v155, v147, -v146
    v_fma_f32 v149, v155, v148, -v147
    v_fma_f32 v150, v155, v149, -v148
    v_fma_f32 v151, v155, v150, -v149
    v_fma_f32 v152, v155, v151, -v150
    v_fma_f32 v153, v155, v152, -v151
    v_mul_f32 v146, v157, v146
    v_mul_f32 v147, v157, v147
    v_mul_f32 v148, v157, v148
    v_mul_f32 v149, v157, v149
    v_mul_f32 v150, v157, v150
    v_mul_f32 v151, v157, v151
    v_mul_f32 v152, v157, v152
    v_mul_f32 v153, v157, v153
    v_cvt_pk_bf16_f32 v84, v146, v147
    v_cvt_pk_bf16_f32 v85, v148, v149
    v_cvt_pk_bf16_f32 v86, v150, v151
    v_cvt_pk_bf16_f32 v87, v152, v153
    v_lshrrev_b32 v154, 1, v2
    s_lshl_b32 s50, s54, 3
    v_add_u32 v154, s50, v154
    v_and_b32 v157, 1, v2
    v_cmp_eq_u32 vcc, 0, v154
    v_lshlrev_b32 v155, 4, v157
    s_nop 0
    v_cndmask_b32 v154, v154, v155, vcc
    v_cndmask_b32 v157, v157, 0, vcc
    v_cvt_f32_u32 v154, v154
    v_cvt_f32_u32 v157, v157
    v_mul_f32 v154, 0x3d000000, v154
    v_mul_f32 v157, 0x3e800000, v157
    v_lshlrev_b32 v155, 3, v3
    v_cvt_f32_u32 v155, v155
    v_fma_f32 v155, v155, v154, v157
    s_mov_b32 s50, 0x3d800000
    v_cos_f32 v146, v155
    v_add_f32 v155, v155, v154
    v_cos_f32 v153, v154
    v_cos_f32 v147, v155
    v_add_f32 v155, v153, v153
    v_fma_f32 v148, v155, v147, -v146
    v_fma_f32 v149, v155, v148, -v147
    v_fma_f32 v150, v155, v149, -v148
    v_fma_f32 v151, v155, v150, -v149
    v_fma_f32 v152, v155, v151, -v150
    v_fma_f32 v153, v155, v152, -v151
    v_mul_f32 v146, s50, v146
    v_mul_f32 v147, s50, v147
    v_mul_f32 v148, s50, v148
    v_mul_f32 v149, s50, v149
    v_mul_f32 v150, s50, v150
    v_mul_f32 v151, s50, v151
    v_mul_f32 v152, s50, v152
    v_mul_f32 v153, s50, v153
    v_cvt_pk_bf16_f32 v76, v146, v147
    v_cvt_pk_bf16_f32 v77, v148, v149
    v_cvt_pk_bf16_f32 v78, v150, v151
    v_cvt_pk_bf16_f32 v79, v152, v153
    s_lshl_b32 s52, s54, 13
    s_lshl_b32 s53, s55, 8
    s_add_u32 s52, s52, s53
    v_lshlrev_b32 v160, 11, v3
    v_lshl_add_u32 v160, v2, 4, v160
    v_add_u32 v160, s52, v160
    v_lshrrev_b32 v146, 3, v2
    v_lshl_add_u32 v147, v3, 2, v146
    v_mul_u32_u24 v161, 1280, v147
    v_and_b32 v147, 1, v3
    v_lshl_add_u32 v146, v147, 1, v146
    v_bfe_u32 v147, v2, 2, 1
    v_mul_u32_u24 v147, 20, v147
    v_add_u32 v146, v146, v147
    v_lshl_add_u32 v161, v146, 5, v161
    v_and_b32 v146, 3, v0
    v_lshl_add_u32 v161, v146, 3, v161
    s_lshl_b32 s53, s55, 8
    s_add_u32 s53, s53, 16384
    v_add_u32 v161, s53, v161
    v_bfe_u32 v147, v2, 2, 1
    v_lshlrev_b32 v147, 8, v147
    v_sub_u32 v6, v161, v147
    v_add_u32 v6, 128, v6
    v_mul_u32_u24 v162, 1040, v2
    v_lshl_add_u32 v162, v3, 8, v162
    s_lshl_b32 s53, s55, 4
    s_add_u32 s53, s53, 16384
    v_add_u32 v162, s53, v162
    s_mov_b32 s56, 0x05040100
    s_mov_b32 s57, 0x07060302
    v_lshrrev_b32 v146, 3, v2
    v_lshl_add_u32 v146, v3, 1, v146
    v_mul_u32_u24 v7, 1088, v146
    v_bfe_u32 v146, v2, 2, 1
    v_mul_u32_u24 v146, 544, v146
    v_add_u32 v7, v7, v146
    v_and_b32 v146, 3, v0
    v_lshl_add_u32 v7, v146, 3, v7
    s_lshl_b32 s53, s46, 7
    s_add_u32 s53, s53, 65536
    v_add_u32 v7, s53, v7
    v_xor_b32 v144, 32, v7
    v_mul_u32_u24 v145, 8320, v2
    v_lshl_add_u32 v145, v3, 4, v145
    s_cmp_lt_u32 s2, 128
    s_cbranch_scc1 L_p1_nogen
    s_call_b64 s[60:61], L_gen_tw
    s_call_b64 s[60:61], L_gen_f12
    s_lshl_b32 s50, s46, 2
    s_mov_b32 s51, 0x3b000000
L_p1_nogen:
    s_waitcnt vmcnt(4)
    s_barrier
    s_sub_u32 s52, s2, 128
    s_cmp_ge_u32 s52, 96
    s_cbranch_scc1 L_p1_rd
    ds_read_b64_tr_b16 v[44:45], v161 offset:0
    ds_read_b64_tr_b16 v[46:47], v161 offset:2560
    ds_read_b64_tr_b16 v[48:49], v161 offset:32
    ds_read_b64_tr_b16 v[50:51], v161 offset:2592
    ds_read_b64_tr_b16 v[52:53], v161 offset:64
    ds_read_b64_tr_b16 v[54:55], v161 offset:2624
    ds_read_b64_tr_b16 v[56:57], v161 offset:96
    ds_read_b64_tr_b16 v[58:59], v161 offset:2656
    ds_read_b64_tr_b16 v[60:61], v6 offset:0
    ds_read_b64_tr_b16 v[62:63], v6 offset:2560
    ds_read_b64_tr_b16 v[64:65], v6 offset:32
    ds_read_b64_tr_b16 v[66:67], v6 offset:2592
    ds_read_b64_tr_b16 v[68:69], v6 offset:64
    ds_read_b64_tr_b16 v[70:71], v6 offset:2624
    ds_read_b64_tr_b16 v[72:73], v6 offset:96
    ds_read_b64_tr_b16 v[74:75], v6 offset:2656
    s_waitcnt lgkmcnt(0)
    s_branch L_p1_s1
L_p1_rd:
    ds_read_b128 v[12:15], v162 offset:0
    ds_read_b128 v[16:19], v162 offset:32
    ds_read_b128 v[20:23], v162 offset:64
    ds_read_b128 v[24:27], v162 offset:96
    ds_read_b128 v[28:31], v162 offset:128
    ds_read_b128 v[32:35], v162 offset:160
    ds_read_b128 v[36:39], v162 offset:192
    ds_read_b128 v[40:43], v162 offset:224
    s_waitcnt lgkmcnt(6)
    v_perm_b32 v44, v16, v12, s56
    v_perm_b32 v48, v16, v12, s57
    v_perm_b32 v52, v17, v13, s56
    v_perm_b32 v56, v17, v13, s57
    v_perm_b32 v60, v18, v14, s56
    v_perm_b32 v64, v18, v14, s57
    v_perm_b32 v68, v19, v15, s56
    v_perm_b32 v72, v19, v15, s57
    s_waitcnt lgkmcnt(4)
    v_perm_b32 v45, v24, v20, s56
    v_perm_b32 v49, v24, v20, s57
    v_perm_b32 v53, v25, v21, s56
    v_perm_b32 v57, v25, v21, s57
    v_perm_b32 v61, v26, v22, s56
    v_perm_b32 v65, v26, v22, s57
    v_perm_b32 v69, v27, v23, s56
    v_perm_b32 v73, v27, v23, s57
    s_waitcnt lgkmcnt(2)
    v_perm_b32 v46, v32, v28, s56
    v_perm_b32 v50, v32, v28, s57
    v_perm_b32 v54, v33, v29, s56
    v_perm_b32 v58, v33, v29, s57
    v_perm_b32 v62, v34, v30, s56
    v_perm_b32 v66, v34, v30, s57
    v_perm_b32 v70, v35, v31, s56
    v_perm_b32 v74, v35, v31, s57
    s_waitcnt lgkmcnt(0)
    v_perm_b32 v47, v40, v36, s56
    v_perm_b32 v51, v40, v36, s57
    v_perm_b32 v55, v41, v37, s56
    v_perm_b32 v59, v41, v37, s57
    v_perm_b32 v63, v42, v38, s56
    v_perm_b32 v67, v42, v38, s57
    v_perm_b32 v71, v43, v39, s56
    v_perm_b32 v75, v43, v39, s57
L_p1_s1:
    v_mfma_f32_16x16x32_bf16 v[12:15], v[76:79], v[44:47], 0
    v_mfma_f32_16x16x32_bf16 v[16:19], v[76:79], v[48:51], 0
    v_mfma_f32_16x16x32_bf16 v[20:23], v[76:79], v[52:55], 0
    v_mfma_f32_16x16x32_bf16 v[24:27], v[76:79], v[56:59], 0
    v_mfma_f32_16x16x32_bf16 v[28:31], v[76:79], v[60:63], 0
    v_mfma_f32_16x16x32_bf16 v[32:35], v[76:79], v[64:67], 0
    v_mfma_f32_16x16x32_bf16 v[36:39], v[76:79], v[68:71], 0
    v_mfma_f32_16x16x32_bf16 v[40:43], v[76:79], v[72:75], 0
    s_nop 1
    v_cvt_pk_bf16_f32 v44, v12, v16
    s_nop 0
    v_cvt_pk_bf16_f32 v45, v20, v24
    s_nop 0
    v_cvt_pk_bf16_f32 v46, v28, v32
    s_nop 0
    v_cvt_pk_bf16_f32 v47, v36, v40
    ds_write_b128 v160, v[44:47] offset:0
    v_cvt_pk_bf16_f32 v48, v13, v17
    v_cvt_pk_bf16_f32 v49, v21, v25
    v_cvt_pk_bf16_f32 v50, v29, v33
    v_cvt_pk_bf16_f32 v51, v37, v41
    ds_write_b128 v160, v[48:51] offset:512
    v_cvt_pk_bf16_f32 v52, v14, v18
    v_cvt_pk_bf16_f32 v53, v22, v26
    v_cvt_pk_bf16_f32 v54, v30, v34
    v_cvt_pk_bf16_f32 v55, v38, v42
    ds_write_b128 v160, v[52:55] offset:1024
    v_cvt_pk_bf16_f32 v56, v15, v19
    v_cvt_pk_bf16_f32 v57, v23, v27
    v_cvt_pk_bf16_f32 v58, v31, v35
    v_cvt_pk_bf16_f32 v59, v39, v43
    ds_write_b128 v160, v[56:59] offset:1536
    s_lshl_b32 s52, s46, 12
    v_add_u32 v161, s52, v5
    s_waitcnt lgkmcnt(0)
    s_barrier
    ds_read_b128 v[60:63], v161 offset:0
    ds_read_b128 v[64:67], v161 offset:1024
    ds_read_b128 v[68:71], v161 offset:2048
    ds_read_b128 v[72:75], v161 offset:3072
    s_cmp_ge_u32 s2, 128
    s_cbranch_scc1 L_p1_s2w
    v_lshrrev_b32 v146, 2, v2
    v_lshlrev_b32 v146, 2, v146
    v_and_b32 v147, 1, v3
    v_lshl_add_u32 v146, v147, 1, v146
    v_bfe_u32 v147, v2, 1, 1
    v_add_u32 v146, v146, v147
    v_mul_u32_u24 v146, 8320, v146
    v_and_b32 v147, 1, v2
    v_lshl_add_u32 v146, v147, 5, v146
    v_lshrrev_b32 v147, 1, v3
    v_lshl_add_u32 v146, v147, 4, v146
    s_mul_i32 s50, s46, 532480
    s_lshl_b32 s51, s2, 6
    s_add_u32 s50, s50, s51
    s_add_u32 s50, s50, 1048576
    s_waitcnt lgkmcnt(3)
    v_mfma_f32_16x16x32_bf16 v[12:15], v[60:63], v[80:83], 0
    v_mfma_f32_16x16x32_bf16 v[16:19], v[60:63], v[84:87], 0
    s_waitcnt lgkmcnt(2)
    v_mfma_f32_16x16x32_bf16 v[20:23], v[64:67], v[88:91], 0
    v_mfma_f32_16x16x32_bf16 v[24:27], v[64:67], v[92:95], 0
    s_waitcnt lgkmcnt(1)
    v_mfma_f32_16x16x32_bf16 v[28:31], v[68:71], v[96:99], 0
    v_mfma_f32_16x16x32_bf16 v[32:35], v[68:71], v[100:103], 0
    s_waitcnt lgkmcnt(0)
    v_mfma_f32_16x16x32_bf16 v[36:39], v[72:75], v[104:107], 0
    v_mfma_f32_16x16x32_bf16 v[40:43], v[72:75], v[108:111], 0
    s_cmp_eq_u32 s46, 0
    s_cselect_b32 s53, 1, 0
    v_cmp_gt_u32 vcc, s53, v2
    s_lshl_b32 s53, s46, 6
    s_add_u32 s53, s53, 152576
    v_lshl_add_u32 v147, v3, 4, s53
    v_cndmask_b32 v80, v12, 0, vcc
    v_cndmask_b32 v81, v13, 0, vcc
    v_cndmask_b32 v82, v14, 0, vcc
    v_cndmask_b32 v83, v15, 0, vcc
    v_pk_mul_f32 v[80:81], v[80:81], v[80:81]
    v_pk_mul_f32 v[82:83], v[82:83], v[82:83]
    v_pk_fma_f32 v[80:81], v[16:17], v[16:17], v[80:81]
    v_pk_fma_f32 v[82:83], v[18:19], v[18:19], v[82:83]
    v_pk_fma_f32 v[80:81], v[20:21], v[20:21], v[80:81]
    v_pk_fma_f32 v[82:83], v[22:23], v[22:23], v[82:83]
    v_pk_fma_f32 v[80:81], v[24:25], v[24:25], v[80:81]
    v_pk_fma_f32 v[82:83], v[26:27], v[26:27], v[82:83]
    v_pk_fma_f32 v[80:81], v[28:29], v[28:29], v[80:81]
    v_pk_fma_f32 v[82:83], v[30:31], v[30:31], v[82:83]
    v_pk_fma_f32 v[80:81], v[32:33], v[32:33], v[80:81]
    v_pk_fma_f32 v[82:83], v[34:35], v[34:35], v[82:83]
    v_pk_fma_f32 v[80:81], v[36:37], v[36:37], v[80:81]
    v_pk_fma_f32 v[82:83], v[38:39], v[38:39], v[82:83]
    v_pk_fma_f32 v[80:81], v[40:41], v[40:41], v[80:81]
    v_pk_fma_f32 v[82:83], v[42:43], v[42:43], v[82:83]
    s_nop 0
    v_add_f32_dpp v80, v80, v80 row_ror:8 row_mask:0xf bank_mask:0xf
    v_add_f32_dpp v81, v81, v81 row_ror:8 row_mask:0xf bank_mask:0xf
    v_add_f32_dpp v82, v82, v82 row_ror:8 row_mask:0xf bank_mask:0xf
    v_add_f32_dpp v83, v83, v83 row_ror:8 row_mask:0xf bank_mask:0xf
    v_add_f32_dpp v80, v80, v80 row_ror:4 row_mask:0xf bank_mask:0xf
    v_add_f32_dpp v81, v81, v81 row_ror:4 row_mask:0xf bank_mask:0xf
    v_add_f32_dpp v82, v82, v82 row_ror:4 row_mask:0xf bank_mask:0xf
    v_add_f32_dpp v83, v83, v83 row_ror:4 row_mask:0xf bank_mask:0xf
    v_add_f32_dpp v80, v80, v80 row_ror:2 row_mask:0xf bank_mask:0xf
    v_add_f32_dpp v81, v81, v81 row_ror:2 row_mask:0xf bank_mask:0xf
    v_add_f32_dpp v82, v82, v82 row_ror:2 row_mask:0xf bank_mask:0xf
    v_add_f32_dpp v83, v83, v83 row_ror:2 row_mask:0xf bank_mask:0xf
    v_add_f32_dpp v80, v80, v80 row_ror:1 row_mask:0xf bank_mask:0xf
    v_add_f32_dpp v81, v81, v81 row_ror:1 row_mask:0xf bank_mask:0xf
    v_add_f32_dpp v82, v82, v82 row_ror:1 row_mask:0xf bank_mask:0xf
    v_add_f32_dpp v83, v83, v83 row_ror:1 row_mask:0xf bank_mask:0xf
    ds_write_b128 v147, v[80:83]
    v_cvt_pk_bf16_f32 v44, v12, v13
    v_cvt_pk_bf16_f32 v45, v14, v15
    v_cvt_pk_bf16_f32 v46, v16, v17
    v_cvt_pk_bf16_f32 v47, v18, v19
    s_nop 0
    v_permlane16_swap_b32 v44, v46
    v_permlane16_swap_b32 v45, v47
    buffer_store_dwordx4 v[44:47], v146, s[24:27], s50 offen sc1
    s_add_u32 s50, s50, 133120
    v_cvt_pk_bf16_f32 v48, v20, v21
    v_cvt_pk_bf16_f32 v49, v22, v23
    v_cvt_pk_bf16_f32 v50, v24, v25
    v_cvt_pk_bf16_f32 v51, v26, v27
    s_nop 0
    v_permlane16_swap_b32 v48, v50
    v_permlane16_swap_b32 v49, v51
    buffer_store_dwordx4 v[48:51], v146, s[24:27], s50 offen sc1
    s_add_u32 s50, s50, 133120
    v_cvt_pk_bf16_f32 v52, v28, v29
    v_cvt_pk_bf16_f32 v53, v30, v31
    v_cvt_pk_bf16_f32 v54, v32, v33
    v_cvt_pk_bf16_f32 v55, v34, v35
    s_nop 0
    v_permlane16_swap_b32 v52, v54
    v_permlane16_swap_b32 v53, v55
    buffer_store_dwordx4 v[52:55], v146, s[24:27], s50 offen sc1
    s_add_u32 s50, s50, 133120
    v_cvt_pk_bf16_f32 v56, v36, v37
    v_cvt_pk_bf16_f32 v57, v38, v39
    v_cvt_pk_bf16_f32 v58, v40, v41
    v_cvt_pk_bf16_f32 v59, v42, v43
    s_nop 0
    v_permlane16_swap_b32 v56, v58
    v_permlane16_swap_b32 v57, v59
    buffer_store_dwordx4 v[56:59], v146, s[24:27], s50 offen sc1
    s_waitcnt vmcnt(4)
    v_lshlrev_b32 v146, 2, v2
    v_add_u32 v147, 152576, v146
    s_waitcnt lgkmcnt(0)
    s_barrier
    s_cmp_lg_u32 s46, 3
    s_cbranch_scc1 L_p1_nor
    ds_read_b32 v80, v147 offset:0
    ds_read_b32 v81, v147 offset:64
    ds_read_b32 v82, v147 offset:128
    ds_read_b32 v83, v147 offset:192
    s_lshl_b32 s50, s2, 6
    s_add_u32 s50, s50, 65536
    v_mov_b32 v84, 0x3727c5ac
    s_waitcnt lgkmcnt(0)
    v_add_f32 v80, v80, v81
    v_add_f32 v82, v82, v83
    v_add_f32 v80, v80, v82
    v_fmac_f32 v84, 0x3b000000, v80
    v_rsq_f32 v84, v84
    s_mov_b64 exec, 0xffff
    buffer_store_dword v84, v146, s[24:27], s50 offen sc1
    s_mov_b64 exec, -1
L_p1_nor:
    ds_read_b64_tr_b16 v[128:129], v7 offset:0
    ds_read_b64_tr_b16 v[130:131], v7 offset:9216
    ds_read_b64_tr_b16 v[132:133], v144 offset:0
    ds_read_b64_tr_b16 v[134:135], v144 offset:9216
    ds_read_b64_tr_b16 v[136:137], v7 offset:64
    ds_read_b64_tr_b16 v[138:139], v7 offset:9280
    ds_read_b64_tr_b16 v[140:141], v144 offset:64
    ds_read_b64_tr_b16 v[142:143], v144 offset:9280
    s_mul_i32 s50, s46, 532480
    s_and_b32 s51, s2, 127
    s_lshl_b32 s51, s51, 6
    s_add_u32 s50, s50, s51
    s_add_u32 s50, s50, 3407872
    s_waitcnt lgkmcnt(6)
    v_perm_b32 v112, v130, v128, s56
    v_perm_b32 v113, v130, v128, s57
    v_perm_b32 v114, v131, v129, s56
    v_perm_b32 v115, v131, v129, s57
    buffer_store_dwordx4 v[112:115], v145, s[24:27], s50 offen sc1
    s_add_u32 s50, s50, 133120
    s_waitcnt lgkmcnt(4)
    v_perm_b32 v116, v134, v132, s56
    v_perm_b32 v117, v134, v132, s57
    v_perm_b32 v118, v135, v133, s56
    v_perm_b32 v119, v135, v133, s57
    buffer_store_dwordx4 v[116:119], v145, s[24:27], s50 offen sc1
    s_add_u32 s50, s50, 133120
    s_waitcnt lgkmcnt(2)
    v_perm_b32 v120, v138, v136, s56
    v_perm_b32 v121, v138, v136, s57
    v_perm_b32 v122, v139, v137, s56
    v_perm_b32 v123, v139, v137, s57
    buffer_store_dwordx4 v[120:123], v145, s[24:27], s50 offen sc1
    s_add_u32 s50, s50, 133120
    s_waitcnt lgkmcnt(0)
    v_perm_b32 v124, v142, v140, s56
    v_perm_b32 v125, v142, v140, s57
    v_perm_b32 v126, v143, v141, s56
    v_perm_b32 v127, v143, v141, s57
    buffer_store_dwordx4 v[124:127], v145, s[24:27], s50 offen sc1
    s_cmp_lt_u32 s2, 128
    s_cselect_b64 exec, -1, 0
    s_and_b32 s63, s2, 127
    s_mul_i32 s63, s63, 16896
    s_add_u32 s63, s63, 5767168
    buffer_store_dwordx4 v[252:255], v4, s[24:27], s63 offen sc1
    s_add_u32 s63, s63, 4224
    buffer_store_dwordx4 v[252:255], v4, s[24:27], s63 offen sc1
    s_add_u32 s63, s63, 4224
    buffer_store_dwordx4 v[252:255], v4, s[24:27], s63 offen sc1
    s_add_u32 s63, s63, 4224
    buffer_store_dwordx4 v[252:255], v4, s[24:27], s63 offen sc1
    s_add_u32 s63, s63, 4224
    s_mov_b64 exec, -1
    v_mov_b32 v147, 0
    buffer_load_dword v146, v147, s[40:43], 0 offen sc1
    s_call_b64 s[60:61], L_gen_tw
    s_mov_b32 s59, 0
    s_waitcnt vmcnt(0)
L_nonce_x:
    v_readfirstlane_b32 s49, v146
    s_nop 0
    s_cmp_lg_u32 s49, 0
    s_cbranch_scc1 L_nonce_ok_x
    buffer_load_dword v146, v147, s[40:43], 0 offen sc1
    s_add_u32 s59, s59, 1
    s_cmp_gt_u32 s59, 0x100000
    s_cbranch_scc1 L_end
    s_waitcnt vmcnt(0)
    s_branch L_nonce_x
L_nonce_ok_x:
    s_barrier
    s_cmp_lg_u32 s46, 0
    s_cbranch_scc1 L_nosig_x
    s_lshl_b32 s59, s2, 6
    v_mov_b32 v146, s49
    v_lshlrev_b32 v147, 2, v2
    s_mov_b64 exec, 0xffff
    buffer_store_dword v146, v147, s[24:27], s59 offen sc1
    s_mov_b64 exec, -1
L_nosig_x:
    s_call_b64 s[60:61], L_gen_f12
    s_branch L_p1_end
L_p1_s2w:
    s_cmp_ge_u32 s2, 224
    s_cbranch_scc1 L_p1_wo
    s_waitcnt lgkmcnt(3)
    v_mfma_f32_16x16x32_bf16 v[12:15], v[80:83], v[60:63], 0
    v_mfma_f32_16x16x32_bf16 v[16:19], v[84:87], v[60:63], 0
    s_waitcnt lgkmcnt(2)
    v_mfma_f32_16x16x32_bf16 v[20:23], v[88:91], v[64:67], 0
    v_mfma_f32_16x16x32_bf16 v[24:27], v[92:95], v[64:67], 0
    s_waitcnt lgkmcnt(1)
    v_mfma_f32_16x16x32_bf16 v[28:31], v[96:99], v[68:71], 0
    v_mfma_f32_16x16x32_bf16 v[32:35], v[100:103], v[68:71], 0
    s_waitcnt lgkmcnt(0)
    v_mfma_f32_16x16x32_bf16 v[36:39], v[104:107], v[72:75], 0
    v_mfma_f32_16x16x32_bf16 v[40:43], v[108:111], v[72:75], 0
    s_and_b32 s50, s49, 31
    s_mul_i32 s50, s50, 3
    s_lshr_b32 s51, s49, 5
    s_add_u32 s50, s50, s51
    s_cmp_eq_u32 s51, 0
    s_cselect_b32 s52, 0x3eb8aa3b, 1.0
    s_lshl_b32 s50, s50, 14
    s_lshl_b32 s51, s46, 12
    s_add_u32 s50, s50, s51
    s_add_u32 s50, s50, 12845056
    s_cmp_eq_u32 s46, 0
    s_cselect_b32 s53, 16, 0
    v_cmp_gt_u32 vcc, s53, v1
    s_nop 1
    v_cndmask_b32 v12, v12, 0, vcc
    v_mul_f32 v12, s52, v12
    v_mul_f32 v13, s52, v13
    v_mul_f32 v14, s52, v14
    v_mul_f32 v15, s52, v15
    v_mul_f32 v16, s52, v16
    v_mul_f32 v17, s52, v17
    v_mul_f32 v18, s52, v18
    v_mul_f32 v19, s52, v19
    v_cvt_pk_bf16_f32 v44, v12, v13
    v_cvt_pk_bf16_f32 v45, v14, v15
    v_cvt_pk_bf16_f32 v46, v16, v17
    v_cvt_pk_bf16_f32 v47, v18, v19
    buffer_store_dwordx4 v[44:47], v5, s[24:27], s50 offen offset:0 sc1
    v_mul_f32 v20, s52, v20
    v_mul_f32 v21, s52, v21
    v_mul_f32 v22, s52, v22
    v_mul_f32 v23, s52, v23
    v_mul_f32 v24, s52, v24
    v_mul_f32 v25, s52, v25
    v_mul_f32 v26, s52, v26
    v_mul_f32 v27, s52, v27
    v_cvt_pk_bf16_f32 v48, v20, v21
    v_cvt_pk_bf16_f32 v49, v22, v23
    v_cvt_pk_bf16_f32 v50, v24, v25
    v_cvt_pk_bf16_f32 v51, v26, v27
    buffer_store_dwordx4 v[48:51], v5, s[24:27], s50 offen offset:1024 sc1
    v_mul_f32 v28, s52, v28
    v_mul_f32 v29, s52, v29
    v_mul_f32 v30, s52, v30
    v_mul_f32 v31, s52, v31
    v_mul_f32 v32, s52, v32
    v_mul_f32 v33, s52, v33
    v_mul_f32 v34, s52, v34
    v_mul_f32 v35, s52, v35
    v_cvt_pk_bf16_f32 v52, v28, v29
    v_cvt_pk_bf16_f32 v53, v30, v31
    v_cvt_pk_bf16_f32 v54, v32, v33
    v_cvt_pk_bf16_f32 v55, v34, v35
    buffer_store_dwordx4 v[52:55], v5, s[24:27], s50 offen offset:2048 sc1
    v_mul_f32 v36, s52, v36
    v_mul_f32 v37, s52, v37
    v_mul_f32 v38, s52, v38
    v_mul_f32 v39, s52, v39
    v_mul_f32 v40, s52, v40
    v_mul_f32 v41, s52, v41
    v_mul_f32 v42, s52, v42
    v_mul_f32 v43, s52, v43
    v_cvt_pk_bf16_f32 v56, v36, v37
    v_cvt_pk_bf16_f32 v57, v38, v39
    v_cvt_pk_bf16_f32 v58, v40, v41
    v_cvt_pk_bf16_f32 v59, v42, v43
    buffer_store_dwordx4 v[56:59], v5, s[24:27], s50 offen offset:3072 sc1
    s_branch L_p1_tail
L_p1_wo:
    s_waitcnt lgkmcnt(3)
    v_mfma_f32_16x16x32_bf16 v[12:15], v[60:63], v[80:83], 0
    v_mfma_f32_16x16x32_bf16 v[16:19], v[60:63], v[84:87], 0
    s_waitcnt lgkmcnt(2)
    v_mfma_f32_16x16x32_bf16 v[20:23], v[64:67], v[88:91], 0
    v_mfma_f32_16x16x32_bf16 v[24:27], v[64:67], v[92:95], 0
    s_waitcnt lgkmcnt(1)
    v_mfma_f32_16x16x32_bf16 v[28:31], v[68:71], v[96:99], 0
    v_mfma_f32_16x16x32_bf16 v[32:35], v[68:71], v[100:103], 0
    s_waitcnt lgkmcnt(0)
    v_mfma_f32_16x16x32_bf16 v[36:39], v[72:75], v[104:107], 0
    v_mfma_f32_16x16x32_bf16 v[40:43], v[72:75], v[108:111], 0
    v_and_b32 v146, 1, v3
    v_lshrrev_b32 v147, 2, v2
    v_lshl_add_u32 v147, v146, 2, v147
    v_mul_u32_u24 v147, 1040, v147
    v_lshrrev_b32 v148, 1, v3
    v_lshl_add_u32 v147, v148, 5, v147
    v_and_b32 v149, 3, v0
    v_lshl_add_u32 v147, v149, 3, v147
    s_lshl_b32 s50, s46, 8
    s_add_u32 s50, s50, 16384
    v_add_u32 v147, s50, v147
    ds_read_b64_tr_b16 v[80:81], v147 offset:0
    ds_read_b64_tr_b16 v[82:83], v147 offset:8320
    ds_read_b64_tr_b16 v[84:85], v147 offset:64
    ds_read_b64_tr_b16 v[86:87], v147 offset:8384
    ds_read_b64_tr_b16 v[88:89], v147 offset:128
    ds_read_b64_tr_b16 v[90:91], v147 offset:8448
    ds_read_b64_tr_b16 v[92:93], v147 offset:192
    ds_read_b64_tr_b16 v[94:95], v147 offset:8512
    v_lshlrev_b32 v147, 8, v146
    v_lshl_add_u32 v150, v148, 10, v147
    v_lshl_add_u32 v150, v2, 4, v150
    v_lshrrev_b32 v151, 3, v2
    v_lshl_add_u32 v147, v151, 10, v147
    v_bfe_u32 v151, v2, 2, 1
    v_lshl_add_u32 v147, v151, 7, v147
    v_lshl_add_u32 v147, v148, 6, v147
    v_lshl_add_u32 v147, v149, 4, v147
    s_sub_u32 s50, s2, 224
    s_lshr_b32 s51, s50, 1
    s_lshl_b32 s51, s51, 12
    s_and_b32 s50, s50, 1
    s_lshl_b32 s50, s50, 9
    s_add_u32 s50, s50, s51
    s_lshl_b32 s51, s46, 17
    s_add_u32 s50, s50, s51
    s_add_u32 s52, s50, 15466496
    s_add_u32 s50, s50, 14417920
    s_add_u32 s51, s50, 65536
    s_add_u32 s53, s52, 65536
    v_cvt_pk_bf16_f32 v44, v12, v13
    v_cvt_pk_bf16_f32 v45, v14, v15
    v_cvt_pk_bf16_f32 v46, v16, v17
    v_cvt_pk_bf16_f32 v47, v18, v19
    s_nop 0
    v_permlane32_swap_b32 v44, v46
    v_permlane32_swap_b32 v45, v47
    buffer_store_dwordx4 v[44:47], v147, s[24:27], s50 offen offset:0 sc1
    v_cvt_pk_bf16_f32 v48, v20, v21
    v_cvt_pk_bf16_f32 v49, v22, v23
    v_cvt_pk_bf16_f32 v50, v24, v25
    v_cvt_pk_bf16_f32 v51, v26, v27
    s_nop 0
    v_permlane32_swap_b32 v48, v50
    v_permlane32_swap_b32 v49, v51
    buffer_store_dwordx4 v[48:51], v147, s[24:27], s50 offen offset:2048 sc1
    v_cvt_pk_bf16_f32 v52, v28, v29
    v_cvt_pk_bf16_f32 v53, v30, v31
    v_cvt_pk_bf16_f32 v54, v32, v33
    v_cvt_pk_bf16_f32 v55, v34, v35
    s_nop 0
    v_permlane32_swap_b32 v52, v54
    v_permlane32_swap_b32 v53, v55
    buffer_store_dwordx4 v[52:55], v147, s[24:27], s51 offen offset:0 sc1
    v_cvt_pk_bf16_f32 v56, v36, v37
    v_cvt_pk_bf16_f32 v57, v38, v39
    v_cvt_pk_bf16_f32 v58, v40, v41
    v_cvt_pk_bf16_f32 v59, v42, v43
    s_nop 0
    v_permlane32_swap_b32 v56, v58
    v_permlane32_swap_b32 v57, v59
    buffer_store_dwordx4 v[56:59], v147, s[24:27], s51 offen offset:2048 sc1
    s_waitcnt lgkmcnt(0)
    buffer_store_dwordx4 v[80:83], v150, s[24:27], s52 offen offset:0 sc1
    buffer_store_dwordx4 v[84:87], v150, s[24:27], s52 offen offset:2048 sc1
    buffer_store_dwordx4 v[88:91], v150, s[24:27], s53 offen offset:0 sc1
    buffer_store_dwordx4 v[92:95], v150, s[24:27], s53 offen offset:2048 sc1
L_p1_tail:
    v_mov_b32 v147, 0
    buffer_load_dword v146, v147, s[40:43], 0 offen sc1
    s_mov_b32 s59, 0
    s_waitcnt vmcnt(0)
L_nonce_w:
    v_readfirstlane_b32 s49, v146
    s_nop 0
    s_cmp_lg_u32 s49, 0
    s_cbranch_scc1 L_nonce_ok_w
    buffer_load_dword v146, v147, s[40:43], 0 offen sc1
    s_add_u32 s59, s59, 1
    s_cmp_gt_u32 s59, 0x100000
    s_cbranch_scc1 L_end
    s_waitcnt vmcnt(0)
    s_branch L_nonce_w
L_nonce_ok_w:
    s_barrier
    s_cmp_lg_u32 s46, 0
    s_cbranch_scc1 L_nosig_w
    s_lshl_b32 s59, s2, 6
    v_mov_b32 v146, s49
    v_lshlrev_b32 v147, 2, v2
    s_mov_b64 exec, 0xffff
    buffer_store_dword v146, v147, s[24:27], s59 offen sc1
    s_mov_b64 exec, -1
L_nosig_w:
    s_and_b32 s50, s2, 3
    s_lshl_b32 s50, s50, 2
    s_add_u32 s50, s50, s46
    s_bfe_u32 s51, s2, 0x50002
    s_lshl_b32 s52, s51, 4
    v_add_u32 v168, s52, v2
    v_lshl_add_u32 v163, v3, 7, s50
    s_cmp_eq_u32 s50, 0
    s_cselect_b32 s52, -240, 0
    s_mov_b32 s53, 0x3d800000
    s_cselect_b32 s53, 0xbd800000, s53
    v_cmp_lt_u32 vcc, 1, v3
    v_mov_b32 v169, 0xbd800000
    v_mov_b32 v156, s53
    v_cndmask_b32 v169, v169, v156, vcc
    v_mov_b32 v156, s52
    v_cndmask_b32 v156, 0, v156, vcc
    v_add_u32 v163, v163, v156
    s_mov_b32 s52, 0x3d800000
    v_mul_u32_u24 v156, v163, v168
    v_and_b32 v156, 511, v156
    v_cvt_f32_u32 v156, v156
    v_mul_f32 v156, 0x3b000000, v156
    v_cos_f32 v157, v156
    v_sin_f32 v158, v156
    v_mul_f32 v157, s52, v157
    v_mul_f32 v158, v169, v158
    v_cvt_pk_bf16_f32 v164, v157, v158
    v_add_u32 v163, 32, v163
    v_mul_u32_u24 v156, v163, v168
    v_and_b32 v156, 511, v156
    v_cvt_f32_u32 v156, v156
    v_mul_f32 v156, 0x3b000000, v156
    v_cos_f32 v157, v156
    v_sin_f32 v158, v156
    v_mul_f32 v157, s52, v157
    v_mul_f32 v158, v169, v158
    v_cvt_pk_bf16_f32 v165, v157, v158
    v_add_u32 v163, 32, v163
    v_mul_u32_u24 v156, v163, v168
    v_and_b32 v156, 511, v156
    v_cvt_f32_u32 v156, v156
    v_mul_f32 v156, 0x3b000000, v156
    v_cos_f32 v157, v156
    v_sin_f32 v158, v156
    v_mul_f32 v157, s52, v157
    v_mul_f32 v158, v169, v158
    v_cvt_pk_bf16_f32 v166, v157, v158
    v_add_u32 v163, 32, v163
    v_mul_u32_u24 v156, v163, v168
    v_and_b32 v156, 511, v156
    v_cvt_f32_u32 v156, v156
    v_mul_f32 v156, 0x3b000000, v156
    v_cos_f32 v157, v156
    v_sin_f32 v158, v156
    v_mul_f32 v157, s52, v157
    v_mul_f32 v158, v169, v158
    v_cvt_pk_bf16_f32 v167, v157, v158
    s_cmp_lg_u32 s50, 0
    s_cbranch_scc1 L_p1_gst
    v_and_b32 v156, 1, v168
    v_lshlrev_b32 v156, 31, v156
    v_or_b32 v156, 0x3d353d35, v156
    v_cmp_eq_u32 vcc, 0, v3
    s_nop 1
    v_cndmask_b32 v164, v164, v156, vcc
L_p1_gst:
    s_lshl_b32 s51, s51, 4
    s_add_u32 s51, s51, s50
    s_lshl_b32 s51, s51, 10
    s_add_u32 s51, s51, 14942208
    buffer_store_dwordx4 v[164:167], v5, s[24:27], s51 offen sc1
L_p1_nog:
    s_and_b32 s23, s2, 127
    s_mul_i32 s23, s23, 16384
    s_add_u32 s23, s23, 16777216
    buffer_store_dwordx4 v[252:255], v4, s[24:27], s23 offen sc1
    s_and_b32 s23, s2, 127
    s_mul_i32 s23, s23, 16384
    s_add_u32 s23, s23, 16781312
    buffer_store_dwordx4 v[252:255], v4, s[24:27], s23 offen sc1
    s_and_b32 s23, s2, 127
    s_mul_i32 s23, s23, 16384
    s_add_u32 s23, s23, 16785408
    buffer_store_dwordx4 v[252:255], v4, s[24:27], s23 offen sc1
    s_and_b32 s23, s2, 127
    s_mul_i32 s23, s23, 16384
    s_add_u32 s23, s23, 16789504
    buffer_store_dwordx4 v[252:255], v4, s[24:27], s23 offen sc1
    s_waitcnt vmcnt(0)
L_p1_end:
    s_lshl_b32 s50, s46, 4
    v_add_u32 v164, s50, v2
    v_lshlrev_b32 v7, 6, v164
    v_lshl_add_u32 v7, v3, 4, v7
    v_lshlrev_b32 v6, 7, v164
    v_lshlrev_b32 v173, 2, v164
    v_lshl_add_u32 v173, v3, 10, v173
    v_lshrrev_b32 v165, 1, v3
    v_lshl_add_u32 v6, v165, 6, v6
    v_and_b32 v165, 1, v3
    v_lshl_add_u32 v6, v165, 4, v6
    v_bfe_u32 v165, v2, 1, 2
    v_bfe_u32 v166, v2, 3, 1
    v_lshlrev_b32 v166, 1, v166
    v_xor_b32 v165, v165, v166
    v_xor_b32 v165, v165, v3
    v_lshlrev_b32 v168, 6, v164
    v_lshl_add_u32 v168, v165, 4, v168
    v_add_u32 v168, 135168, v168
    v_lshrrev_b32 v165, 2, v2
    v_lshl_add_u32 v166, v3, 3, v165
    v_lshlrev_b32 v169, 6, v166
    v_lshrrev_b32 v165, 1, v165
    v_bfe_u32 v166, v0, 1, 1
    v_xor_b32 v165, v165, v166
    v_and_b32 v166, 1, v3
    v_lshl_or_b32 v165, v166, 1, v165
    v_lshl_add_u32 v169, v165, 4, v169
    v_and_b32 v165, 1, v0
    v_lshl_add_u32 v169, v165, 3, v169
    v_add_u32 v169, 135168, v169
    v_xor_b32 v170, 32, v169
    v_mul_u32_u24 v171, 144, v2
    v_lshl_add_u32 v171, v3, 3, v171
    s_lshl_b32 s50, s46, 5
    s_add_u32 s50, s50, 143360
    v_add_u32 v171, s50, v171
    v_lshrrev_b32 v165, 2, v2
    v_lshlrev_b32 v165, 3, v165
    v_and_b32 v166, 3, v2
    v_add_u32 v165, v165, v166
    v_mul_u32_u24 v172, 144, v165
    v_lshl_add_u32 v172, v3, 4, v172
    v_add_u32 v172, 143360, v172
    v_add_u32 v167, 131072, v5
    s_mov_b32 s50, 0x80008000
    s_mov_b32 s56, 0x00003b00
    s_mov_b32 s57, 0x3b000000
    v_accvgpr_read_b32 v76, a192
    v_accvgpr_read_b32 v77, a193
    v_accvgpr_read_b32 v78, a194
    v_accvgpr_read_b32 v79, a195
    v_accvgpr_read_b32 v80, a196
    v_accvgpr_read_b32 v81, a197
    v_accvgpr_read_b32 v82, a198
    v_accvgpr_read_b32 v83, a199
    v_accvgpr_read_b32 v84, a200
    v_accvgpr_read_b32 v85, a201
    v_accvgpr_read_b32 v86, a202
    v_accvgpr_read_b32 v87, a203
    v_accvgpr_read_b32 v88, a204
    v_accvgpr_read_b32 v89, a205
    v_accvgpr_read_b32 v90, a206
    v_accvgpr_read_b32 v91, a207
    v_accvgpr_read_b32 v132, a248
    v_accvgpr_read_b32 v133, a249
    v_accvgpr_read_b32 v134, a250
    v_accvgpr_read_b32 v135, a251
    v_accvgpr_read_b32 v136, a252
    v_accvgpr_read_b32 v137, a253
    v_accvgpr_read_b32 v138, a254
    v_accvgpr_read_b32 v139, a255
    v_xor_b32 v132, s50, v132
    v_xor_b32 v133, s50, v133
    v_xor_b32 v134, s50, v134
    v_xor_b32 v135, s50, v135
    v_xor_b32 v136, s50, v136
    v_xor_b32 v137, s50, v137
    v_xor_b32 v138, s50, v138
    v_xor_b32 v139, s50, v139
    v_lshlrev_b32 v20, 1, v7
    s_lshl_b32 s51, s48, 2
    s_add_u32 s51, s51, s46
    v_min_u32 v92, 2, v1
    v_lshl_add_u32 v164, v92, 5, s51
    v_mul_u32_u24 v165, 43, v164
    v_lshrrev_b32 v165, 9, v165
    v_mul_u32_u24 v166, 12, v165
    v_sub_u32 v164, v164, v166
    v_lshl_add_u32 v164, v164, 3, v165
    v_add_u32 v164, 128, v164
    v_lshlrev_b32 v174, 6, v164
    s_cmp_eq_u32 s2, 0
    s_cselect_b32 s58, 0, -1
    s_cselect_b32 s51, 32, 0
    s_mul_i32 s52, s2, 8320
    s_add_u32 s54, s52, 1048576
    s_add_u32 s54, s54, s51
    s_xor_b32 s55, s54, 32
    s_lshr_b32 s51, s2, 4
    s_and_b32 s52, s2, 15
    s_lshl_b32 s53, s52, 5
    s_add_u32 s23, s53, s51
    s_sub_u32 s59, 512, s23
    s_sub_u32 s53, s53, 240
    s_cmp_eq_u32 s51, 0
    s_cselect_b32 s59, s53, s59
    s_cmp_lt_u32 s52, 8
    s_cselect_b32 s23, s23, s59
    s_sub_u32 s23, s23, 1
    s_and_b32 s23, s23, 255
    s_mul_i32 s52, s23, 8320
    s_add_u32 s52, s52, 3407872
    s_lshl_b32 s62, s48, 2
    s_add_u32 s62, s62, s46
    s_mul_i32 s62, s62, 49152
    s_add_u32 s62, s62, 12845056
    s_add_u32 s63, s62, 16384
    s_add_u32 s22, s62, 32768
    v_lshrrev_b32 v176, 1, v0
    v_lshlrev_b32 v176, 6, v176
    s_mov_b32 s59, 0
L_poll:
    buffer_load_dword v92, v174, s[24:27], 0 offen sc1
    buffer_load_dword v177, v176, s[24:27], 0 offen sc1
    s_add_u32 s59, s59, 1
    s_cmp_gt_u32 s59, 0x100000
    s_cbranch_scc1 L_end
    s_waitcnt vmcnt(0) lgkmcnt(0)
    v_cmp_ne_u32 vcc, s49, v177
    s_cbranch_vccnz L_poll
    s_barrier
    v_cmp_ne_u32 vcc, s49, v92
    s_mov_b32 s36, s24
    s_mov_b32 s37, s25
    s_mov_b32 s39, 0x20000
    s_cmp_eq_u64 vcc, 0
    s_cselect_b64 s[10:11], -1, 0
    s_cselect_b32 s38, 29360128, 0
    s_mov_b32 s53, 65536
    buffer_load_dwordx4 v[68:71], v20, s[24:27], s53 offen offset:0 sc1
    s_mov_b32 s53, 65536
    buffer_load_dwordx4 v[72:75], v20, s[24:27], s53 offen offset:16 sc1
    buffer_load_dwordx4 v[12:15], v6, s[24:27], s54 offen sc1
    buffer_load_dwordx4 v[16:19], v6, s[24:27], s55 offen sc1
    s_add_u32 s51, s52, 4096
    buffer_load_dword v140, v173, s[24:27], s52 offen offset:0 sc1
    buffer_load_dword v141, v173, s[24:27], s52 offen offset:256 sc1
    buffer_load_dword v142, v173, s[24:27], s52 offen offset:512 sc1
    buffer_load_dword v143, v173, s[24:27], s52 offen offset:768 sc1
    buffer_load_dword v144, v173, s[24:27], s51 offen offset:0 sc1
    buffer_load_dword v145, v173, s[24:27], s51 offen offset:256 sc1
    buffer_load_dword v146, v173, s[24:27], s51 offen offset:512 sc1
    buffer_load_dword v147, v173, s[24:27], s51 offen offset:768 sc1
    buffer_load_dword v92, v174, s[24:27], 0 offen sc1
    ds_read_b128 v[110:113], v167 offset:0
    ds_read_b128 v[116:119], v167 offset:1024
    ds_read_b128 v[122:125], v167 offset:2048
    ds_read_b128 v[128:131], v167 offset:3072
    s_mov_b64 exec, s[10:11]
    buffer_load_dwordx4 a[64:67], v5, s[24:27], s63 offen offset:0 sc1
    s_mov_b64 exec, -1
    s_mov_b64 exec, s[10:11]
    buffer_load_dwordx4 a[128:131], v5, s[24:27], s22 offen offset:0 sc1
    s_mov_b64 exec, -1
    s_mov_b64 exec, s[10:11]
    buffer_load_dwordx4 a[0:3], v5, s[24:27], s62 offen offset:0 sc1
    s_mov_b64 exec, -1
    s_mov_b64 exec, s[10:11]
    buffer_load_dwordx4 a[68:71], v5, s[24:27], s63 offen offset:1024 sc1
    s_mov_b64 exec, -1
    s_mov_b64 exec, s[10:11]
    buffer_load_dwordx4 a[132:135], v5, s[24:27], s22 offen offset:1024 sc1
    s_mov_b64 exec, -1
    s_mov_b64 exec, s[10:11]
    buffer_load_dwordx4 a[4:7], v5, s[24:27], s62 offen offset:1024 sc1
    s_mov_b64 exec, -1
    s_waitcnt lgkmcnt(0)
    v_xor_b32 v108, s50, v112
    v_xor_b32 v109, s50, v113
    v_xor_b32 v114, s50, v118
    v_xor_b32 v115, s50, v119
    v_xor_b32 v120, s50, v124
    v_xor_b32 v121, s50, v125
    v_xor_b32 v126, s50, v130
    v_xor_b32 v127, s50, v131
    s_waitcnt vmcnt(15)
    v_lshlrev_b32 v52, 16, v12
    v_and_b32 v53, 0xffff0000, v12
    v_lshlrev_b32 v54, 16, v13
    v_and_b32 v55, 0xffff0000, v13
    v_lshlrev_b32 v56, 16, v14
    v_and_b32 v57, 0xffff0000, v14
    v_lshlrev_b32 v58, 16, v15
    v_and_b32 v59, 0xffff0000, v15
    v_xor_b32 v164, s50, v16
    v_lshlrev_b32 v60, 16, v164
    v_and_b32 v61, 0xffff0000, v164
    v_xor_b32 v164, s50, v17
    v_lshlrev_b32 v62, 16, v164
    v_and_b32 v63, 0xffff0000, v164
    v_xor_b32 v164, s50, v18
    v_lshlrev_b32 v64, 16, v164
    v_and_b32 v65, 0xffff0000, v164
    v_xor_b32 v164, s50, v19
    v_lshlrev_b32 v66, 16, v164
    v_and_b32 v67, 0xffff0000, v164
    s_waitcnt vmcnt(6)
    s_mov_b32 s12, s10
    v_cmp_ne_u32 vcc, s49, v92
    s_nop 0
    s_cmp_eq_u64 vcc, 0
    s_cselect_b64 s[10:11], -1, s[10:11]
    s_and_b32 s38, s10, 29360128
    v_pk_mul_f32 v[36:37], v[52:53], v[68:69]
    v_pk_mul_f32 v[38:39], v[54:55], v[70:71]
    v_pk_mul_f32 v[40:41], v[56:57], v[72:73]
    v_pk_mul_f32 v[42:43], v[58:59], v[74:75]
    v_cvt_pk_bf16_f32 v156, v36, v37
    v_cvt_pk_bf16_f32 v157, v38, v39
    v_cvt_pk_bf16_f32 v158, v40, v41
    v_cvt_pk_bf16_f32 v159, v42, v43
    ds_write_b128 v168, v[156:159]
    v_pk_mul_f32 v[44:45], v[60:61], v[68:69] neg_lo:[1,0] neg_hi:[1,0]
    v_pk_mul_f32 v[46:47], v[62:63], v[70:71] neg_lo:[1,0] neg_hi:[1,0]
    s_mov_b64 exec, s[10:11]
    buffer_load_dwordx4 a[72:75], v5, s[24:27], s63 offen offset:2048 sc1
    s_mov_b64 exec, -1
    v_pk_mul_f32 v[48:49], v[64:65], v[72:73] neg_lo:[1,0] neg_hi:[1,0]
    v_pk_mul_f32 v[50:51], v[66:67], v[74:75] neg_lo:[1,0] neg_hi:[1,0]
    v_cvt_pk_bf16_f32 v160, v44, v45
    v_cvt_pk_bf16_f32 v161, v46, v47
    v_cvt_pk_bf16_f32 v162, v48, v49
    v_cvt_pk_bf16_f32 v163, v50, v51
    v_and_b32 v160, s58, v160
    v_and_b32 v161, s58, v161
    v_and_b32 v162, s58, v162
    v_and_b32 v163, s58, v163
    ds_write_b128 v168, v[160:163] offset:4096
    s_mov_b64 exec, s[10:11]
    buffer_load_dwordx4 a[136:139], v5, s[24:27], s22 offen offset:2048 sc1
    s_mov_b64 exec, -1
    v_lshlrev_b32 v92, 16, v140
    v_and_b32 v100, 0xffff0000, v140
    v_lshlrev_b32 v93, 16, v141
    v_and_b32 v101, 0xffff0000, v141
    v_lshlrev_b32 v94, 16, v142
    v_and_b32 v102, 0xffff0000, v142
    v_lshlrev_b32 v95, 16, v143
    v_and_b32 v103, 0xffff0000, v143
    v_lshlrev_b32 v96, 16, v144
    v_and_b32 v104, 0xffff0000, v144
    v_lshlrev_b32 v97, 16, v145
    s_mul_i32 s23, s2, 16384
    s_add_u32 s23, s23, 18874368
    buffer_store_dwordx4 v[252:255], v4, s[24:27], s23 offen sc1
    v_and_b32 v105, 0xffff0000, v145
    v_lshlrev_b32 v98, 16, v146
    v_and_b32 v106, 0xffff0000, v146
    v_lshlrev_b32 v99, 16, v147
    v_and_b32 v107, 0xffff0000, v147
    s_waitcnt lgkmcnt(0)
    s_barrier
    ds_read_b64_tr_b16 v[20:21], v169 offset:0
    ds_read_b64_tr_b16 v[22:23], v170 offset:256
    ds_read_b64_tr_b16 v[24:25], v169 offset:2048
    ds_read_b64_tr_b16 v[26:27], v170 offset:2304
    s_mov_b64 exec, s[10:11]
    buffer_load_dwordx4 a[8:11], v5, s[24:27], s62 offen offset:2048 sc1
    s_mov_b64 exec, -1
    ds_read_b64_tr_b16 v[28:29], v169 offset:4096
    ds_read_b64_tr_b16 v[30:31], v170 offset:4352
    ds_read_b64_tr_b16 v[32:33], v169 offset:6144
    ds_read_b64_tr_b16 v[34:35], v170 offset:6400
    ds_read_b64_tr_b16 v[36:37], v170 offset:0
    ds_read_b64_tr_b16 v[38:39], v169 offset:256
    ds_read_b64_tr_b16 v[40:41], v170 offset:2048
    ds_read_b64_tr_b16 v[42:43], v169 offset:2304
    ds_read_b64_tr_b16 v[44:45], v170 offset:4096
    ds_read_b64_tr_b16 v[46:47], v169 offset:4352
    ds_read_b64_tr_b16 v[48:49], v170 offset:6144
    s_mov_b64 exec, s[10:11]
    buffer_load_dwordx4 a[76:79], v5, s[24:27], s63 offen offset:3072 sc1
    s_mov_b64 exec, -1
    s_add_u32 s63, s63, 4096
    ds_read_b64_tr_b16 v[50:51], v169 offset:6400
    s_waitcnt lgkmcnt(14)
    v_mfma_f32_16x16x32_bf16 v[140:143], v[20:23], a[240:243], 0
    v_mfma_f32_16x16x32_bf16 v[148:151], v[20:23], v[132:135], 0
    s_waitcnt lgkmcnt(12)
    v_mfma_f32_16x16x32_bf16 v[140:143], v[24:27], a[244:247], v[140:143]
    v_mfma_f32_16x16x32_bf16 v[148:151], v[24:27], v[136:139], v[148:151]
    s_mul_i32 s23, s2, 16384
    s_add_u32 s23, s23, 18878464
    buffer_store_dwordx4 v[252:255], v4, s[24:27], s23 offen sc1
    s_waitcnt lgkmcnt(10)
    v_mfma_f32_16x16x32_bf16 v[140:143], v[28:31], a[248:251], v[140:143]
    v_mfma_f32_16x16x32_bf16 v[148:151], v[28:31], a[240:243], v[148:151]
    s_waitcnt lgkmcnt(8)
    v_mfma_f32_16x16x32_bf16 v[140:143], v[32:35], a[252:255], v[140:143]
    v_mfma_f32_16x16x32_bf16 v[148:151], v[32:35], a[244:247], v[148:151]
    s_waitcnt lgkmcnt(6)
    v_mfma_f32_16x16x32_bf16 v[144:147], v[36:39], a[240:243], 0
    s_mov_b64 exec, s[10:11]
    buffer_load_dwordx4 a[140:143], v5, s[24:27], s22 offen offset:3072 sc1
    s_mov_b64 exec, -1
    s_add_u32 s22, s22, 4096
    v_mfma_f32_16x16x32_bf16 v[152:155], v[36:39], v[132:135], 0
    s_waitcnt lgkmcnt(4)
    v_mfma_f32_16x16x32_bf16 v[144:147], v[40:43], a[244:247], v[144:147]
    v_mfma_f32_16x16x32_bf16 v[152:155], v[40:43], v[136:139], v[152:155]
    s_waitcnt lgkmcnt(2)
    v_mfma_f32_16x16x32_bf16 v[144:147], v[44:47], a[248:251], v[144:147]
    v_mfma_f32_16x16x32_bf16 v[152:155], v[44:47], a[240:243], v[152:155]
    s_mov_b64 exec, s[10:11]
    buffer_load_dwordx4 a[12:15], v5, s[24:27], s62 offen offset:3072 sc1
    s_mov_b64 exec, -1
    s_add_u32 s62, s62, 4096
    s_waitcnt lgkmcnt(0)
    v_mfma_f32_16x16x32_bf16 v[144:147], v[48:51], a[252:255], v[144:147]
    v_mfma_f32_16x16x32_bf16 v[152:155], v[48:51], a[244:247], v[152:155]
    v_pk_mul_f32 v[164:165], v[148:149], v[84:85]
    v_pk_mul_f32 v[166:167], v[140:141], v[84:85]
    v_pk_fma_f32 v[140:141], v[140:141], v[76:77], v[164:165] neg_lo:[0,0,1] neg_hi:[0,0,1]
    v_pk_fma_f32 v[148:149], v[148:149], v[76:77], v[166:167]
    v_pk_mul_f32 v[164:165], v[150:151], v[86:87]
    v_pk_mul_f32 v[166:167], v[142:143], v[86:87]
    s_mul_i32 s23, s2, 16384
    s_add_u32 s23, s23, 18882560
    buffer_store_dwordx4 v[252:255], v4, s[24:27], s23 offen sc1
    v_pk_fma_f32 v[142:143], v[142:143], v[78:79], v[164:165] neg_lo:[0,0,1] neg_hi:[0,0,1]
    v_pk_fma_f32 v[150:151], v[150:151], v[78:79], v[166:167]
    v_cvt_pk_bf16_f32 v156, v140, v141
    v_cvt_pk_bf16_f32 v157, v142, v143
    v_cvt_pk_bf16_f32 v158, v148, v149
    v_cvt_pk_bf16_f32 v159, v150, v151
    v_pk_mul_f32 v[164:165], v[152:153], v[88:89]
    v_pk_mul_f32 v[166:167], v[144:145], v[88:89]
    v_pk_fma_f32 v[144:145], v[144:145], v[80:81], v[164:165] neg_lo:[0,0,1] neg_hi:[0,0,1]
    v_pk_fma_f32 v[152:153], v[152:153], v[80:81], v[166:167]
    v_pk_mul_f32 v[164:165], v[154:155], v[90:91]
    s_mov_b64 exec, s[10:11]
    buffer_load_dwordx4 a[80:83], v5, s[24:27], s63 offen offset:0 sc1
    s_mov_b64 exec, -1
    v_pk_mul_f32 v[166:167], v[146:147], v[90:91]
    v_pk_fma_f32 v[146:147], v[146:147], v[82:83], v[164:165] neg_lo:[0,0,1] neg_hi:[0,0,1]
    v_pk_fma_f32 v[154:155], v[154:155], v[82:83], v[166:167]
    v_cvt_pk_bf16_f32 v160, v144, v145
    v_cvt_pk_bf16_f32 v161, v146, v147
    v_cvt_pk_bf16_f32 v162, v152, v153
    v_cvt_pk_bf16_f32 v163, v154, v155
    v_mfma_f32_16x16x32_bf16 v[20:23], v[110:113], v[156:159], 0
    v_mfma_f32_16x16x32_bf16 v[28:31], v[108:111], v[156:159], 0
    s_mov_b64 exec, s[10:11]
    buffer_load_dwordx4 a[144:147], v5, s[24:27], s22 offen offset:0 sc1
    s_mov_b64 exec, -1
    v_mfma_f32_16x16x32_bf16 v[20:23], v[116:119], v[160:163], v[20:23]
    v_mfma_f32_16x16x32_bf16 v[28:31], v[114:117], v[160:163], v[28:31]
    v_mfma_f32_16x16x32_bf16 v[24:27], v[122:125], v[156:159], 0
    v_mfma_f32_16x16x32_bf16 v[32:35], v[120:123], v[156:159], 0
    v_mfma_f32_16x16x32_bf16 v[24:27], v[128:131], v[160:163], v[24:27]
    v_mfma_f32_16x16x32_bf16 v[32:35], v[126:129], v[160:163], v[32:35]
    s_mul_i32 s23, s2, 16384
    s_add_u32 s23, s23, 18886656
    buffer_store_dwordx4 v[252:255], v4, s[24:27], s23 offen sc1
    v_accvgpr_read_b32 v76, a208
    v_accvgpr_read_b32 v77, a209
    v_accvgpr_read_b32 v78, a210
    v_accvgpr_read_b32 v79, a211
    v_accvgpr_read_b32 v80, a212
    v_accvgpr_read_b32 v81, a213
    v_accvgpr_read_b32 v82, a214
    v_accvgpr_read_b32 v83, a215
    v_accvgpr_read_b32 v84, a216
    v_accvgpr_read_b32 v85, a217
    v_accvgpr_read_b32 v86, a218
    s_mov_b64 exec, s[10:11]
    buffer_load_dwordx4 a[16:19], v5, s[24:27], s62 offen offset:0 sc1
    s_mov_b64 exec, -1
    v_accvgpr_read_b32 v87, a219
    v_accvgpr_read_b32 v88, a220
    v_accvgpr_read_b32 v89, a221
    v_accvgpr_read_b32 v90, a222
    v_accvgpr_read_b32 v91, a223
    v_pk_mul_f32 v[164:165], v[28:29], v[100:101]
    v_pk_mul_f32 v[166:167], v[20:21], v[100:101]
    v_pk_fma_f32 v[20:21], v[20:21], v[92:93], v[164:165] neg_lo:[0,0,1] neg_hi:[0,0,1]
    v_pk_fma_f32 v[28:29], v[28:29], v[92:93], v[166:167] neg_lo:[1,0,1] neg_hi:[1,0,1]
    v_pk_mul_f32 v[164:165], v[30:31], v[102:103]
    v_pk_mul_f32 v[166:167], v[22:23], v[102:103]
    s_mov_b64 exec, s[10:11]
    buffer_load_dwordx4 a[84:87], v5, s[24:27], s63 offen offset:1024 sc1
    s_mov_b64 exec, -1
    v_pk_fma_f32 v[22:23], v[22:23], v[94:95], v[164:165] neg_lo:[0,0,1] neg_hi:[0,0,1]
    v_pk_fma_f32 v[30:31], v[30:31], v[94:95], v[166:167] neg_lo:[1,0,1] neg_hi:[1,0,1]
    v_cvt_pk_bf16_f32 v156, v20, v21
    v_cvt_pk_bf16_f32 v157, v22, v23
    v_cvt_pk_bf16_f32 v158, v28, v29
    v_cvt_pk_bf16_f32 v159, v30, v31
    v_pk_mul_f32 v[164:165], v[32:33], v[104:105]
    v_pk_mul_f32 v[166:167], v[24:25], v[104:105]
    v_pk_fma_f32 v[24:25], v[24:25], v[96:97], v[164:165] neg_lo:[0,0,1] neg_hi:[0,0,1]
    v_pk_fma_f32 v[32:33], v[32:33], v[96:97], v[166:167] neg_lo:[1,0,1] neg_hi:[1,0,1]
    v_pk_mul_f32 v[164:165], v[34:35], v[106:107]
    s_mul_i32 s23, s2, 8320
    s_add_u32 s23, s23, 8126464
    buffer_store_dwordx4 v[252:255], v4, s[24:27], s23 offen sc1
    v_pk_mul_f32 v[166:167], v[26:27], v[106:107]
    v_pk_fma_f32 v[26:27], v[26:27], v[98:99], v[164:165] neg_lo:[0,0,1] neg_hi:[0,0,1]
    v_pk_fma_f32 v[34:35], v[34:35], v[98:99], v[166:167] neg_lo:[1,0,1] neg_hi:[1,0,1]
    v_cvt_pk_bf16_f32 v160, v24, v25
    v_cvt_pk_bf16_f32 v161, v26, v27
    v_cvt_pk_bf16_f32 v162, v32, v33
    v_cvt_pk_bf16_f32 v163, v34, v35
    v_mfma_f32_16x16x32_bf16 v[140:143], v[156:159], v[110:113], 0
    v_mfma_f32_16x16x32_bf16 v[148:151], v[156:159], v[108:111], 0
    s_mov_b64 exec, s[10:11]
    buffer_load_dwordx4 a[148:151], v5, s[24:27], s22 offen offset:1024 sc1
    s_mov_b64 exec, -1
    v_mfma_f32_16x16x32_bf16 v[140:143], v[160:163], v[116:119], v[140:143]
    v_mfma_f32_16x16x32_bf16 v[148:151], v[160:163], v[114:117], v[148:151]
    v_mfma_f32_16x16x32_bf16 v[144:147], v[156:159], v[122:125], 0
    v_mfma_f32_16x16x32_bf16 v[152:155], v[156:159], v[120:123], 0
    v_mfma_f32_16x16x32_bf16 v[144:147], v[160:163], v[128:131], v[144:147]
    v_mfma_f32_16x16x32_bf16 v[152:155], v[160:163], v[126:129], v[152:155]
    s_mov_b64 exec, s[10:11]
    buffer_load_dwordx4 a[20:23], v5, s[24:27], s62 offen offset:1024 sc1
    s_mov_b64 exec, -1
    v_accvgpr_write_b32 a224, v92
    v_accvgpr_write_b32 a225, v93
    v_accvgpr_write_b32 a226, v94
    v_accvgpr_write_b32 a227, v95
    v_accvgpr_write_b32 a228, v96
    v_accvgpr_write_b32 a229, v97
    v_accvgpr_write_b32 a230, v98
    v_accvgpr_write_b32 a231, v99
    v_accvgpr_write_b32 a232, v100
    v_accvgpr_write_b32 a233, v101
    v_accvgpr_write_b32 a234, v102
    s_mul_i32 s23, s2, 8320
    s_add_u32 s23, s23, 8130560
    buffer_store_dwordx4 v[252:255], v4, s[24:27], s23 offen sc1
    v_accvgpr_write_b32 a235, v103
    v_accvgpr_write_b32 a236, v104
    v_accvgpr_write_b32 a237, v105
    v_accvgpr_write_b32 a238, v106
    v_accvgpr_write_b32 a239, v107
    s_mul_i32 s52, s2, 8448
    s_add_u32 s54, s52, 5767168
    s_add_u32 s55, s54, 4224
    s_cmp_eq_u32 s2, 0
    s_cselect_b32 s52, s55, s54
    s_cselect_b32 s53, s54, s55
    v_pk_mul_f32 v[164:165], v[148:149], v[84:85]
    s_mov_b64 exec, s[10:11]
    buffer_load_dwordx4 a[88:91], v5, s[24:27], s63 offen offset:2048 sc1
    s_mov_b64 exec, -1
    v_pk_mul_f32 v[166:167], v[140:141], v[84:85]
    v_pk_fma_f32 v[140:141], v[140:141], v[76:77], v[164:165] neg_lo:[0,0,1] neg_hi:[0,0,1]
    v_pk_fma_f32 v[148:149], v[148:149], v[76:77], v[166:167]
    v_pk_mul_f32 v[164:165], v[150:151], v[86:87]
    v_pk_mul_f32 v[166:167], v[142:143], v[86:87]
    v_pk_fma_f32 v[142:143], v[142:143], v[78:79], v[164:165] neg_lo:[0,0,1] neg_hi:[0,0,1]
    v_pk_fma_f32 v[150:151], v[150:151], v[78:79], v[166:167]
    v_cvt_pk_bf16_f32 v156, v140, v141
    v_cvt_pk_bf16_f32 v157, v142, v143
    v_cvt_pk_bf16_f32 v158, v148, v149
    v_cvt_pk_bf16_f32 v159, v150, v151
    s_mov_b64 exec, s[10:11]
    buffer_load_dwordx4 a[152:155], v5, s[24:27], s22 offen offset:2048 sc1
    s_mov_b64 exec, -1
    ds_write_b64 v171, v[156:157] offset:0
    ds_write_b64 v171, v[158:159] offset:4608
    v_pk_mul_f32 v[164:165], v[152:153], v[88:89]
    v_pk_mul_f32 v[166:167], v[144:145], v[88:89]
    v_pk_fma_f32 v[144:145], v[144:145], v[80:81], v[164:165] neg_lo:[0,0,1] neg_hi:[0,0,1]
    v_pk_fma_f32 v[152:153], v[152:153], v[80:81], v[166:167]
    v_pk_mul_f32 v[164:165], v[154:155], v[90:91]
    v_pk_mul_f32 v[166:167], v[146:147], v[90:91]
    v_pk_fma_f32 v[146:147], v[146:147], v[82:83], v[164:165] neg_lo:[0,0,1] neg_hi:[0,0,1]
    v_pk_fma_f32 v[154:155], v[154:155], v[82:83], v[166:167]
    v_cvt_pk_bf16_f32 v160, v144, v145
    s_lshr_b32 s23, s2, 5
    s_mul_i32 s23, s23, 128
    s_lshl_b32 s59, s2, 7
    s_add_u32 s23, s23, s59
    s_add_u32 s23, s23, 81920
    s_mov_b64 exec, 0xff
    buffer_store_dwordx4 v[252:255], v5, s[24:27], s23 offen sc1
    s_mov_b64 exec, -1
    v_cvt_pk_bf16_f32 v161, v146, v147
    v_cvt_pk_bf16_f32 v162, v152, v153
    v_cvt_pk_bf16_f32 v163, v154, v155
    ds_write_b64 v171, v[160:161] offset:2304
    ds_write_b64 v171, v[162:163] offset:6912
    s_waitcnt lgkmcnt(0)
    s_barrier
    ds_read_b128 v[20:23], v172 offset:0
    ds_read_b128 v[36:39], v172 offset:576
    ds_read_b128 v[24:27], v172 offset:64
    ds_read_b128 v[40:43], v172 offset:640
    s_mov_b64 exec, s[10:11]
    buffer_load_dwordx4 a[24:27], v5, s[24:27], s62 offen offset:2048 sc1
    s_mov_b64 exec, -1
    ds_read_b128 v[28:31], v172 offset:4608
    ds_read_b128 v[44:47], v172 offset:5184
    ds_read_b128 v[32:35], v172 offset:4672
    ds_read_b128 v[48:51], v172 offset:5248
    s_waitcnt lgkmcnt(6)
    v_mfma_f32_16x16x32_bf16 v[52:55], v[20:23], a[240:243], v[52:55]
    v_mfma_f32_16x16x32_bf16 v[56:59], v[36:39], a[240:243], v[56:59]
    s_waitcnt lgkmcnt(4)
    v_mfma_f32_16x16x32_bf16 v[52:55], v[24:27], a[244:247], v[52:55]
    s_mov_b64 exec, s[10:11]
    buffer_load_dwordx4 a[92:95], v5, s[24:27], s63 offen offset:3072 sc1
    s_mov_b64 exec, -1
    s_add_u32 s63, s63, 4096
    v_mfma_f32_16x16x32_bf16 v[56:59], v[40:43], a[244:247], v[56:59]
    s_waitcnt lgkmcnt(2)
    v_mfma_f32_16x16x32_bf16 v[52:55], v[28:31], a[248:251], v[52:55]
    v_mfma_f32_16x16x32_bf16 v[56:59], v[44:47], a[248:251], v[56:59]
    s_waitcnt lgkmcnt(0)
    v_mfma_f32_16x16x32_bf16 v[52:55], v[32:35], a[252:255], v[52:55]
    v_mfma_f32_16x16x32_bf16 v[56:59], v[48:51], a[252:255], v[56:59]
    s_mov_b64 exec, s[10:11]
    buffer_load_dwordx4 a[156:159], v5, s[24:27], s22 offen offset:3072 sc1
    s_mov_b64 exec, -1
    s_add_u32 s22, s22, 4096
    v_mfma_f32_16x16x32_bf16 v[60:63], v[20:23], v[132:135], v[60:63]
    v_mfma_f32_16x16x32_bf16 v[64:67], v[36:39], v[132:135], v[64:67]
    v_mfma_f32_16x16x32_bf16 v[60:63], v[24:27], v[136:139], v[60:63]
    v_mfma_f32_16x16x32_bf16 v[64:67], v[40:43], v[136:139], v[64:67]
    v_mfma_f32_16x16x32_bf16 v[60:63], v[28:31], a[240:243], v[60:63]
    v_mfma_f32_16x16x32_bf16 v[64:67], v[44:47], a[240:243], v[64:67]
    s_mov_b64 exec, s[10:11]
    buffer_load_dwordx4 a[28:31], v5, s[24:27], s62 offen offset:3072 sc1
    s_mov_b64 exec, -1
    s_add_u32 s62, s62, 4096
    v_mfma_f32_16x16x32_bf16 v[60:63], v[32:35], a[244:247], v[60:63]
    v_mfma_f32_16x16x32_bf16 v[64:67], v[48:51], a[244:247], v[64:67]
    v_cvt_pk_bf16_f32 v156, v52, v53
    v_cvt_pk_bf16_f32 v157, v54, v55
    v_cvt_pk_bf16_f32 v158, v56, v57
    v_cvt_pk_bf16_f32 v159, v58, v59
    v_min_u32 v156, -2, v156
    buffer_store_dwordx4 v[156:159], v7, s[24:27], s52 offen sc1
    s_nop 0
    v_cvt_pk_bf16_f32 v160, -v60, -v61
    v_cvt_pk_bf16_f32 v161, -v62, -v63
    v_cvt_pk_bf16_f32 v162, -v64, -v65
    v_cvt_pk_bf16_f32 v163, -v66, -v67
    v_bfi_b32 v160, s58, v160, v16
    v_bfi_b32 v161, s58, v161, v17
    v_bfi_b32 v162, s58, v162, v18
    v_bfi_b32 v163, s58, v163, v19
    v_min_u32 v160, -2, v160
    buffer_store_dwordx4 v[160:163], v7, s[24:27], s53 offen sc1
    s_cmp_eq_u32 s12, 0
    s_cbranch_scc1 L_wq_slow
L_wq_ok:
    v_and_b32 v6, 27, v0
    v_cmp_eq_u32 vcc, 16, v6
    v_mov_b32 v6, 0x3f803f80
    s_nop 0
    v_cndmask_b32 v6, 0, v6, vcc
    s_cmp_ge_u32 s47, 4
    s_cselect_b32 s50, -1, 0
    v_and_b32 v8, s50, v6
    buffer_load_dwordx4 a[96:99], v5, s[24:27], s63 offen offset:0 sc1
    v_and_b32 v9, s50, v6
    v_and_b32 v10, s50, v6
    v_and_b32 v11, s50, v6
    v_and_b32 v12, s50, v6
    v_and_b32 v13, s50, v6
    v_and_b32 v14, s50, v6
    v_and_b32 v15, s50, v6
    v_and_b32 v16, s50, v6
    v_and_b32 v17, s50, v6
    v_and_b32 v18, s50, v6
    buffer_load_dwordx4 a[160:163], v5, s[24:27], s22 offen offset:0 sc1
    v_and_b32 v19, s50, v6
    v_and_b32 v20, s50, v6
    v_and_b32 v21, s50, v6
    v_and_b32 v22, s50, v6
    v_and_b32 v23, s50, v6
    s_cmp_ge_u32 s47, 3
    s_cselect_b32 s50, -1, 0
    v_and_b32 v24, s50, v6
    v_and_b32 v25, s50, v6
    v_and_b32 v26, s50, v6
    buffer_load_dwordx4 a[32:35], v5, s[24:27], s62 offen offset:0 sc1
    v_and_b32 v27, s50, v6
    v_and_b32 v28, s50, v6
    v_and_b32 v29, s50, v6
    v_and_b32 v30, s50, v6
    v_and_b32 v31, s50, v6
    v_and_b32 v32, s50, v6
    v_and_b32 v33, s50, v6
    v_and_b32 v34, s50, v6
    v_and_b32 v35, s50, v6
    v_and_b32 v36, s50, v6
    buffer_load_dwordx4 a[100:103], v5, s[24:27], s63 offen offset:1024 sc1
    v_and_b32 v37, s50, v6
    v_and_b32 v38, s50, v6
    v_and_b32 v39, s50, v6
    s_cmp_ge_u32 s47, 2
    s_cselect_b32 s50, -1, 0
    v_and_b32 v40, s50, v6
    v_and_b32 v41, s50, v6
    v_and_b32 v42, s50, v6
    v_and_b32 v43, s50, v6
    v_and_b32 v44, s50, v6
    buffer_load_dwordx4 a[164:167], v5, s[24:27], s22 offen offset:1024 sc1
    v_and_b32 v45, s50, v6
    v_and_b32 v46, s50, v6
    v_and_b32 v47, s50, v6
    v_and_b32 v48, s50, v6
    v_and_b32 v49, s50, v6
    v_and_b32 v50, s50, v6
    v_and_b32 v51, s50, v6
    v_and_b32 v52, s50, v6
    v_and_b32 v53, s50, v6
    v_and_b32 v54, s50, v6
    buffer_load_dwordx4 a[36:39], v5, s[24:27], s62 offen offset:1024 sc1
    v_and_b32 v55, s50, v6
    s_cmp_ge_u32 s47, 1
    s_cselect_b32 s50, -1, 0
    v_and_b32 v56, s50, v6
    v_and_b32 v57, s50, v6
    v_and_b32 v58, s50, v6
    v_and_b32 v59, s50, v6
    v_and_b32 v60, s50, v6
    v_and_b32 v61, s50, v6
    v_and_b32 v62, s50, v6
    buffer_load_dwordx4 a[104:107], v5, s[24:27], s63 offen offset:2048 sc1
    v_and_b32 v63, s50, v6
    v_and_b32 v64, s50, v6
    v_and_b32 v65, s50, v6
    v_and_b32 v66, s50, v6
    v_and_b32 v67, s50, v6
    v_and_b32 v68, s50, v6
    v_and_b32 v69, s50, v6
    v_and_b32 v70, s50, v6
    v_and_b32 v71, s50, v6
    v_mov_b32 v72, v6
    buffer_load_dwordx4 a[168:171], v5, s[24:27], s22 offen offset:2048 sc1
    v_mov_b32 v73, v6
    v_mov_b32 v74, v6
    v_mov_b32 v75, v6
    v_mov_b32 v76, v6
    v_mov_b32 v77, v6
    v_mov_b32 v78, v6
    v_mov_b32 v79, v6
    v_mov_b32 v80, v6
    v_mov_b32 v81, v6
    v_mov_b32 v82, v6
    buffer_load_dwordx4 a[40:43], v5, s[24:27], s62 offen offset:2048 sc1
    v_mov_b32 v83, v6
    v_mov_b32 v84, v6
    v_mov_b32 v85, v6
    v_mov_b32 v86, v6
    v_mov_b32 v87, v6
    v_lshrrev_b32 v248, 3, v1
    v_mul_u32_u24 v6, 4224, v248
    v_bfe_u32 v248, v1, 1, 2
    v_bfe_u32 v249, v1, 4, 1
    v_xor_b32 v248, v248, v249
    buffer_load_dwordx4 a[108:111], v5, s[24:27], s63 offen offset:3072 sc1
    s_add_u32 s63, s63, 4096
    s_and_b32 s54, s46, 1
    s_lshl_b32 s54, s54, 1
    v_xor_b32 v248, s54, v248
    v_lshl_add_u32 v6, v248, 5, v6
    v_and_b32 v248, 1, v1
    v_lshl_add_u32 v6, v248, 4, v6
    s_lshl_b32 s55, s48, 2
    s_add_u32 s55, s55, s46
    s_lshl_b32 s54, s47, 7
    s_add_u32 s54, s54, 5767168
    s_add_u32 s50, s55, 0
    s_and_b32 s50, s50, 15
    s_lshl_b32 s50, s50, 10
    v_add_u32 v240, s50, v5
    buffer_load_dwordx4 a[172:175], v5, s[24:27], s22 offen offset:3072 sc1
    s_add_u32 s22, s22, 4096
    s_add_u32 s51, s55, 4
    s_and_b32 s51, s51, 15
    s_lshl_b32 s51, s51, 10
    v_add_u32 v241, s51, v5
    s_add_u32 s52, s55, 8
    s_and_b32 s52, s52, 15
    s_lshl_b32 s52, s52, 10
    v_add_u32 v242, s52, v5
    s_add_u32 s53, s55, 12
    s_and_b32 s53, s53, 15
    s_lshl_b32 s53, s53, 10
    v_add_u32 v243, s53, v5
    buffer_load_dwordx4 a[44:47], v5, s[24:27], s62 offen offset:3072 sc1
    s_add_u32 s62, s62, 4096
    v_lshrrev_b32 v248, 2, v2
    v_lshl_add_u32 v249, v3, 3, v248
    v_lshlrev_b32 v244, 7, v249
    v_lshrrev_b32 v248, 1, v248
    v_and_b32 v249, 1, v3
    v_lshl_or_b32 v248, v249, 1, v248
    v_lshl_add_u32 v244, v248, 5, v244
    v_and_b32 v248, 3, v0
    v_lshl_add_u32 v244, v248, 3, v244
    v_xor_b32 v245, 32, v244
    buffer_load_dwordx4 a[112:115], v5, s[24:27], s63 offen offset:0 sc1
    v_xor_b32 v246, 64, v244
    v_xor_b32 v247, 96, v244
    s_lshl_b32 s55, s46, 5
    v_xor_b32 v7, s55, v244
    v_cmp_gt_u32 vcc, 16, v1
    v_mov_b32 v138, 0xffff0000
    s_nop 0
    v_cndmask_b32 v138, -1, v138, vcc
    v_and_b32 v248, 3, v1
    v_cmp_eq_u32 s[10:11], 1, v248
    v_cmp_eq_u32 s[12:13], 2, v248
    v_cmp_eq_u32 s[14:15], 3, v248
    s_add_u32 s32, s20, 18874368
    s_addc_u32 s33, s21, 0
    s_mov_b32 s34, 4194304
    s_mov_b32 s35, 0x20000
    s_waitcnt vmcnt(19)
    s_barrier
    s_cmp_lg_u32 s46, 0
    s_cbranch_scc1 L_nof2
    s_lshl_b32 s59, s2, 6
    s_add_u32 s59, s59, 16384
    v_mov_b32 v136, s49
    v_lshlrev_b32 v137, 2, v2
    s_mov_b64 exec, 0xffff
    buffer_store_dword v136, v137, s[24:27], s59 offen sc1
    s_mov_b64 exec, -1
L_nof2:
    s_waitcnt vmcnt(13)
    s_barrier
    s_mul_i32 s55, s50, 33
    s_add_u32 m0, s50, 0
    s_add_u32 s55, s55, s54
    s_add_u32 s55, s55, 0
    buffer_load_dwordx4 v6, s[24:27], s55 offen sc1 lds
    s_mul_i32 s55, s51, 33
    s_add_u32 m0, s51, 0
    s_add_u32 s55, s55, s54
    s_add_u32 s55, s55, 0
    buffer_load_dwordx4 v6, s[24:27], s55 offen sc1 lds
    s_mul_i32 s55, s52, 33
    s_add_u32 m0, s52, 0
    s_add_u32 s55, s55, s54
    s_add_u32 s55, s55, 0
    buffer_load_dwordx4 v6, s[24:27], s55 offen sc1 lds
    s_mul_i32 s55, s53, 33
    s_add_u32 m0, s53, 0
    s_add_u32 s55, s55, s54
    s_add_u32 s55, s55, 0
    buffer_load_dwordx4 v6, s[24:27], s55 offen sc1 lds
    s_mul_i32 s55, s50, 33
    s_add_u32 m0, s50, 16384
    s_add_u32 s55, s55, s54
    s_add_u32 s55, s55, 540672
    buffer_load_dwordx4 v6, s[24:27], s55 offen sc1 lds
    s_mul_i32 s55, s51, 33
    s_add_u32 m0, s51, 16384
    s_add_u32 s55, s55, s54
    s_add_u32 s55, s55, 540672
    buffer_load_dwordx4 v6, s[24:27], s55 offen sc1 lds
    s_mul_i32 s55, s52, 33
    s_add_u32 m0, s52, 16384
    s_add_u32 s55, s55, s54
    s_add_u32 s55, s55, 540672
    buffer_load_dwordx4 v6, s[24:27], s55 offen sc1 lds
    s_mul_i32 s55, s53, 33
    s_add_u32 m0, s53, 16384
    s_add_u32 s55, s55, s54
    s_add_u32 s55, s55, 540672
    buffer_load_dwordx4 v6, s[24:27], s55 offen sc1 lds
    s_waitcnt vmcnt(4)
    ds_read_b32 v128, v240 offset:0
    ds_read_b32 v129, v241 offset:0
    ds_read_b32 v130, v242 offset:0
    ds_read_b32 v131, v243 offset:0
    s_mul_i32 s55, s50, 33
    s_add_u32 m0, s50, 32768
    s_add_u32 s55, s55, s54
    s_add_u32 s55, s55, 1081344
    buffer_load_dwordx4 v6, s[24:27], s55 offen sc1 lds
    s_mul_i32 s55, s51, 33
    s_add_u32 m0, s51, 32768
    s_add_u32 s55, s55, s54
    s_add_u32 s55, s55, 1081344
    buffer_load_dwordx4 v6, s[24:27], s55 offen sc1 lds
    s_mul_i32 s55, s52, 33
    s_add_u32 m0, s52, 32768
    s_add_u32 s55, s55, s54
    s_add_u32 s55, s55, 1081344
    buffer_load_dwordx4 v6, s[24:27], s55 offen sc1 lds
    s_mul_i32 s55, s53, 33
    s_add_u32 m0, s53, 32768
    s_add_u32 s55, s55, s54
    s_add_u32 s55, s55, 1081344
    buffer_load_dwordx4 v6, s[24:27], s55 offen sc1 lds
    s_waitcnt lgkmcnt(0)
    v_max3_u32 v248, v128, v129, v130
    v_max_u32 v248, v248, v131
    v_cmp_eq_u32 vcc, -1, v248
    s_cbranch_vccnz L_slow_4
L_ok_3:
    s_barrier
    ds_read_b64_tr_b16 v[184:185], v7 offset:0
    ds_read_b64_tr_b16 v[186:187], v7 offset:512
    ds_read_b64_tr_b16 v[152:153], v244 offset:0
    ds_read_b64_tr_b16 v[154:155], v244 offset:512
    ds_read_b64_tr_b16 v[156:157], v245 offset:0
    ds_read_b64_tr_b16 v[158:159], v245 offset:512
    ds_read_b64_tr_b16 v[160:161], v246 offset:0
    ds_read_b64_tr_b16 v[162:163], v246 offset:512
    ds_read_b64_tr_b16 v[164:165], v247 offset:0
    ds_read_b64_tr_b16 v[166:167], v247 offset:512
    s_waitcnt lgkmcnt(0)
    v_and_b32 v184, v138, v184
    v_mfma_f32_16x16x32_bf16 v[192:195], a[64:67], v[152:155], 0
    ds_read_b64_tr_b16 v[168:169], v244 offset:4096
    v_mfma_f32_16x16x32_bf16 v[196:199], a[64:67], v[156:159], 0
    ds_read_b64_tr_b16 v[170:171], v244 offset:4608
    v_mfma_f32_16x16x32_bf16 v[148:151], v[184:187], v[184:187], 0
    ds_read_b64_tr_b16 v[172:173], v245 offset:4096
    s_mul_i32 s55, s50, 33
    s_add_u32 m0, s50, 49152
    s_add_u32 s55, s55, s54
    s_add_u32 s55, s55, 1622016
    buffer_load_dwordx4 v6, s[24:27], s55 offen sc1 lds
    v_mfma_f32_16x16x32_bf16 v[200:203], a[64:67], v[160:163], 0
    ds_read_b64_tr_b16 v[174:175], v245 offset:4608
    v_mfma_f32_16x16x32_bf16 v[204:207], a[64:67], v[164:167], 0
    ds_read_b64_tr_b16 v[176:177], v246 offset:4096
    v_mfma_f32_16x16x32_bf16 v[208:211], v[152:155], a[128:131], 0
    ds_read_b64_tr_b16 v[178:179], v246 offset:4608
    s_mul_i32 s55, s51, 33
    s_add_u32 m0, s51, 49152
    s_add_u32 s55, s55, s54
    s_add_u32 s55, s55, 1622016
    buffer_load_dwordx4 v6, s[24:27], s55 offen sc1 lds
    v_mfma_f32_16x16x32_bf16 v[212:215], v[156:159], a[128:131], 0
    ds_read_b64_tr_b16 v[180:181], v247 offset:4096
    v_mfma_f32_16x16x32_bf16 v[216:219], v[160:163], a[128:131], 0
    ds_read_b64_tr_b16 v[182:183], v247 offset:4608
    s_mul_i32 s55, s52, 33
    s_add_u32 m0, s52, 49152
    s_add_u32 s55, s55, s54
    s_add_u32 s55, s55, 1622016
    buffer_load_dwordx4 v6, s[24:27], s55 offen sc1 lds
    v_mfma_f32_16x16x32_bf16 v[220:223], v[164:167], a[128:131], 0
    ds_read_b64_tr_b16 v[188:189], v7 offset:4096
    v_mfma_f32_16x16x32_bf16 v[224:227], a[0:3], v[152:155], 0
    ds_read_b64_tr_b16 v[190:191], v7 offset:4608
    v_mfma_f32_16x16x32_bf16 v[228:231], a[0:3], v[156:159], 0
    s_mul_i32 s55, s53, 33
    s_add_u32 m0, s53, 49152
    s_add_u32 s55, s55, s54
    s_add_u32 s55, s55, 1622016
    buffer_load_dwordx4 v6, s[24:27], s55 offen sc1 lds
    v_mfma_f32_16x16x32_bf16 v[232:235], a[0:3], v[160:163], 0
    v_mfma_f32_16x16x32_bf16 v[236:239], a[0:3], v[164:167], 0
    s_waitcnt lgkmcnt(0)
    v_mfma_f32_16x16x32_bf16 v[192:195], a[68:71], v[168:171], v[192:195]
    ds_read_b64_tr_b16 v[152:153], v244 offset:8192
    v_mfma_f32_16x16x32_bf16 v[196:199], a[68:71], v[172:175], v[196:199]
    ds_read_b64_tr_b16 v[154:155], v244 offset:8704
    v_mfma_f32_16x16x32_bf16 v[148:151], v[188:191], v[188:191], v[148:151]
    ds_read_b64_tr_b16 v[156:157], v245 offset:8192
    v_mfma_f32_16x16x32_bf16 v[200:203], a[68:71], v[176:179], v[200:203]
    ds_read_b64_tr_b16 v[158:159], v245 offset:8704
    v_mfma_f32_16x16x32_bf16 v[204:207], a[68:71], v[180:183], v[204:207]
    ds_read_b64_tr_b16 v[160:161], v246 offset:8192
    buffer_load_dwordx4 a[176:179], v5, s[24:27], s22 offen offset:0 sc1
    v_mfma_f32_16x16x32_bf16 v[208:211], v[168:171], a[132:135], v[208:211]
    ds_read_b64_tr_b16 v[162:163], v246 offset:8704
    v_mfma_f32_16x16x32_bf16 v[212:215], v[172:175], a[132:135], v[212:215]
    ds_read_b64_tr_b16 v[164:165], v247 offset:8192
    v_mfma_f32_16x16x32_bf16 v[216:219], v[176:179], a[132:135], v[216:219]
    ds_read_b64_tr_b16 v[166:167], v247 offset:8704
    v_mfma_f32_16x16x32_bf16 v[220:223], v[180:183], a[132:135], v[220:223]
    ds_read_b64_tr_b16 v[184:185], v7 offset:8192
    buffer_load_dwordx4 a[48:51], v5, s[24:27], s62 offen offset:0 sc1
    v_mfma_f32_16x16x32_bf16 v[224:227], a[4:7], v[168:171], v[224:227]
    ds_read_b64_tr_b16 v[186:187], v7 offset:8704
    v_mfma_f32_16x16x32_bf16 v[228:231], a[4:7], v[172:175], v[228:231]
    v_mfma_f32_16x16x32_bf16 v[232:235], a[4:7], v[176:179], v[232:235]
    v_mfma_f32_16x16x32_bf16 v[236:239], a[4:7], v[180:183], v[236:239]
    buffer_load_dwordx4 a[116:119], v5, s[24:27], s63 offen offset:1024 sc1
    s_waitcnt lgkmcnt(0)
    v_mfma_f32_16x16x32_bf16 v[192:195], a[72:75], v[152:155], v[192:195]
    ds_read_b64_tr_b16 v[168:169], v244 offset:12288
    v_mfma_f32_16x16x32_bf16 v[196:199], a[72:75], v[156:159], v[196:199]
    ds_read_b64_tr_b16 v[170:171], v244 offset:12800
    v_mfma_f32_16x16x32_bf16 v[148:151], v[184:187], v[184:187], v[148:151]
    ds_read_b64_tr_b16 v[172:173], v245 offset:12288
    v_mfma_f32_16x16x32_bf16 v[200:203], a[72:75], v[160:163], v[200:203]
    ds_read_b64_tr_b16 v[174:175], v245 offset:12800
    buffer_load_dwordx4 a[180:183], v5, s[24:27], s22 offen offset:1024 sc1
    v_mfma_f32_16x16x32_bf16 v[204:207], a[72:75], v[164:167], v[204:207]
    ds_read_b64_tr_b16 v[176:177], v246 offset:12288
    v_mfma_f32_16x16x32_bf16 v[208:211], v[152:155], a[136:139], v[208:211]
    ds_read_b64_tr_b16 v[178:179], v246 offset:12800
    v_mfma_f32_16x16x32_bf16 v[212:215], v[156:159], a[136:139], v[212:215]
    ds_read_b64_tr_b16 v[180:181], v247 offset:12288
    buffer_load_dwordx4 a[52:55], v5, s[24:27], s62 offen offset:1024 sc1
    v_mfma_f32_16x16x32_bf16 v[216:219], v[160:163], a[136:139], v[216:219]
    ds_read_b64_tr_b16 v[182:183], v247 offset:12800
    v_mfma_f32_16x16x32_bf16 v[220:223], v[164:167], a[136:139], v[220:223]
    ds_read_b64_tr_b16 v[188:189], v7 offset:12288
    v_mfma_f32_16x16x32_bf16 v[224:227], a[8:11], v[152:155], v[224:227]
    ds_read_b64_tr_b16 v[190:191], v7 offset:12800
    buffer_load_dwordx4 a[120:123], v5, s[24:27], s63 offen offset:2048 sc1
    v_mfma_f32_16x16x32_bf16 v[228:231], a[8:11], v[156:159], v[228:231]
    v_mfma_f32_16x16x32_bf16 v[232:235], a[8:11], v[160:163], v[232:235]
    v_mfma_f32_16x16x32_bf16 v[236:239], a[8:11], v[164:167], v[236:239]
    s_waitcnt vmcnt(14)
    ds_read_b32 v132, v240 offset:16384
    ds_read_b32 v133, v241 offset:16384
    ds_read_b32 v134, v242 offset:16384
    ds_read_b32 v135, v243 offset:16384
    s_waitcnt lgkmcnt(0)
    v_max3_u32 v248, v132, v133, v134
    v_max_u32 v248, v248, v135
    v_cmp_eq_u32 vcc, -1, v248
    s_cbranch_vccnz L_slow_6
L_ok_5:
    s_barrier
    v_mfma_f32_16x16x32_bf16 v[192:195], a[76:79], v[168:171], v[192:195]
    ds_read_b64_tr_b16 v[152:153], v244 offset:16384
    v_mfma_f32_16x16x32_bf16 v[196:199], a[76:79], v[172:175], v[196:199]
    ds_read_b64_tr_b16 v[154:155], v244 offset:16896
    v_mfma_f32_16x16x32_bf16 v[148:151], v[188:191], v[188:191], v[148:151]
    ds_read_b64_tr_b16 v[156:157], v245 offset:16384
    v_mfma_f32_16x16x32_bf16 v[200:203], a[76:79], v[176:179], v[200:203]
    ds_read_b64_tr_b16 v[158:159], v245 offset:16896
    v_mfma_f32_16x16x32_bf16 v[204:207], a[76:79], v[180:183], v[204:207]
    ds_read_b64_tr_b16 v[160:161], v246 offset:16384
    buffer_load_dwordx4 a[184:187], v5, s[24:27], s22 offen offset:2048 sc1
    v_mfma_f32_16x16x32_bf16 v[208:211], v[168:171], a[140:143], v[208:211]
    ds_read_b64_tr_b16 v[162:163], v246 offset:16896
    v_mfma_f32_16x16x32_bf16 v[212:215], v[172:175], a[140:143], v[212:215]
    ds_read_b64_tr_b16 v[164:165], v247 offset:16384
    v_mfma_f32_16x16x32_bf16 v[216:219], v[176:179], a[140:143], v[216:219]
    ds_read_b64_tr_b16 v[166:167], v247 offset:16896
    v_mfma_f32_16x16x32_bf16 v[220:223], v[180:183], a[140:143], v[220:223]
    ds_read_b64_tr_b16 v[184:185], v7 offset:16384
    buffer_load_dwordx4 a[56:59], v5, s[24:27], s62 offen offset:2048 sc1
    v_mfma_f32_16x16x32_bf16 v[224:227], a[12:15], v[168:171], v[224:227]
    ds_read_b64_tr_b16 v[186:187], v7 offset:16896
    v_mfma_f32_16x16x32_bf16 v[228:231], a[12:15], v[172:175], v[228:231]
    v_mfma_f32_16x16x32_bf16 v[232:235], a[12:15], v[176:179], v[232:235]
    v_mfma_f32_16x16x32_bf16 v[236:239], a[12:15], v[180:183], v[236:239]
    buffer_load_dwordx4 a[124:127], v5, s[24:27], s63 offen offset:3072 sc1
    s_add_u32 s63, s63, 4096
    s_waitcnt lgkmcnt(0)
    v_mfma_f32_16x16x32_bf16 v[192:195], a[80:83], v[152:155], v[192:195]
    ds_read_b64_tr_b16 v[168:169], v244 offset:20480
    ds_read_b64_tr_b16 v[170:171], v244 offset:20992
    v_mfma_f32_16x16x32_bf16 v[196:199], a[80:83], v[156:159], v[196:199]
    ds_read_b64_tr_b16 v[172:173], v245 offset:20480
    v_mfma_f32_16x16x32_bf16 v[148:151], v[184:187], v[184:187], v[148:151]
    ds_read_b64_tr_b16 v[174:175], v245 offset:20992
    ds_read_b64_tr_b16 v[176:177], v246 offset:20480
    buffer_load_dwordx4 a[188:191], v5, s[24:27], s22 offen offset:3072 sc1
    s_add_u32 s22, s22, 4096
    v_mfma_f32_16x16x32_bf16 v[200:203], a[80:83], v[160:163], v[200:203]
    ds_read_b64_tr_b16 v[178:179], v246 offset:20992
    v_mfma_f32_16x16x32_bf16 v[204:207], a[80:83], v[164:167], v[204:207]
    ds_read_b64_tr_b16 v[180:181], v247 offset:20480
    ds_read_b64_tr_b16 v[182:183], v247 offset:20992
    v_mfma_f32_16x16x32_bf16 v[208:211], v[152:155], a[144:147], v[208:211]
    ds_read_b64_tr_b16 v[188:189], v7 offset:20480
    buffer_load_dwordx4 a[60:63], v5, s[24:27], s62 offen offset:3072 sc1
    s_add_u32 s62, s62, 4096
    v_mfma_f32_16x16x32_bf16 v[212:215], v[156:159], a[144:147], v[212:215]
    ds_read_b64_tr_b16 v[190:191], v7 offset:20992
    v_mfma_f32_16x16x32_bf16 v[216:219], v[160:163], a[144:147], v[216:219]
    v_mfma_f32_16x16x32_bf16 v[220:223], v[164:167], a[144:147], v[220:223]
    s_mul_i32 s23, s2, 8448
    s_add_u32 s23, s23, 10485760
    buffer_store_dwordx4 v[252:255], v4, s[24:27], s23 offen sc1
    s_waitcnt lgkmcnt(0)
    v_mfma_f32_16x16x32_bf16 v[192:195], a[84:87], v[168:171], v[192:195]
    ds_read_b64_tr_b16 v[152:153], v244 offset:24576
    ds_read_b64_tr_b16 v[154:155], v244 offset:25088
    v_mfma_f32_16x16x32_bf16 v[196:199], a[84:87], v[172:175], v[196:199]
    ds_read_b64_tr_b16 v[156:157], v245 offset:24576
    v_mfma_f32_16x16x32_bf16 v[148:151], v[188:191], v[188:191], v[148:151]
    ds_read_b64_tr_b16 v[158:159], v245 offset:25088
    ds_read_b64_tr_b16 v[160:161], v246 offset:24576
    v_mfma_f32_16x16x32_bf16 v[200:203], a[84:87], v[176:179], v[200:203]
    ds_read_b64_tr_b16 v[162:163], v246 offset:25088
    v_mfma_f32_16x16x32_bf16 v[204:207], a[84:87], v[180:183], v[204:207]
    ds_read_b64_tr_b16 v[164:165], v247 offset:24576
    ds_read_b64_tr_b16 v[166:167], v247 offset:25088
    v_mfma_f32_16x16x32_bf16 v[208:211], v[168:171], a[148:151], v[208:211]
    ds_read_b64_tr_b16 v[184:185], v7 offset:24576
    v_mfma_f32_16x16x32_bf16 v[212:215], v[172:175], a[148:151], v[212:215]
    ds_read_b64_tr_b16 v[186:187], v7 offset:25088
    v_mfma_f32_16x16x32_bf16 v[216:219], v[176:179], a[148:151], v[216:219]
    v_mfma_f32_16x16x32_bf16 v[220:223], v[180:183], a[148:151], v[220:223]
    s_mul_i32 s23, s2, 8448
    s_add_u32 s23, s23, 10489984
    buffer_store_dwordx4 v[252:255], v4, s[24:27], s23 offen sc1
    s_waitcnt lgkmcnt(0)
    v_mfma_f32_16x16x32_bf16 v[192:195], a[88:91], v[152:155], v[192:195]
    ds_read_b64_tr_b16 v[168:169], v244 offset:28672
    ds_read_b64_tr_b16 v[170:171], v244 offset:29184
    v_mfma_f32_16x16x32_bf16 v[196:199], a[88:91], v[156:159], v[196:199]
    ds_read_b64_tr_b16 v[172:173], v245 offset:28672
    v_mfma_f32_16x16x32_bf16 v[148:151], v[184:187], v[184:187], v[148:151]
    ds_read_b64_tr_b16 v[174:175], v245 offset:29184
    ds_read_b64_tr_b16 v[176:177], v246 offset:28672
    v_mfma_f32_16x16x32_bf16 v[200:203], a[88:91], v[160:163], v[200:203]
    ds_read_b64_tr_b16 v[178:179], v246 offset:29184
    v_mfma_f32_16x16x32_bf16 v[204:207], a[88:91], v[164:167], v[204:207]
    ds_read_b64_tr_b16 v[180:181], v247 offset:28672
    ds_read_b64_tr_b16 v[182:183], v247 offset:29184
    s_waitcnt vmcnt(17)
    ds_read_b32 v128, v240 offset:32768
    ds_read_b32 v129, v241 offset:32768
    ds_read_b32 v130, v242 offset:32768
    ds_read_b32 v131, v243 offset:32768
    v_mfma_f32_16x16x32_bf16 v[208:211], v[152:155], a[152:155], v[208:211]
    ds_read_b64_tr_b16 v[188:189], v7 offset:28672
    v_mfma_f32_16x16x32_bf16 v[212:215], v[156:159], a[152:155], v[212:215]
    ds_read_b64_tr_b16 v[190:191], v7 offset:29184
    v_mfma_f32_16x16x32_bf16 v[216:219], v[160:163], a[152:155], v[216:219]
    v_mfma_f32_16x16x32_bf16 v[220:223], v[164:167], a[152:155], v[220:223]
    s_mul_i32 s23, s2, 24576
    s_add_u32 s23, s23, 23068672
    buffer_store_dwordx4 v[252:255], v4, s[24:27], s23 offen sc1
    s_waitcnt lgkmcnt(0)
    v_max3_u32 v248, v128, v129, v130
    v_max_u32 v248, v248, v131
    v_cmp_eq_u32 vcc, -1, v248
    s_cbranch_vccnz L_slow_8
L_ok_7:
    s_barrier
    v_mfma_f32_16x16x32_bf16 v[192:195], a[92:95], v[168:171], v[192:195]
    ds_read_b64_tr_b16 v[152:153], v244 offset:32768
    ds_read_b64_tr_b16 v[154:155], v244 offset:33280
    v_mfma_f32_16x16x32_bf16 v[196:199], a[92:95], v[172:175], v[196:199]
    ds_read_b64_tr_b16 v[156:157], v245 offset:32768
    v_mfma_f32_16x16x32_bf16 v[148:151], v[188:191], v[188:191], v[148:151]
    ds_read_b64_tr_b16 v[158:159], v245 offset:33280
    ds_read_b64_tr_b16 v[160:161], v246 offset:32768
    v_mfma_f32_16x16x32_bf16 v[200:203], a[92:95], v[176:179], v[200:203]
    ds_read_b64_tr_b16 v[162:163], v246 offset:33280
    v_mfma_f32_16x16x32_bf16 v[204:207], a[92:95], v[180:183], v[204:207]
    ds_read_b64_tr_b16 v[164:165], v247 offset:32768
    ds_read_b64_tr_b16 v[166:167], v247 offset:33280
    v_mfma_f32_16x16x32_bf16 v[208:211], v[168:171], a[156:159], v[208:211]
    ds_read_b64_tr_b16 v[184:185], v7 offset:32768
    v_mfma_f32_16x16x32_bf16 v[212:215], v[172:175], a[156:159], v[212:215]
    ds_read_b64_tr_b16 v[186:187], v7 offset:33280
    v_mfma_f32_16x16x32_bf16 v[216:219], v[176:179], a[156:159], v[216:219]
    v_mfma_f32_16x16x32_bf16 v[220:223], v[180:183], a[156:159], v[220:223]
    s_mul_i32 s23, s2, 24576
    s_add_u32 s23, s23, 23072768
    buffer_store_dwordx4 v[252:255], v4, s[24:27], s23 offen sc1
    s_waitcnt lgkmcnt(0)
    v_mfma_f32_16x16x32_bf16 v[192:195], a[96:99], v[152:155], v[192:195]
    ds_read_b64_tr_b16 v[168:169], v244 offset:36864
    ds_read_b64_tr_b16 v[170:171], v244 offset:37376
    v_mfma_f32_16x16x32_bf16 v[196:199], a[96:99], v[156:159], v[196:199]
    ds_read_b64_tr_b16 v[172:173], v245 offset:36864
    v_mfma_f32_16x16x32_bf16 v[148:151], v[184:187], v[184:187], v[148:151]
    ds_read_b64_tr_b16 v[174:175], v245 offset:37376
    ds_read_b64_tr_b16 v[176:177], v246 offset:36864
    v_mfma_f32_16x16x32_bf16 v[200:203], a[96:99], v[160:163], v[200:203]
    ds_read_b64_tr_b16 v[178:179], v246 offset:37376
    v_mfma_f32_16x16x32_bf16 v[204:207], a[96:99], v[164:167], v[204:207]
    ds_read_b64_tr_b16 v[180:181], v247 offset:36864
    ds_read_b64_tr_b16 v[182:183], v247 offset:37376
    v_mfma_f32_16x16x32_bf16 v[208:211], v[152:155], a[160:163], v[208:211]
    ds_read_b64_tr_b16 v[188:189], v7 offset:36864
    v_mfma_f32_16x16x32_bf16 v[212:215], v[156:159], a[160:163], v[212:215]
    ds_read_b64_tr_b16 v[190:191], v7 offset:37376
    v_mfma_f32_16x16x32_bf16 v[216:219], v[160:163], a[160:163], v[216:219]
    v_mfma_f32_16x16x32_bf16 v[220:223], v[164:167], a[160:163], v[220:223]
    s_mul_i32 s23, s2, 24576
    s_add_u32 s23, s23, 23076864
    buffer_store_dwordx4 v[252:255], v4, s[24:27], s23 offen sc1
    s_waitcnt lgkmcnt(0)
    v_mfma_f32_16x16x32_bf16 v[192:195], a[100:103], v[168:171], v[192:195]
    ds_read_b64_tr_b16 v[152:153], v244 offset:40960
    ds_read_b64_tr_b16 v[154:155], v244 offset:41472
    v_mfma_f32_16x16x32_bf16 v[196:199], a[100:103], v[172:175], v[196:199]
    ds_read_b64_tr_b16 v[156:157], v245 offset:40960
    v_mfma_f32_16x16x32_bf16 v[148:151], v[188:191], v[188:191], v[148:151]
    ds_read_b64_tr_b16 v[158:159], v245 offset:41472
    ds_read_b64_tr_b16 v[160:161], v246 offset:40960
    v_mfma_f32_16x16x32_bf16 v[200:203], a[100:103], v[176:179], v[200:203]
    ds_read_b64_tr_b16 v[162:163], v246 offset:41472
    v_mfma_f32_16x16x32_bf16 v[204:207], a[100:103], v[180:183], v[204:207]
    ds_read_b64_tr_b16 v[164:165], v247 offset:40960
    ds_read_b64_tr_b16 v[166:167], v247 offset:41472
    v_mfma_f32_16x16x32_bf16 v[208:211], v[168:171], a[164:167], v[208:211]
    ds_read_b64_tr_b16 v[184:185], v7 offset:40960
    v_mfma_f32_16x16x32_bf16 v[212:215], v[172:175], a[164:167], v[212:215]
    ds_read_b64_tr_b16 v[186:187], v7 offset:41472
    v_mfma_f32_16x16x32_bf16 v[216:219], v[176:179], a[164:167], v[216:219]
    v_mfma_f32_16x16x32_bf16 v[220:223], v[180:183], a[164:167], v[220:223]
    s_waitcnt lgkmcnt(0)
    v_mfma_f32_16x16x32_bf16 v[192:195], a[104:107], v[152:155], v[192:195]
    ds_read_b64_tr_b16 v[168:169], v244 offset:45056
    ds_read_b64_tr_b16 v[170:171], v244 offset:45568
    v_mfma_f32_16x16x32_bf16 v[196:199], a[104:107], v[156:159], v[196:199]
    ds_read_b64_tr_b16 v[172:173], v245 offset:45056
    v_mfma_f32_16x16x32_bf16 v[148:151], v[184:187], v[184:187], v[148:151]
    ds_read_b64_tr_b16 v[174:175], v245 offset:45568
    ds_read_b64_tr_b16 v[176:177], v246 offset:45056
    v_mfma_f32_16x16x32_bf16 v[200:203], a[104:107], v[160:163], v[200:203]
    ds_read_b64_tr_b16 v[178:179], v246 offset:45568
    v_mfma_f32_16x16x32_bf16 v[204:207], a[104:107], v[164:167], v[204:207]
    ds_read_b64_tr_b16 v[180:181], v247 offset:45056
    ds_read_b64_tr_b16 v[182:183], v247 offset:45568
    v_mfma_f32_16x16x32_bf16 v[208:211], v[152:155], a[168:171], v[208:211]
    ds_read_b64_tr_b16 v[188:189], v7 offset:45056
    v_mfma_f32_16x16x32_bf16 v[212:215], v[156:159], a[168:171], v[212:215]
    ds_read_b64_tr_b16 v[190:191], v7 offset:45568
    v_mfma_f32_16x16x32_bf16 v[216:219], v[160:163], a[168:171], v[216:219]
    v_mfma_f32_16x16x32_bf16 v[220:223], v[164:167], a[168:171], v[220:223]
    s_waitcnt vmcnt(16)
    ds_read_b32 v132, v240 offset:49152
    ds_read_b32 v133, v241 offset:49152
    ds_read_b32 v134, v242 offset:49152
    ds_read_b32 v135, v243 offset:49152
    s_waitcnt lgkmcnt(0)
    v_max3_u32 v248, v132, v133, v134
    v_max_u32 v248, v248, v135
    v_cmp_eq_u32 vcc, -1, v248
    s_cbranch_vccnz L_slow_10
L_ok_9:
    s_barrier
    v_mfma_f32_16x16x32_bf16 v[192:195], a[108:111], v[168:171], v[192:195]
    ds_read_b64_tr_b16 v[88:89], v244 offset:49152
    ds_read_b64_tr_b16 v[90:91], v244 offset:49664
    ds_read_b64_tr_b16 v[92:93], v245 offset:49152
    v_mfma_f32_16x16x32_bf16 v[196:199], a[108:111], v[172:175], v[196:199]
    ds_read_b64_tr_b16 v[94:95], v245 offset:49664
    ds_read_b64_tr_b16 v[96:97], v246 offset:49152
    v_mfma_f32_16x16x32_bf16 v[148:151], v[188:191], v[188:191], v[148:151]
    ds_read_b64_tr_b16 v[98:99], v246 offset:49664
    ds_read_b64_tr_b16 v[100:101], v247 offset:49152
    v_mfma_f32_16x16x32_bf16 v[200:203], a[108:111], v[176:179], v[200:203]
    ds_read_b64_tr_b16 v[102:103], v247 offset:49664
    ds_read_b64_tr_b16 v[104:105], v7 offset:49152
    ds_read_b64_tr_b16 v[106:107], v7 offset:49664
    v_mfma_f32_16x16x32_bf16 v[204:207], a[108:111], v[180:183], v[204:207]
    ds_read_b64_tr_b16 v[108:109], v7 offset:53248
    ds_read_b64_tr_b16 v[110:111], v7 offset:53760
    v_mfma_f32_16x16x32_bf16 v[208:211], v[168:171], a[172:175], v[208:211]
    ds_read_b64_tr_b16 v[112:113], v7 offset:57344
    ds_read_b64_tr_b16 v[114:115], v7 offset:57856
    v_mfma_f32_16x16x32_bf16 v[212:215], v[172:175], a[172:175], v[212:215]
    ds_read_b64_tr_b16 v[116:117], v7 offset:61440
    ds_read_b64_tr_b16 v[118:119], v7 offset:61952
    v_mfma_f32_16x16x32_bf16 v[216:219], v[176:179], a[172:175], v[216:219]
    v_mfma_f32_16x16x32_bf16 v[220:223], v[180:183], a[172:175], v[220:223]
    v_lshlrev_b32 v137, 6, v0
    s_movk_i32 s55, 16384
    buffer_load_dword v136, v137, s[24:27], s55 offen sc1
    s_waitcnt vmcnt(15)
    s_waitcnt lgkmcnt(0)
    v_mfma_f32_16x16x32_bf16 v[148:151], v[104:107], v[104:107], v[148:151]
    ds_read_b64_tr_b16 v[120:121], v244 offset:53248
    v_mfma_f32_16x16x32_bf16 v[192:195], a[112:115], v[88:91], v[192:195]
    ds_read_b64_tr_b16 v[122:123], v244 offset:53760
    v_mfma_f32_16x16x32_bf16 v[148:151], v[108:111], v[108:111], v[148:151]
    ds_read_b64_tr_b16 v[124:125], v245 offset:53248
    v_mfma_f32_16x16x32_bf16 v[196:199], a[112:115], v[92:95], v[196:199]
    ds_read_b64_tr_b16 v[126:127], v245 offset:53760
    v_mfma_f32_16x16x32_bf16 v[148:151], v[112:115], v[112:115], v[148:151]
    v_mfma_f32_16x16x32_bf16 v[200:203], a[112:115], v[96:99], v[200:203]
    ds_read_b64_tr_b16 v[128:129], v246 offset:53248
    v_mfma_f32_16x16x32_bf16 v[148:151], v[116:119], v[116:119], v[148:151]
    ds_read_b64_tr_b16 v[130:131], v246 offset:53760
    v_mfma_f32_16x16x32_bf16 v[204:207], a[112:115], v[100:103], v[204:207]
    ds_read_b64_tr_b16 v[132:133], v247 offset:53248
    v_mfma_f32_16x16x32_bf16 v[208:211], v[88:91], a[176:179], v[208:211]
    ds_read_b64_tr_b16 v[134:135], v247 offset:53760
    v_mfma_f32_16x16x32_bf16 v[212:215], v[92:95], a[176:179], v[212:215]
    v_mfma_f32_16x16x32_bf16 v[216:219], v[96:99], a[176:179], v[216:219]
    v_mfma_f32_16x16x32_bf16 v[220:223], v[100:103], a[176:179], v[220:223]
    s_mul_i32 s23, s2, 24576
    s_add_u32 s23, s23, 23080960
    buffer_store_dwordx4 v[252:255], v4, s[24:27], s23 offen sc1
    s_waitcnt vmcnt(13)
    s_waitcnt lgkmcnt(0)
    v_mfma_f32_16x16x32_bf16 v[192:195], a[116:119], v[120:123], v[192:195]
    ds_read_b64_tr_b16 v[152:153], v244 offset:57344
    ds_read_b64_tr_b16 v[154:155], v244 offset:57856
    s_mul_i32 s23, s2, 24576
    s_add_u32 s23, s23, 23085056
    buffer_store_dwordx4 v[252:255], v4, s[24:27], s23 offen sc1
    v_mfma_f32_16x16x32_bf16 v[196:199], a[116:119], v[124:127], v[196:199]
    ds_read_b64_tr_b16 v[156:157], v245 offset:57344
    v_cndmask_b32 v248, v148, v149, s[10:11]
    v_cndmask_b32 v248, v248, v150, s[12:13]
    v_mfma_f32_16x16x32_bf16 v[200:203], a[116:119], v[128:131], v[200:203]
    ds_read_b64_tr_b16 v[158:159], v245 offset:57856
    v_cndmask_b32 v248, v248, v151, s[14:15]
    v_mov_b32 v249, 0x3727c5ac
    v_mfma_f32_16x16x32_bf16 v[204:207], a[116:119], v[132:135], v[204:207]
    ds_read_b64_tr_b16 v[160:161], v246 offset:57344
    ds_read_b64_tr_b16 v[162:163], v246 offset:57856
    v_fmac_f32 v249, 0x3b000000, v248
    s_lshl_b32 s55, s46, 6
    s_add_u32 s55, s55, 152576
    v_mfma_f32_16x16x32_bf16 v[208:211], v[120:123], a[180:183], v[208:211]
    ds_read_b64_tr_b16 v[164:165], v247 offset:57344
    v_rsq_f32 v249, v249
    v_lshl_add_u32 v248, v2, 2, s55
    s_mov_b32 s60, 0x00f0000f
    s_mov_b32 s61, 0xf0000f00
    v_mfma_f32_16x16x32_bf16 v[212:215], v[124:127], a[180:183], v[212:215]
    ds_read_b64_tr_b16 v[166:167], v247 offset:57856
    s_mov_b64 exec, s[60:61]
    ds_write_b32 v248, v249
    s_mov_b64 exec, -1
    v_mfma_f32_16x16x32_bf16 v[216:219], v[128:131], a[180:183], v[216:219]
    v_lshlrev_b32 v248, 2, v2
    v_lshlrev_b32 v249, 4, v3
    v_mfma_f32_16x16x32_bf16 v[220:223], v[132:135], a[180:183], v[220:223]
    v_add_u32 v248, 152576, v248
    v_add_u32 v249, 152576, v249
    s_waitcnt vmcnt(11)
    s_waitcnt lgkmcnt(0)
    s_waitcnt vmcnt(2)
    v_cmp_ne_u32 vcc, s49, v136
    s_cbranch_vccnz L_f2_slow
L_f2_ok:
    s_barrier
    v_mfma_f32_16x16x32_bf16 v[192:195], a[120:123], v[152:155], v[192:195]
    ds_read_b64_tr_b16 v[168:169], v244 offset:61440
    ds_read_b64_tr_b16 v[170:171], v244 offset:61952
    ds_read_b64_tr_b16 v[172:173], v245 offset:61440
    v_mfma_f32_16x16x32_bf16 v[196:199], a[120:123], v[156:159], v[196:199]
    ds_read_b64_tr_b16 v[174:175], v245 offset:61952
    ds_read_b64_tr_b16 v[176:177], v246 offset:61440
    ds_read_b64_tr_b16 v[178:179], v246 offset:61952
    v_mfma_f32_16x16x32_bf16 v[200:203], a[120:123], v[160:163], v[200:203]
    ds_read_b64_tr_b16 v[180:181], v247 offset:61440
    ds_read_b64_tr_b16 v[182:183], v247 offset:61952
    v_mfma_f32_16x16x32_bf16 v[204:207], a[120:123], v[164:167], v[204:207]
    ds_read_b32 v184, v248 offset:0
    ds_read_b32 v185, v248 offset:64
    ds_read_b32 v186, v248 offset:128
    v_mfma_f32_16x16x32_bf16 v[208:211], v[152:155], a[184:187], v[208:211]
    ds_read_b32 v187, v248 offset:192
    ds_read_b128 v[136:139], v249 offset:0
    ds_read_b128 v[140:143], v249 offset:64
    v_mfma_f32_16x16x32_bf16 v[212:215], v[156:159], a[184:187], v[212:215]
    ds_read_b128 v[144:147], v249 offset:128
    ds_read_b128 v[148:151], v249 offset:192
    v_mfma_f32_16x16x32_bf16 v[216:219], v[160:163], a[184:187], v[216:219]
    v_mfma_f32_16x16x32_bf16 v[220:223], v[164:167], a[184:187], v[220:223]
    s_mul_i32 s23, s2, 24576
    s_add_u32 s23, s23, 23089152
    buffer_store_dwordx4 v[252:255], v4, s[24:27], s23 offen sc1
    s_waitcnt lgkmcnt(0)
    v_mfma_f32_16x16x32_bf16 v[192:195], a[124:127], v[168:171], v[192:195]
    v_mfma_f32_16x16x32_bf16 v[196:199], a[124:127], v[172:175], v[196:199]
    s_lshl_b32 s50, s48, 2
    s_add_u32 s50, s50, s46
    s_lshl_b32 s50, s50, 5
    s_add_u32 s50, s50, s47
    s_lshl_b32 s23, s50, 12
    s_lshl_b32 s51, s46, 11
    s_add_u32 s51, s51, 152832
    v_mfma_f32_16x16x32_bf16 v[200:203], a[124:127], v[176:179], v[200:203]
    v_mfma_f32_16x16x32_bf16 v[204:207], a[124:127], v[180:183], v[204:207]
    v_add_u32 v6, s51, v5
    v_lshrrev_b32 v7, 5, v1
    v_mfma_f32_16x16x32_bf16 v[208:211], v[168:171], a[188:191], v[208:211]
    v_mfma_f32_16x16x32_bf16 v[212:215], v[172:175], a[188:191], v[212:215]
    v_lshlrev_b32 v7, 8, v7
    v_lshl_add_u32 v7, v2, 4, v7
    v_mfma_f32_16x16x32_bf16 v[216:219], v[176:179], a[188:191], v[216:219]
    v_mfma_f32_16x16x32_bf16 v[220:223], v[180:183], a[188:191], v[220:223]
    v_add_u32 v240, s51, v7
    v_mul_f32 v192, v184, v192
    v_mul_f32 v193, v184, v193
    v_mul_f32 v194, v184, v194
    v_mul_f32 v195, v184, v195
    v_mfma_f32_16x16x32_bf16 v[224:227], a[48:51], v[88:91], v[224:227]
    v_cvt_pk_bf16_f32 v104, v192, v193
    v_cvt_pk_bf16_f32 v105, v194, v195
    v_mul_f32 v196, v185, v196
    v_mul_f32 v197, v185, v197
    v_mul_f32 v198, v185, v198
    v_mul_f32 v199, v185, v199
    v_mfma_f32_16x16x32_bf16 v[228:231], a[48:51], v[92:95], v[228:231]
    v_cvt_pk_bf16_f32 v106, v196, v197
    v_cvt_pk_bf16_f32 v107, v198, v199
    v_mul_f32 v200, v186, v200
    v_mul_f32 v201, v186, v201
    v_mul_f32 v202, v186, v202
    v_mul_f32 v203, v186, v203
    v_mfma_f32_16x16x32_bf16 v[232:235], a[48:51], v[96:99], v[232:235]
    v_cvt_pk_bf16_f32 v108, v200, v201
    v_cvt_pk_bf16_f32 v109, v202, v203
    v_mul_f32 v204, v187, v204
    v_mul_f32 v205, v187, v205
    v_mul_f32 v206, v187, v206
    v_mul_f32 v207, v187, v207
    v_mfma_f32_16x16x32_bf16 v[236:239], a[48:51], v[100:103], v[236:239]
    v_cvt_pk_bf16_f32 v110, v204, v205
    v_cvt_pk_bf16_f32 v111, v206, v207
    v_permlane16_swap_b32 v104, v106
    v_permlane16_swap_b32 v105, v107
    v_min_u32 v104, -2, v104
    buffer_store_dwordx4 v[104:107], v5, s[32:35], s23 offen offset:0 sc1
    v_permlane16_swap_b32 v108, v110
    v_permlane16_swap_b32 v109, v111
    v_min_u32 v108, -2, v108
    buffer_store_dwordx4 v[108:111], v5, s[32:35], s23 offen offset:2048 sc1
    v_pk_mul_f32 v[208:209], v[208:209], v[136:137]
    v_pk_mul_f32 v[210:211], v[210:211], v[138:139]
    v_mfma_f32_16x16x32_bf16 v[224:227], a[52:55], v[120:123], v[224:227]
    v_cvt_pk_bf16_f32 v112, v208, v209
    v_cvt_pk_bf16_f32 v113, v210, v211
    v_pk_mul_f32 v[212:213], v[212:213], v[140:141]
    v_pk_mul_f32 v[214:215], v[214:215], v[142:143]
    v_mfma_f32_16x16x32_bf16 v[228:231], a[52:55], v[124:127], v[228:231]
    v_cvt_pk_bf16_f32 v114, v212, v213
    v_cvt_pk_bf16_f32 v115, v214, v215
    v_min_u32 v112, -2, v112
    buffer_store_dwordx4 v[112:115], v5, s[32:35], s23 offen offset:1024 sc1
    v_pk_mul_f32 v[216:217], v[216:217], v[144:145]
    v_pk_mul_f32 v[218:219], v[218:219], v[146:147]
    v_mfma_f32_16x16x32_bf16 v[232:235], a[52:55], v[128:131], v[232:235]
    v_cvt_pk_bf16_f32 v116, v216, v217
    v_cvt_pk_bf16_f32 v117, v218, v219
    v_pk_mul_f32 v[220:221], v[220:221], v[148:149]
    v_pk_mul_f32 v[222:223], v[222:223], v[150:151]
    v_mfma_f32_16x16x32_bf16 v[236:239], a[52:55], v[132:135], v[236:239]
    v_cvt_pk_bf16_f32 v118, v220, v221
    v_cvt_pk_bf16_f32 v119, v222, v223
    v_min_u32 v116, -2, v116
    buffer_store_dwordx4 v[116:119], v5, s[32:35], s23 offen offset:3072 sc1
    ds_write_b128 v6, v[112:115] offset:0
    ds_write_b128 v6, v[116:119] offset:1024
    v_mfma_f32_16x16x32_bf16 v[224:227], a[56:59], v[152:155], v[224:227]
    ds_read_b64_tr_b16 v[192:193], v244 offset:16384
    ds_read_b64_tr_b16 v[194:195], v244 offset:16896
    s_mov_b32 s60, 0x0000ffff
    s_mov_b32 s61, 0x0000ffff
    s_mov_b32 s50, 0xff800000
    v_and_b32 v248, 31, v1
    v_lshrrev_b32 v249, 5, v1
    v_mfma_f32_16x16x32_bf16 v[228:231], a[56:59], v[156:159], v[228:231]
    ds_read_b64_tr_b16 v[196:197], v245 offset:16384
    ds_read_b64_tr_b16 v[198:199], v245 offset:16896
    v_lshlrev_b32 v249, 2, v249
    v_sub_u32 v248, v248, v249
    v_mfma_f32_16x16x32_bf16 v[232:235], a[56:59], v[160:163], v[232:235]
    ds_read_b64_tr_b16 v[200:201], v246 offset:16384
    ds_read_b64_tr_b16 v[202:203], v246 offset:16896
    s_sub_u32 s51, s23, 4096
    s_cmp_ge_u32 s47, 1
    s_cselect_b32 s51, s51, 0x7f000000
    v_add_u32 v253, s51, v5
    v_add_u32 v191, s51, v7
    v_mfma_f32_16x16x32_bf16 v[236:239], a[56:59], v[164:167], v[236:239]
    ds_read_b64_tr_b16 v[204:205], v247 offset:16384
    ds_read_b64_tr_b16 v[206:207], v247 offset:16896
    s_sub_u32 s51, s23, 8192
    s_cmp_ge_u32 s47, 2
    s_cselect_b32 s51, s51, 0x7f000000
    v_add_u32 v252, s51, v5
    v_add_u32 v190, s51, v7
    v_mfma_f32_16x16x32_bf16 v[224:227], a[60:63], v[168:171], v[224:227]
    ds_read_b64_tr_b16 v[208:209], v244 offset:20480
    ds_read_b64_tr_b16 v[210:211], v244 offset:20992
    s_sub_u32 s51, s23, 12288
    s_cmp_ge_u32 s47, 3
    s_cselect_b32 s51, s51, 0x7f000000
    v_add_u32 v251, s51, v5
    v_add_u32 v189, s51, v7
    v_mfma_f32_16x16x32_bf16 v[228:231], a[60:63], v[172:175], v[228:231]
    ds_read_b64_tr_b16 v[212:213], v245 offset:20480
    ds_read_b64_tr_b16 v[214:215], v245 offset:20992
    s_sub_u32 s51, s23, 16384
    s_cmp_ge_u32 s47, 4
    s_cselect_b32 s51, s51, 0x7f000000
    v_add_u32 v250, s51, v5
    v_add_u32 v188, s51, v7
    v_mfma_f32_16x16x32_bf16 v[232:235], a[60:63], v[176:179], v[232:235]
    ds_read_b64_tr_b16 v[216:217], v246 offset:20480
    ds_read_b64_tr_b16 v[218:219], v246 offset:20992
    v_mfma_f32_16x16x32_bf16 v[236:239], a[60:63], v[180:183], v[236:239]
    ds_read_b64_tr_b16 v[220:221], v247 offset:20480
    ds_read_b64_tr_b16 v[222:223], v247 offset:20992
    s_waitcnt lgkmcnt(8)
    v_mfma_f32_16x16x32_bf16 v[224:227], a[16:19], v[192:195], v[224:227]
    ds_read_b64_tr_b16 v[152:153], v244 offset:24576
    ds_read_b64_tr_b16 v[154:155], v244 offset:25088
    v_subrev_u32 v136, 0, v248
    v_ashrrev_i32 v136, 31, v136
    v_and_b32 v136, s50, v136
    v_mfma_f32_16x16x32_bf16 v[228:231], a[16:19], v[196:199], v[228:231]
    ds_read_b64_tr_b16 v[156:157], v245 offset:24576
    ds_read_b64_tr_b16 v[158:159], v245 offset:25088
    v_subrev_u32 v137, 1, v248
    v_ashrrev_i32 v137, 31, v137
    v_and_b32 v137, s50, v137
    v_mfma_f32_16x16x32_bf16 v[232:235], a[16:19], v[200:203], v[232:235]
    ds_read_b64_tr_b16 v[160:161], v246 offset:24576
    ds_read_b64_tr_b16 v[162:163], v246 offset:25088
    v_subrev_u32 v138, 2, v248
    v_ashrrev_i32 v138, 31, v138
    v_and_b32 v138, s50, v138
    v_mfma_f32_16x16x32_bf16 v[236:239], a[16:19], v[204:207], v[236:239]
    ds_read_b64_tr_b16 v[164:165], v247 offset:24576
    ds_read_b64_tr_b16 v[166:167], v247 offset:25088
    v_subrev_u32 v139, 3, v248
    v_ashrrev_i32 v139, 31, v139
    v_and_b32 v139, s50, v139
    s_waitcnt lgkmcnt(8)
    v_mfma_f32_16x16x32_bf16 v[224:227], a[20:23], v[208:211], v[224:227]
    ds_read_b64_tr_b16 v[168:169], v244 offset:28672
    ds_read_b64_tr_b16 v[170:171], v244 offset:29184
    v_subrev_u32 v140, 8, v248
    v_ashrrev_i32 v140, 31, v140
    v_and_b32 v140, s50, v140
    v_mfma_f32_16x16x32_bf16 v[228:231], a[20:23], v[212:215], v[228:231]
    ds_read_b64_tr_b16 v[172:173], v245 offset:28672
    ds_read_b64_tr_b16 v[174:175], v245 offset:29184
    v_subrev_u32 v141, 9, v248
    v_ashrrev_i32 v141, 31, v141
    v_and_b32 v141, s50, v141
    v_mfma_f32_16x16x32_bf16 v[232:235], a[20:23], v[216:219], v[232:235]
    ds_read_b64_tr_b16 v[176:177], v246 offset:28672
    ds_read_b64_tr_b16 v[178:179], v246 offset:29184
    v_subrev_u32 v142, 10, v248
    v_ashrrev_i32 v142, 31, v142
    v_and_b32 v142, s50, v142
    v_mfma_f32_16x16x32_bf16 v[236:239], a[20:23], v[220:223], v[236:239]
    ds_read_b64_tr_b16 v[180:181], v247 offset:28672
    ds_read_b64_tr_b16 v[182:183], v247 offset:29184
    v_subrev_u32 v143, 11, v248
    v_ashrrev_i32 v143, 31, v143
    v_and_b32 v143, s50, v143
    s_waitcnt lgkmcnt(8)
    v_mfma_f32_16x16x32_bf16 v[224:227], a[24:27], v[152:155], v[224:227]
    ds_read_b64_tr_b16 v[192:193], v244 offset:32768
    ds_read_b64_tr_b16 v[194:195], v244 offset:33280
    v_subrev_u32 v144, 16, v248
    v_ashrrev_i32 v144, 31, v144
    v_and_b32 v144, s50, v144
    v_mfma_f32_16x16x32_bf16 v[228:231], a[24:27], v[156:159], v[228:231]
    ds_read_b64_tr_b16 v[196:197], v245 offset:32768
    ds_read_b64_tr_b16 v[198:199], v245 offset:33280
    v_subrev_u32 v145, 17, v248
    v_ashrrev_i32 v145, 31, v145
    v_and_b32 v145, s50, v145
    v_mfma_f32_16x16x32_bf16 v[232:235], a[24:27], v[160:163], v[232:235]
    ds_read_b64_tr_b16 v[200:201], v246 offset:32768
    ds_read_b64_tr_b16 v[202:203], v246 offset:33280
    v_subrev_u32 v146, 18, v248
    v_ashrrev_i32 v146, 31, v146
    v_and_b32 v146, s50, v146
    v_mfma_f32_16x16x32_bf16 v[236:239], a[24:27], v[164:167], v[236:239]
    ds_read_b64_tr_b16 v[204:205], v247 offset:32768
    ds_read_b64_tr_b16 v[206:207], v247 offset:33280
    v_subrev_u32 v147, 19, v248
    v_ashrrev_i32 v147, 31, v147
    v_and_b32 v147, s50, v147
    s_waitcnt lgkmcnt(8)
    v_mfma_f32_16x16x32_bf16 v[224:227], a[28:31], v[168:171], v[224:227]
    ds_read_b64_tr_b16 v[208:209], v244 offset:36864
    ds_read_b64_tr_b16 v[210:211], v244 offset:37376
    v_subrev_u32 v148, 24, v248
    v_ashrrev_i32 v148, 31, v148
    v_and_b32 v148, s50, v148
    v_mfma_f32_16x16x32_bf16 v[228:231], a[28:31], v[172:175], v[228:231]
    ds_read_b64_tr_b16 v[212:213], v245 offset:36864
    ds_read_b64_tr_b16 v[214:215], v245 offset:37376
    v_subrev_u32 v149, 25, v248
    v_ashrrev_i32 v149, 31, v149
    v_and_b32 v149, s50, v149
    v_mfma_f32_16x16x32_bf16 v[232:235], a[28:31], v[176:179], v[232:235]
    ds_read_b64_tr_b16 v[216:217], v246 offset:36864
    ds_read_b64_tr_b16 v[218:219], v246 offset:37376
    v_subrev_u32 v150, 26, v248
    v_ashrrev_i32 v150, 31, v150
    v_and_b32 v150, s50, v150
    v_mfma_f32_16x16x32_bf16 v[236:239], a[28:31], v[180:183], v[236:239]
    ds_read_b64_tr_b16 v[220:221], v247 offset:36864
    ds_read_b64_tr_b16 v[222:223], v247 offset:37376
    v_subrev_u32 v151, 27, v248
    v_ashrrev_i32 v151, 31, v151
    v_and_b32 v151, s50, v151
    s_waitcnt lgkmcnt(8)
    v_mfma_f32_16x16x32_bf16 v[224:227], a[32:35], v[192:195], v[224:227]
    ds_read_b64_tr_b16 v[152:153], v244 offset:40960
    ds_read_b64_tr_b16 v[154:155], v244 offset:41472
    v_mfma_f32_16x16x32_bf16 v[228:231], a[32:35], v[196:199], v[228:231]
    ds_read_b64_tr_b16 v[156:157], v245 offset:40960
    ds_read_b64_tr_b16 v[158:159], v245 offset:41472
    v_mfma_f32_16x16x32_bf16 v[232:235], a[32:35], v[200:203], v[232:235]
    ds_read_b64_tr_b16 v[160:161], v246 offset:40960
    ds_read_b64_tr_b16 v[162:163], v246 offset:41472
    v_mfma_f32_16x16x32_bf16 v[236:239], a[32:35], v[204:207], v[236:239]
    ds_read_b64_tr_b16 v[164:165], v247 offset:40960
    ds_read_b64_tr_b16 v[166:167], v247 offset:41472
    s_waitcnt lgkmcnt(8)
    v_mfma_f32_16x16x32_bf16 v[224:227], a[36:39], v[208:211], v[224:227]
    ds_read_b64_tr_b16 v[168:169], v244 offset:45056
    ds_read_b64_tr_b16 v[170:171], v244 offset:45568
    v_mfma_f32_16x16x32_bf16 v[228:231], a[36:39], v[212:215], v[228:231]
    ds_read_b64_tr_b16 v[172:173], v245 offset:45056
    ds_read_b64_tr_b16 v[174:175], v245 offset:45568
    v_mfma_f32_16x16x32_bf16 v[232:235], a[36:39], v[216:219], v[232:235]
    ds_read_b64_tr_b16 v[176:177], v246 offset:45056
    ds_read_b64_tr_b16 v[178:179], v246 offset:45568
    v_mfma_f32_16x16x32_bf16 v[236:239], a[36:39], v[220:223], v[236:239]
    ds_read_b64_tr_b16 v[180:181], v247 offset:45056
    ds_read_b64_tr_b16 v[182:183], v247 offset:45568
    s_waitcnt lgkmcnt(8)
    v_mfma_f32_16x16x32_bf16 v[224:227], a[40:43], v[152:155], v[224:227]
    v_mfma_f32_16x16x32_bf16 v[228:231], a[40:43], v[156:159], v[228:231]
    v_mfma_f32_16x16x32_bf16 v[232:235], a[40:43], v[160:163], v[232:235]
    v_mfma_f32_16x16x32_bf16 v[236:239], a[40:43], v[164:167], v[236:239]
    s_waitcnt lgkmcnt(0)
    v_mfma_f32_16x16x32_bf16 v[224:227], a[44:47], v[168:171], v[224:227]
    v_mfma_f32_16x16x32_bf16 v[228:231], a[44:47], v[172:175], v[228:231]
    v_mfma_f32_16x16x32_bf16 v[232:235], a[44:47], v[176:179], v[232:235]
    v_mfma_f32_16x16x32_bf16 v[236:239], a[44:47], v[180:183], v[236:239]
    s_mov_b64 exec, s[60:61]
    ds_read_b128 v[72:75], v240 offset:0
    ds_read_b128 v[76:79], v240 offset:512
    ds_read_b128 v[80:83], v240 offset:1024
    ds_read_b128 v[84:87], v240 offset:1536
    s_mov_b64 exec, -1
    v_mul_f32 v224, v184, v224
    v_mul_f32 v225, v184, v225
    v_mul_f32 v226, v184, v226
    v_mul_f32 v227, v184, v227
    v_cvt_pk_bf16_f32 v112, v224, v225
    v_cvt_pk_bf16_f32 v113, v226, v227
    v_mul_f32 v228, v185, v228
    v_mul_f32 v229, v185, v229
    v_mul_f32 v230, v185, v230
    v_mul_f32 v231, v185, v231
    v_cvt_pk_bf16_f32 v114, v228, v229
    v_cvt_pk_bf16_f32 v115, v230, v231
    v_mul_f32 v232, v186, v232
    v_mul_f32 v233, v186, v233
    v_mul_f32 v234, v186, v234
    v_mul_f32 v235, v186, v235
    v_cvt_pk_bf16_f32 v116, v232, v233
    v_cvt_pk_bf16_f32 v117, v234, v235
    v_mul_f32 v236, v187, v236
    v_mul_f32 v237, v187, v237
    v_mul_f32 v238, v187, v238
    v_mul_f32 v239, v187, v239
    v_cvt_pk_bf16_f32 v118, v236, v237
    v_cvt_pk_bf16_f32 v119, v238, v239
    v_permlane16_swap_b32 v112, v114
    v_permlane16_swap_b32 v113, v115
    v_permlane16_swap_b32 v116, v118
    v_permlane16_swap_b32 v117, v119
    s_lshl_b32 s62, s48, 16
    s_lshl_b32 s63, s46, 14
    s_add_u32 s62, s62, s63
    s_add_u32 s62, s62, 14417920
    s_add_u32 s63, s63, 65536
    v_mfma_f32_32x32x16_bf16 v[152:167], v[104:107], v[116:119], 0
    s_waitcnt lgkmcnt(0)
    s_waitcnt vmcnt(0)
    s_barrier
    buffer_load_dwordx4 v[88:91], v253, s[32:35], 0 offen offset:2048 sc1
    s_mov_b64 exec, s[60:61]
    buffer_load_dwordx4 v[64:67], v191, s[32:35], 0 offen offset:3072 sc1
    buffer_load_dwordx4 v[68:71], v191, s[32:35], 0 offen offset:3584 sc1
    s_mov_b64 exec, -1
    buffer_load_dwordx4 v[92:95], v253, s[32:35], 0 offen offset:0 sc1
    s_mov_b64 exec, s[60:61]
    buffer_load_dwordx4 v[56:59], v191, s[32:35], 0 offen offset:1024 sc1
    buffer_load_dwordx4 v[60:63], v191, s[32:35], 0 offen offset:1536 sc1
    s_mov_b64 exec, -1
    buffer_load_dwordx4 v[96:99], v252, s[32:35], 0 offen offset:2048 sc1
    s_mov_b64 exec, s[60:61]
    buffer_load_dwordx4 v[48:51], v190, s[32:35], 0 offen offset:3072 sc1
    buffer_load_dwordx4 v[52:55], v190, s[32:35], 0 offen offset:3584 sc1
    s_mov_b64 exec, -1
    buffer_load_dwordx4 v[100:103], v252, s[32:35], 0 offen offset:0 sc1
    s_mov_b64 exec, s[60:61]
    buffer_load_dwordx4 v[40:43], v190, s[32:35], 0 offen offset:1024 sc1
    buffer_load_dwordx4 v[44:47], v190, s[32:35], 0 offen offset:1536 sc1
    s_mov_b64 exec, -1
    v_exp_f32 v152, v152
    v_exp_f32 v153, v153
    v_exp_f32 v154, v154
    v_exp_f32 v155, v155
    v_exp_f32 v160, v160
    v_exp_f32 v161, v161
    v_mfma_f32_32x32x16_bf16 v[168:183], v[104:107], v[112:115], v[136:151]
    v_exp_f32 v162, v162
    v_exp_f32 v163, v163
    v_cvt_pk_bf16_f32 v224, v152, v153
    v_cvt_pk_bf16_f32 v225, v154, v155
    v_cvt_pk_bf16_f32 v226, v160, v161
    v_cvt_pk_bf16_f32 v227, v162, v163
    v_exp_f32 v156, v156
    buffer_load_dwordx4 v[120:123], v251, s[32:35], 0 offen offset:2048 sc1
    v_exp_f32 v157, v157
    v_mfma_f32_32x32x16_bf16 v[208:223], v[72:75], v[224:227], 0
    v_exp_f32 v158, v158
    v_exp_f32 v159, v159
    v_exp_f32 v164, v164
    v_exp_f32 v165, v165
    v_exp_f32 v166, v166
    v_exp_f32 v167, v167
    v_cvt_pk_bf16_f32 v228, v156, v157
    v_cvt_pk_bf16_f32 v229, v158, v159
    v_cvt_pk_bf16_f32 v230, v164, v165
    v_cvt_pk_bf16_f32 v231, v166, v167
    v_exp_f32 v168, v168
    v_exp_f32 v169, v169
    s_mov_b64 exec, s[60:61]
    buffer_load_dwordx4 v[32:35], v189, s[32:35], 0 offen offset:3072 sc1
    buffer_load_dwordx4 v[36:39], v189, s[32:35], 0 offen offset:3584 sc1
    s_mov_b64 exec, -1
    v_mfma_f32_32x32x16_bf16 v[208:223], v[76:79], v[228:231], v[208:223]
    v_exp_f32 v170, v170
    v_exp_f32 v171, v171
    v_exp_f32 v176, v176
    v_exp_f32 v177, v177
    v_mfma_f32_32x32x16_bf16 v[152:167], v[108:111], v[116:119], v[136:151]
    v_exp_f32 v178, v178
    v_exp_f32 v179, v179
    v_cvt_pk_bf16_f32 v232, v168, v169
    v_cvt_pk_bf16_f32 v233, v170, v171
    v_cvt_pk_bf16_f32 v234, v176, v177
    v_cvt_pk_bf16_f32 v235, v178, v179
    v_exp_f32 v172, v172
    v_exp_f32 v173, v173
    buffer_load_dwordx4 v[124:127], v251, s[32:35], 0 offen offset:0 sc1
    v_mfma_f32_32x32x16_bf16 v[192:207], v[72:75], v[232:235], 0
    v_exp_f32 v174, v174
    v_exp_f32 v175, v175
    v_exp_f32 v180, v180
    v_exp_f32 v181, v181
    v_exp_f32 v182, v182
    v_exp_f32 v183, v183
    v_cvt_pk_bf16_f32 v236, v172, v173
    v_cvt_pk_bf16_f32 v237, v174, v175
    v_cvt_pk_bf16_f32 v238, v180, v181
    v_cvt_pk_bf16_f32 v239, v182, v183
    v_exp_f32 v152, v152
    v_exp_f32 v153, v153
    v_mfma_f32_32x32x16_bf16 v[192:207], v[76:79], v[236:239], v[192:207]
    s_mov_b64 exec, s[60:61]
    buffer_load_dwordx4 v[24:27], v189, s[32:35], 0 offen offset:1024 sc1
    buffer_load_dwordx4 v[28:31], v189, s[32:35], 0 offen offset:1536 sc1
    s_mov_b64 exec, -1
    v_exp_f32 v154, v154
    v_exp_f32 v155, v155
    v_exp_f32 v160, v160
    v_exp_f32 v161, v161
    v_xor_b32 v136, s50, v136
    v_xor_b32 v137, s50, v137
    v_xor_b32 v138, s50, v138
    v_xor_b32 v139, s50, v139
    v_xor_b32 v140, s50, v140
    v_xor_b32 v141, s50, v141
    v_xor_b32 v142, s50, v142
    v_xor_b32 v143, s50, v143
    v_xor_b32 v144, s50, v144
    v_xor_b32 v145, s50, v145
    v_xor_b32 v146, s50, v146
    v_xor_b32 v147, s50, v147
    v_xor_b32 v148, s50, v148
    v_xor_b32 v149, s50, v149
    v_xor_b32 v150, s50, v150
    v_xor_b32 v151, s50, v151
    s_waitcnt vmcnt(12)
    v_max3_u32 v248, v88, v92, v64
    v_max3_u32 v248, v248, v68, v56
    v_max_u32 v248, v248, v60
    v_cmp_eq_u32 vcc, -1, v248
    s_cbranch_vccnz L_slow_12
L_ok_11:
    v_mfma_f32_32x32x16_bf16 v[168:183], v[88:91], v[112:115], 0
    v_exp_f32 v162, v162
    v_exp_f32 v163, v163
    v_cvt_pk_bf16_f32 v224, v152, v153
    v_cvt_pk_bf16_f32 v225, v154, v155
    v_cvt_pk_bf16_f32 v226, v160, v161
    v_cvt_pk_bf16_f32 v227, v162, v163
    v_exp_f32 v156, v156
    v_exp_f32 v157, v157
    v_mfma_f32_32x32x16_bf16 v[208:223], v[80:83], v[224:227], v[208:223]
    buffer_load_dwordx4 v[128:131], v250, s[32:35], 0 offen offset:2048 sc1
    v_exp_f32 v158, v158
    v_exp_f32 v159, v159
    v_exp_f32 v164, v164
    v_exp_f32 v165, v165
    v_exp_f32 v166, v166
    v_exp_f32 v167, v167
    v_cvt_pk_bf16_f32 v228, v156, v157
    v_cvt_pk_bf16_f32 v229, v158, v159
    v_cvt_pk_bf16_f32 v230, v164, v165
    v_cvt_pk_bf16_f32 v231, v166, v167
    v_exp_f32 v168, v168
    v_exp_f32 v169, v169
    v_mfma_f32_32x32x16_bf16 v[208:223], v[84:87], v[228:231], v[208:223]
    v_exp_f32 v170, v170
    s_mov_b64 exec, s[60:61]
    buffer_load_dwordx4 v[16:19], v188, s[32:35], 0 offen offset:3072 sc1
    buffer_load_dwordx4 v[20:23], v188, s[32:35], 0 offen offset:3584 sc1
    s_mov_b64 exec, -1
    v_exp_f32 v171, v171
    v_exp_f32 v176, v176
    v_exp_f32 v177, v177
    v_mfma_f32_32x32x16_bf16 v[152:167], v[88:91], v[116:119], 0
    v_exp_f32 v178, v178
    v_exp_f32 v179, v179
    v_cvt_pk_bf16_f32 v232, v168, v169
    v_cvt_pk_bf16_f32 v233, v170, v171
    v_cvt_pk_bf16_f32 v234, v176, v177
    v_cvt_pk_bf16_f32 v235, v178, v179
    v_exp_f32 v172, v172
    v_exp_f32 v173, v173
    v_mfma_f32_32x32x16_bf16 v[192:207], v[64:67], v[232:235], v[192:207]
    v_exp_f32 v174, v174
    buffer_load_dwordx4 v[132:135], v250, s[32:35], 0 offen offset:0 sc1
    v_exp_f32 v175, v175
    v_exp_f32 v180, v180
    v_exp_f32 v181, v181
    v_exp_f32 v182, v182
    v_exp_f32 v183, v183
    v_cvt_pk_bf16_f32 v236, v172, v173
    v_cvt_pk_bf16_f32 v237, v174, v175
    v_cvt_pk_bf16_f32 v238, v180, v181
    v_cvt_pk_bf16_f32 v239, v182, v183
    v_exp_f32 v152, v152
    v_exp_f32 v153, v153
    v_mfma_f32_32x32x16_bf16 v[192:207], v[68:71], v[236:239], v[192:207]
    v_exp_f32 v154, v154
    v_exp_f32 v155, v155
    s_mov_b64 exec, s[60:61]
    buffer_load_dwordx4 v[8:11], v188, s[32:35], 0 offen offset:1024 sc1
    buffer_load_dwordx4 v[12:15], v188, s[32:35], 0 offen offset:1536 sc1
    s_mov_b64 exec, -1
    v_exp_f32 v160, v160
    v_exp_f32 v161, v161
    v_mfma_f32_32x32x16_bf16 v[168:183], v[92:95], v[112:115], 0
    v_exp_f32 v162, v162
    v_exp_f32 v163, v163
    v_cvt_pk_bf16_f32 v224, v152, v153
    v_cvt_pk_bf16_f32 v225, v154, v155
    v_cvt_pk_bf16_f32 v226, v160, v161
    v_cvt_pk_bf16_f32 v227, v162, v163
    v_exp_f32 v156, v156
    v_exp_f32 v157, v157
    v_mfma_f32_32x32x16_bf16 v[208:223], v[64:67], v[224:227], v[208:223]
    v_exp_f32 v158, v158
    v_exp_f32 v159, v159
    s_add_u32 m0, s63, 0
    s_nop 0
    buffer_load_dwordx4 v5, s[24:27], s62 offen offset:0 sc1 lds
    v_exp_f32 v164, v164
    v_exp_f32 v165, v165
    v_exp_f32 v166, v166
    v_exp_f32 v167, v167
    v_cvt_pk_bf16_f32 v228, v156, v157
    v_cvt_pk_bf16_f32 v229, v158, v159
    v_cvt_pk_bf16_f32 v230, v164, v165
    v_cvt_pk_bf16_f32 v231, v166, v167
    v_exp_f32 v168, v168
    v_exp_f32 v169, v169
    v_mfma_f32_32x32x16_bf16 v[208:223], v[68:71], v[228:231], v[208:223]
    v_exp_f32 v170, v170
    v_exp_f32 v171, v171
    v_exp_f32 v176, v176
    buffer_load_dwordx4 v5, s[24:27], s62 offen offset:1024 sc1 lds
    v_exp_f32 v177, v177
    v_mfma_f32_32x32x16_bf16 v[152:167], v[92:95], v[116:119], 0
    v_exp_f32 v178, v178
    v_exp_f32 v179, v179
    v_cvt_pk_bf16_f32 v232, v168, v169
    v_cvt_pk_bf16_f32 v233, v170, v171
    v_cvt_pk_bf16_f32 v234, v176, v177
    v_cvt_pk_bf16_f32 v235, v178, v179
    v_exp_f32 v172, v172
    v_exp_f32 v173, v173
    v_mfma_f32_32x32x16_bf16 v[192:207], v[56:59], v[232:235], v[192:207]
    v_exp_f32 v174, v174
    v_exp_f32 v175, v175
    v_exp_f32 v180, v180
    buffer_load_dwordx4 v5, s[24:27], s62 offen offset:2048 sc1 lds
    v_exp_f32 v181, v181
    v_exp_f32 v182, v182
    v_exp_f32 v183, v183
    v_cvt_pk_bf16_f32 v236, v172, v173
    v_cvt_pk_bf16_f32 v237, v174, v175
    v_cvt_pk_bf16_f32 v238, v180, v181
    v_cvt_pk_bf16_f32 v239, v182, v183
    v_exp_f32 v152, v152
    v_exp_f32 v153, v153
    v_mfma_f32_32x32x16_bf16 v[192:207], v[60:63], v[236:239], v[192:207]
    v_exp_f32 v154, v154
    v_exp_f32 v155, v155
    v_exp_f32 v160, v160
    v_exp_f32 v161, v161
    buffer_load_dwordx4 v5, s[24:27], s62 offen offset:3072 sc1 lds
    s_add_u32 s62, s62, 4096
    s_waitcnt vmcnt(16)
    v_max3_u32 v248, v96, v100, v48
    v_max3_u32 v248, v248, v52, v40
    v_max_u32 v248, v248, v44
    v_cmp_eq_u32 vcc, -1, v248
    s_cbranch_vccnz L_slow_14
L_ok_13:
    v_mfma_f32_32x32x16_bf16 v[168:183], v[96:99], v[112:115], 0
    v_exp_f32 v162, v162
    v_exp_f32 v163, v163
    v_cvt_pk_bf16_f32 v224, v152, v153
    v_cvt_pk_bf16_f32 v225, v154, v155
    v_cvt_pk_bf16_f32 v226, v160, v161
    v_cvt_pk_bf16_f32 v227, v162, v163
    v_exp_f32 v156, v156
    v_exp_f32 v157, v157
    v_mfma_f32_32x32x16_bf16 v[208:223], v[56:59], v[224:227], v[208:223]
    v_exp_f32 v158, v158
    v_exp_f32 v159, v159
    v_exp_f32 v164, v164
    v_exp_f32 v165, v165
    s_add_u32 m0, s63, 4096
    s_nop 0
    buffer_load_dwordx4 v5, s[24:27], s62 offen offset:0 sc1 lds
    v_exp_f32 v166, v166
    v_exp_f32 v167, v167
    v_cvt_pk_bf16_f32 v228, v156, v157
    v_cvt_pk_bf16_f32 v229, v158, v159
    v_cvt_pk_bf16_f32 v230, v164, v165
    v_cvt_pk_bf16_f32 v231, v166, v167
    v_exp_f32 v168, v168
    v_exp_f32 v169, v169
    v_mfma_f32_32x32x16_bf16 v[208:223], v[60:63], v[228:231], v[208:223]
    v_exp_f32 v170, v170
    v_exp_f32 v171, v171
    v_exp_f32 v176, v176
    v_exp_f32 v177, v177
    v_mfma_f32_32x32x16_bf16 v[152:167], v[96:99], v[116:119], 0
    buffer_load_dwordx4 v5, s[24:27], s62 offen offset:1024 sc1 lds
    v_exp_f32 v178, v178
    v_exp_f32 v179, v179
    v_cvt_pk_bf16_f32 v232, v168, v169
    v_cvt_pk_bf16_f32 v233, v170, v171
    v_cvt_pk_bf16_f32 v234, v176, v177
    v_cvt_pk_bf16_f32 v235, v178, v179
    v_exp_f32 v172, v172
    v_exp_f32 v173, v173
    v_mfma_f32_32x32x16_bf16 v[192:207], v[48:51], v[232:235], v[192:207]
    v_exp_f32 v174, v174
    v_exp_f32 v175, v175
    v_exp_f32 v180, v180
    v_exp_f32 v181, v181
    v_exp_f32 v182, v182
    buffer_load_dwordx4 v5, s[24:27], s62 offen offset:2048 sc1 lds
    v_exp_f32 v183, v183
    v_cvt_pk_bf16_f32 v236, v172, v173
    v_cvt_pk_bf16_f32 v237, v174, v175
    v_cvt_pk_bf16_f32 v238, v180, v181
    v_cvt_pk_bf16_f32 v239, v182, v183
    v_exp_f32 v152, v152
    v_exp_f32 v153, v153
    v_mfma_f32_32x32x16_bf16 v[192:207], v[52:55], v[236:239], v[192:207]
    v_exp_f32 v154, v154
    v_exp_f32 v155, v155
    v_exp_f32 v160, v160
    v_exp_f32 v161, v161
    v_mfma_f32_32x32x16_bf16 v[168:183], v[100:103], v[112:115], 0
    v_exp_f32 v162, v162
    buffer_load_dwordx4 v5, s[24:27], s62 offen offset:3072 sc1 lds
    s_add_u32 s62, s62, 4096
    v_exp_f32 v163, v163
    v_cvt_pk_bf16_f32 v224, v152, v153
    v_cvt_pk_bf16_f32 v225, v154, v155
    v_cvt_pk_bf16_f32 v226, v160, v161
    v_cvt_pk_bf16_f32 v227, v162, v163
    v_exp_f32 v156, v156
    v_exp_f32 v157, v157
    v_mfma_f32_32x32x16_bf16 v[208:223], v[48:51], v[224:227], v[208:223]
    v_exp_f32 v158, v158
    v_exp_f32 v159, v159
    v_exp_f32 v164, v164
    v_exp_f32 v165, v165
    v_exp_f32 v166, v166
    v_exp_f32 v167, v167
    s_add_u32 m0, s63, 8192
    s_nop 0
    buffer_load_dwordx4 v5, s[24:27], s62 offen offset:0 sc1 lds
    v_cvt_pk_bf16_f32 v228, v156, v157
    v_cvt_pk_bf16_f32 v229, v158, v159
    v_cvt_pk_bf16_f32 v230, v164, v165
    v_cvt_pk_bf16_f32 v231, v166, v167
    v_exp_f32 v168, v168
    v_exp_f32 v169, v169
    v_mfma_f32_32x32x16_bf16 v[208:223], v[52:55], v[228:231], v[208:223]
    v_exp_f32 v170, v170
    v_exp_f32 v171, v171
    v_exp_f32 v176, v176
    v_exp_f32 v177, v177
    v_mfma_f32_32x32x16_bf16 v[152:167], v[100:103], v[116:119], 0
    v_exp_f32 v178, v178
    v_exp_f32 v179, v179
    buffer_load_dwordx4 v5, s[24:27], s62 offen offset:1024 sc1 lds
    v_cvt_pk_bf16_f32 v232, v168, v169
    v_cvt_pk_bf16_f32 v233, v170, v171
    v_cvt_pk_bf16_f32 v234, v176, v177
    v_cvt_pk_bf16_f32 v235, v178, v179
    v_exp_f32 v172, v172
    v_exp_f32 v173, v173
    v_mfma_f32_32x32x16_bf16 v[192:207], v[40:43], v[232:235], v[192:207]
    v_exp_f32 v174, v174
    v_exp_f32 v175, v175
    v_exp_f32 v180, v180
    v_exp_f32 v181, v181
    v_exp_f32 v182, v182
    v_exp_f32 v183, v183
    v_cvt_pk_bf16_f32 v236, v172, v173
    buffer_load_dwordx4 v5, s[24:27], s62 offen offset:2048 sc1 lds
    v_cvt_pk_bf16_f32 v237, v174, v175
    v_cvt_pk_bf16_f32 v238, v180, v181
    v_cvt_pk_bf16_f32 v239, v182, v183
    v_exp_f32 v152, v152
    v_exp_f32 v153, v153
    v_mfma_f32_32x32x16_bf16 v[192:207], v[44:47], v[236:239], v[192:207]
    v_exp_f32 v154, v154
    v_exp_f32 v155, v155
    v_exp_f32 v160, v160
    v_exp_f32 v161, v161
    s_waitcnt vmcnt(17)
    v_max3_u32 v248, v120, v124, v32
    v_max3_u32 v248, v248, v36, v24
    v_max_u32 v248, v248, v28
    v_cmp_eq_u32 vcc, -1, v248
    s_cbranch_vccnz L_slow_16
L_ok_15:
    v_mfma_f32_32x32x16_bf16 v[168:183], v[120:123], v[112:115], 0
    v_exp_f32 v162, v162
    v_exp_f32 v163, v163
    buffer_load_dwordx4 v5, s[24:27], s62 offen offset:3072 sc1 lds
    s_add_u32 s62, s62, 4096
    v_cvt_pk_bf16_f32 v224, v152, v153
    v_cvt_pk_bf16_f32 v225, v154, v155
    v_cvt_pk_bf16_f32 v226, v160, v161
    v_cvt_pk_bf16_f32 v227, v162, v163
    v_exp_f32 v156, v156
    v_exp_f32 v157, v157
    v_mfma_f32_32x32x16_bf16 v[208:223], v[40:43], v[224:227], v[208:223]
    v_exp_f32 v158, v158
    v_exp_f32 v159, v159
    v_exp_f32 v164, v164
    v_exp_f32 v165, v165
    v_exp_f32 v166, v166
    v_exp_f32 v167, v167
    v_cvt_pk_bf16_f32 v228, v156, v157
    s_add_u32 m0, s63, 12288
    s_nop 0
    buffer_load_dwordx4 v5, s[24:27], s62 offen offset:0 sc1 lds
    v_cvt_pk_bf16_f32 v229, v158, v159
    v_cvt_pk_bf16_f32 v230, v164, v165
    v_cvt_pk_bf16_f32 v231, v166, v167
    v_exp_f32 v168, v168
    v_exp_f32 v169, v169
    v_mfma_f32_32x32x16_bf16 v[208:223], v[44:47], v[228:231], v[208:223]
    v_exp_f32 v170, v170
    v_exp_f32 v171, v171
    v_exp_f32 v176, v176
    v_exp_f32 v177, v177
    v_mfma_f32_32x32x16_bf16 v[152:167], v[120:123], v[116:119], 0
    v_exp_f32 v178, v178
    v_exp_f32 v179, v179
    buffer_load_dwordx4 v5, s[24:27], s62 offen offset:1024 sc1 lds
    v_cvt_pk_bf16_f32 v232, v168, v169
    v_cvt_pk_bf16_f32 v233, v170, v171
    v_cvt_pk_bf16_f32 v234, v176, v177
    v_cvt_pk_bf16_f32 v235, v178, v179
    v_exp_f32 v172, v172
    v_exp_f32 v173, v173
    v_mfma_f32_32x32x16_bf16 v[192:207], v[32:35], v[232:235], v[192:207]
    v_exp_f32 v174, v174
    v_exp_f32 v175, v175
    v_exp_f32 v180, v180
    v_exp_f32 v181, v181
    v_exp_f32 v182, v182
    v_exp_f32 v183, v183
    v_cvt_pk_bf16_f32 v236, v172, v173
    buffer_load_dwordx4 v5, s[24:27], s62 offen offset:2048 sc1 lds
    v_cvt_pk_bf16_f32 v237, v174, v175
    v_cvt_pk_bf16_f32 v238, v180, v181
    v_cvt_pk_bf16_f32 v239, v182, v183
    v_exp_f32 v152, v152
    v_exp_f32 v153, v153
    v_mfma_f32_32x32x16_bf16 v[192:207], v[36:39], v[236:239], v[192:207]
    v_exp_f32 v154, v154
    v_exp_f32 v155, v155
    v_exp_f32 v160, v160
    v_exp_f32 v161, v161
    v_mfma_f32_32x32x16_bf16 v[168:183], v[124:127], v[112:115], 0
    v_exp_f32 v162, v162
    v_exp_f32 v163, v163
    buffer_load_dwordx4 v5, s[24:27], s62 offen offset:3072 sc1 lds
    s_add_u32 s62, s62, 4096
    v_cvt_pk_bf16_f32 v224, v152, v153
    v_cvt_pk_bf16_f32 v225, v154, v155
    v_cvt_pk_bf16_f32 v226, v160, v161
    v_cvt_pk_bf16_f32 v227, v162, v163
    v_exp_f32 v156, v156
    v_exp_f32 v157, v157
    v_mfma_f32_32x32x16_bf16 v[208:223], v[32:35], v[224:227], v[208:223]
    v_exp_f32 v158, v158
    v_exp_f32 v159, v159
    v_exp_f32 v164, v164
    v_exp_f32 v165, v165
    v_exp_f32 v166, v166
    v_exp_f32 v167, v167
    v_cvt_pk_bf16_f32 v228, v156, v157
    v_cvt_pk_bf16_f32 v229, v158, v159
    v_cvt_pk_bf16_f32 v230, v164, v165
    v_cvt_pk_bf16_f32 v231, v166, v167
    v_exp_f32 v168, v168
    v_exp_f32 v169, v169
    v_mfma_f32_32x32x16_bf16 v[208:223], v[36:39], v[228:231], v[208:223]
    v_exp_f32 v170, v170
    v_exp_f32 v171, v171
    v_exp_f32 v176, v176
    v_exp_f32 v177, v177
    v_mfma_f32_32x32x16_bf16 v[152:167], v[124:127], v[116:119], 0
    v_exp_f32 v178, v178
    v_exp_f32 v179, v179
    v_cvt_pk_bf16_f32 v232, v168, v169
    v_cvt_pk_bf16_f32 v233, v170, v171
    v_cvt_pk_bf16_f32 v234, v176, v177
    v_cvt_pk_bf16_f32 v235, v178, v179
    v_exp_f32 v172, v172
    v_exp_f32 v173, v173
    v_mfma_f32_32x32x16_bf16 v[192:207], v[24:27], v[232:235], v[192:207]
    v_exp_f32 v174, v174
    v_exp_f32 v175, v175
    v_exp_f32 v180, v180
    v_exp_f32 v181, v181
    v_exp_f32 v182, v182
    v_exp_f32 v183, v183
    v_cvt_pk_bf16_f32 v236, v172, v173
    v_cvt_pk_bf16_f32 v237, v174, v175
    v_cvt_pk_bf16_f32 v238, v180, v181
    v_cvt_pk_bf16_f32 v239, v182, v183
    v_exp_f32 v152, v152
    v_exp_f32 v153, v153
    v_mfma_f32_32x32x16_bf16 v[192:207], v[28:31], v[236:239], v[192:207]
    v_exp_f32 v154, v154
    v_exp_f32 v155, v155
    v_exp_f32 v160, v160
    v_exp_f32 v161, v161
    s_waitcnt vmcnt(16)
    v_max3_u32 v248, v128, v132, v16
    v_max3_u32 v248, v248, v20, v8
    v_max_u32 v248, v248, v12
    v_cmp_eq_u32 vcc, -1, v248
    s_cbranch_vccnz L_slow_18
L_ok_17:
    v_mfma_f32_32x32x16_bf16 v[168:183], v[128:131], v[112:115], 0
    v_exp_f32 v162, v162
    v_exp_f32 v163, v163
    v_cvt_pk_bf16_f32 v224, v152, v153
    v_cvt_pk_bf16_f32 v225, v154, v155
    v_cvt_pk_bf16_f32 v226, v160, v161
    v_cvt_pk_bf16_f32 v227, v162, v163
    v_exp_f32 v156, v156
    v_exp_f32 v157, v157
    v_mfma_f32_32x32x16_bf16 v[208:223], v[24:27], v[224:227], v[208:223]
    v_exp_f32 v158, v158
    v_exp_f32 v159, v159
    v_exp_f32 v164, v164
    v_exp_f32 v165, v165
    v_exp_f32 v166, v166
    v_exp_f32 v167, v167
    v_cvt_pk_bf16_f32 v228, v156, v157
    v_cvt_pk_bf16_f32 v229, v158, v159
    v_cvt_pk_bf16_f32 v230, v164, v165
    v_cvt_pk_bf16_f32 v231, v166, v167
    v_exp_f32 v168, v168
    v_exp_f32 v169, v169
    v_mfma_f32_32x32x16_bf16 v[208:223], v[28:31], v[228:231], v[208:223]
    v_exp_f32 v170, v170
    v_exp_f32 v171, v171
    v_exp_f32 v176, v176
    v_exp_f32 v177, v177
    v_mfma_f32_32x32x16_bf16 v[152:167], v[128:131], v[116:119], v[136:151]
    v_exp_f32 v178, v178
    v_exp_f32 v179, v179
    v_cvt_pk_bf16_f32 v232, v168, v169
    v_cvt_pk_bf16_f32 v233, v170, v171
    v_cvt_pk_bf16_f32 v234, v176, v177
    v_cvt_pk_bf16_f32 v235, v178, v179
    v_exp_f32 v172, v172
    v_exp_f32 v173, v173
    v_mfma_f32_32x32x16_bf16 v[192:207], v[16:19], v[232:235], v[192:207]
    v_exp_f32 v174, v174
    v_exp_f32 v175, v175
    v_exp_f32 v180, v180
    v_exp_f32 v181, v181
    v_exp_f32 v182, v182
    v_exp_f32 v183, v183
    v_cvt_pk_bf16_f32 v236, v172, v173
    v_cvt_pk_bf16_f32 v237, v174, v175
    v_cvt_pk_bf16_f32 v238, v180, v181
    v_cvt_pk_bf16_f32 v239, v182, v183
    v_exp_f32 v152, v152
    v_exp_f32 v153, v153
    v_mfma_f32_32x32x16_bf16 v[192:207], v[20:23], v[236:239], v[192:207]
    v_exp_f32 v154, v154
    v_exp_f32 v155, v155
    v_exp_f32 v160, v160
    v_exp_f32 v161, v161
    v_mfma_f32_32x32x16_bf16 v[168:183], v[132:135], v[112:115], v[136:151]
    v_exp_f32 v162, v162
    v_exp_f32 v163, v163
    v_cvt_pk_bf16_f32 v224, v152, v153
    v_cvt_pk_bf16_f32 v225, v154, v155
    v_cvt_pk_bf16_f32 v226, v160, v161
    v_cvt_pk_bf16_f32 v227, v162, v163
    v_exp_f32 v156, v156
    v_exp_f32 v157, v157
    v_mfma_f32_32x32x16_bf16 v[208:223], v[16:19], v[224:227], v[208:223]
    v_exp_f32 v158, v158
    v_exp_f32 v159, v159
    v_exp_f32 v164, v164
    v_exp_f32 v165, v165
    v_exp_f32 v166, v166
    v_exp_f32 v167, v167
    v_cvt_pk_bf16_f32 v228, v156, v157
    v_cvt_pk_bf16_f32 v229, v158, v159
    v_cvt_pk_bf16_f32 v230, v164, v165
    v_cvt_pk_bf16_f32 v231, v166, v167
    v_exp_f32 v168, v168
    v_exp_f32 v169, v169
    v_mfma_f32_32x32x16_bf16 v[208:223], v[20:23], v[228:231], v[208:223]
    v_exp_f32 v170, v170
    v_exp_f32 v171, v171
    v_exp_f32 v176, v176
    v_exp_f32 v177, v177
    v_exp_f32 v178, v178
    v_exp_f32 v179, v179
    v_cvt_pk_bf16_f32 v232, v168, v169
    v_cvt_pk_bf16_f32 v233, v170, v171
    v_cvt_pk_bf16_f32 v234, v176, v177
    v_cvt_pk_bf16_f32 v235, v178, v179
    v_exp_f32 v172, v172
    v_exp_f32 v173, v173
    v_mfma_f32_32x32x16_bf16 v[192:207], v[8:11], v[232:235], v[192:207]
    v_exp_f32 v174, v174
    v_exp_f32 v175, v175
    v_exp_f32 v180, v180
    v_exp_f32 v181, v181
    v_exp_f32 v182, v182
    v_exp_f32 v183, v183
    v_cvt_pk_bf16_f32 v236, v172, v173
    v_cvt_pk_bf16_f32 v237, v174, v175
    v_cvt_pk_bf16_f32 v238, v180, v181
    v_cvt_pk_bf16_f32 v239, v182, v183
    v_bfe_u32 v248, v1, 4, 1
    v_lshlrev_b32 v250, 14, v248
    v_mfma_f32_32x32x16_bf16 v[192:207], v[12:15], v[236:239], v[192:207]
    v_lshrrev_b32 v248, 5, v1
    v_lshl_add_u32 v250, v248, 8, v250
    v_lshl_add_u32 v250, v2, 4, v250
    s_lshl_b32 s50, s47, 16
    s_lshl_b32 s51, s48, 11
    s_add_u32 s50, s50, s51
    s_lshl_b32 s51, s46, 9
    s_add_u32 s50, s50, s51
    s_add_u32 s50, s50, 16777216
    s_add_u32 s51, s50, 32768
    s_mov_b32 s52, 0x1f800000
    s_mov_b32 s53, 0x40000000
    v_pk_add_f32 v[164:165], v[208:209], v[210:211]
    v_pk_add_f32 v[166:167], v[212:213], v[214:215]
    v_pk_add_f32 v[164:165], v[164:165], v[166:167]
    v_add_f32 v164, v164, v165
    v_fma_f32 v164, v164, 0, v216
    v_subrev_u32 v164, s52, v164
    v_pk_add_f32 v[160:161], v[192:193], v[194:195]
    v_pk_add_f32 v[162:163], v[196:197], v[198:199]
    v_pk_add_f32 v[160:161], v[160:161], v[162:163]
    v_add_f32 v160, v160, v161
    v_fma_f32 v160, v160, 0, v200
    v_subrev_u32 v160, s52, v160
    v_max_u32 v160, v160, v164
    v_cmp_lt_u32 vcc, s53, v160
    s_cbranch_vccnz L_smax_call0
L_smax_ret0:
    v_rcp_f32 v248, v216
    s_nop 0
    v_mul_f32 v208, v248, v208
    v_mul_f32 v209, v248, v209
    v_mul_f32 v210, v248, v210
    v_mul_f32 v211, v248, v211
    v_mul_f32 v212, v248, v212
    v_mul_f32 v213, v248, v213
    v_mul_f32 v214, v248, v214
    v_mul_f32 v215, v248, v215
    v_cvt_pk_bf16_f32 v156, v208, v209
    v_cvt_pk_bf16_f32 v157, v210, v211
    v_cvt_pk_bf16_f32 v158, v212, v213
    v_cvt_pk_bf16_f32 v159, v214, v215
    v_min_u32 v156, -2, v156
    buffer_store_dwordx4 v[156:159], v250, s[24:27], s51 offen sc1
    v_rcp_f32 v248, v200
    s_nop 0
    v_mul_f32 v192, v248, v192
    v_mul_f32 v193, v248, v193
    v_mul_f32 v194, v248, v194
    v_mul_f32 v195, v248, v195
    v_mul_f32 v196, v248, v196
    v_mul_f32 v197, v248, v197
    v_mul_f32 v198, v248, v198
    v_mul_f32 v199, v248, v199
    v_cvt_pk_bf16_f32 v152, v192, v193
    v_cvt_pk_bf16_f32 v153, v194, v195
    v_cvt_pk_bf16_f32 v154, v196, v197
    v_cvt_pk_bf16_f32 v155, v198, v199
    v_min_u32 v152, -2, v152
    buffer_store_dwordx4 v[152:155], v250, s[24:27], s50 offen sc1
    v_add_u32 v6, 65536, v5
    s_lshl_b32 s50, s47, 16
    s_lshl_b32 s51, s46, 14
    s_add_u32 s50, s50, s51
    s_add_u32 s50, s50, 16777216
    s_add_u32 s51, s50, 4096
    s_add_u32 s52, s50, 8192
    s_add_u32 s53, s50, 12288
    s_waitcnt vmcnt(0)
    s_barrier
    v_bfe_u32 v232, v2, 1, 1
    v_bfe_u32 v233, v2, 3, 1
    v_lshl_or_b32 v232, v233, 1, v232
    v_xor_b32 v232, s46, v232
    v_lshlrev_b32 v232, 5, v232
    v_lshl_add_u32 v232, v2, 7, v232
    v_lshl_add_u32 v232, v3, 3, v232
    s_lshl_b32 s54, s48, 13
    v_add_u32 v232, s54, v232
    ds_read_b64 v[236:237], v232 offset:0
    ds_read_b64 v[238:239], v232 offset:2048
    ds_read_b64 v[240:241], v232 offset:4096
    ds_read_b64 v[242:243], v232 offset:6144
    v_lshrrev_b32 v232, 1, v2
    v_and_b32 v233, 1, v3
    v_lshl_add_u32 v232, v233, 3, v232
    v_mul_u32_u24 v7, 8320, v232
    v_and_b32 v232, 1, v2
    v_lshl_add_u32 v7, v232, 5, v7
    v_lshrrev_b32 v232, 1, v3
    v_lshl_add_u32 v7, v232, 4, v7
    s_waitcnt lgkmcnt(0)
    v_lshlrev_b32 v216, 16, v236
    v_and_b32 v217, 0xffff0000, v236
    v_lshlrev_b32 v218, 16, v237
    v_and_b32 v219, 0xffff0000, v237
    v_lshlrev_b32 v220, 16, v238
    v_and_b32 v221, 0xffff0000, v238
    v_lshlrev_b32 v222, 16, v239
    v_and_b32 v223, 0xffff0000, v239
    v_lshlrev_b32 v224, 16, v240
    v_and_b32 v225, 0xffff0000, v240
    v_lshlrev_b32 v226, 16, v241
    v_and_b32 v227, 0xffff0000, v241
    v_lshlrev_b32 v228, 16, v242
    v_and_b32 v229, 0xffff0000, v242
    v_lshlrev_b32 v230, 16, v243
    v_and_b32 v231, 0xffff0000, v243
    s_barrier
    ds_read_b128 v[152:155], v6 offset:0
    ds_read_b128 v[156:159], v6 offset:1024
    ds_read_b128 v[160:163], v6 offset:2048
    ds_read_b128 v[164:167], v6 offset:3072
    ds_read_b128 v[168:171], v6 offset:4096
    ds_read_b128 v[172:175], v6 offset:5120
    ds_read_b128 v[176:179], v6 offset:6144
    ds_read_b128 v[180:183], v6 offset:7168
    ds_read_b128 v[184:187], v6 offset:8192
    ds_read_b128 v[188:191], v6 offset:9216
    ds_read_b128 v[192:195], v6 offset:10240
    ds_read_b128 v[196:199], v6 offset:11264
    ds_read_b128 v[200:203], v6 offset:12288
    ds_read_b128 v[204:207], v6 offset:13312
    ds_read_b128 v[208:211], v6 offset:14336
    ds_read_b128 v[212:215], v6 offset:15360
    buffer_load_dwordx4 v[88:91], v5, s[24:27], s50 offen offset:0 sc1
    buffer_load_dwordx4 v[92:95], v5, s[24:27], s50 offen offset:1024 sc1
    buffer_load_dwordx4 v[96:99], v5, s[24:27], s50 offen offset:2048 sc1
    buffer_load_dwordx4 v[100:103], v5, s[24:27], s50 offen offset:3072 sc1
    buffer_load_dwordx4 v[104:107], v5, s[24:27], s51 offen offset:0 sc1
    buffer_load_dwordx4 v[108:111], v5, s[24:27], s51 offen offset:1024 sc1
    buffer_load_dwordx4 v[112:115], v5, s[24:27], s51 offen offset:2048 sc1
    buffer_load_dwordx4 v[116:119], v5, s[24:27], s51 offen offset:3072 sc1
    s_waitcnt vmcnt(4)
    v_max3_u32 v234, v88, v92, v96
    v_max_u32 v234, v234, v100
    v_cmp_eq_u32 vcc, -1, v234
    s_cbranch_vccnz L_slow_20
L_ok_19:
    s_waitcnt lgkmcnt(12)
    v_mfma_f32_16x16x32_bf16 v[216:219], v[88:91], v[152:155], v[216:219]
    ds_read_b128 v[152:155], v6 offset:16384
    v_mfma_f32_16x16x32_bf16 v[220:223], v[88:91], v[156:159], v[220:223]
    ds_read_b128 v[156:159], v6 offset:17408
    buffer_load_dwordx4 v[120:123], v5, s[24:27], s52 offen offset:0 sc1
    v_mfma_f32_16x16x32_bf16 v[224:227], v[88:91], v[160:163], v[224:227]
    ds_read_b128 v[160:163], v6 offset:18432
    v_mfma_f32_16x16x32_bf16 v[228:231], v[88:91], v[164:167], v[228:231]
    ds_read_b128 v[164:167], v6 offset:19456
    s_waitcnt lgkmcnt(12)
    v_mfma_f32_16x16x32_bf16 v[216:219], v[92:95], v[168:171], v[216:219]
    ds_read_b128 v[168:171], v6 offset:20480
    v_mfma_f32_16x16x32_bf16 v[220:223], v[92:95], v[172:175], v[220:223]
    ds_read_b128 v[172:175], v6 offset:21504
    buffer_load_dwordx4 v[124:127], v5, s[24:27], s52 offen offset:1024 sc1
    v_mfma_f32_16x16x32_bf16 v[224:227], v[92:95], v[176:179], v[224:227]
    ds_read_b128 v[176:179], v6 offset:22528
    v_mfma_f32_16x16x32_bf16 v[228:231], v[92:95], v[180:183], v[228:231]
    ds_read_b128 v[180:183], v6 offset:23552
    s_waitcnt lgkmcnt(12)
    v_mfma_f32_16x16x32_bf16 v[216:219], v[96:99], v[184:187], v[216:219]
    ds_read_b128 v[184:187], v6 offset:24576
    v_mfma_f32_16x16x32_bf16 v[220:223], v[96:99], v[188:191], v[220:223]
    ds_read_b128 v[188:191], v6 offset:25600
    buffer_load_dwordx4 v[128:131], v5, s[24:27], s52 offen offset:2048 sc1
    v_mfma_f32_16x16x32_bf16 v[224:227], v[96:99], v[192:195], v[224:227]
    ds_read_b128 v[192:195], v6 offset:26624
    v_mfma_f32_16x16x32_bf16 v[228:231], v[96:99], v[196:199], v[228:231]
    ds_read_b128 v[196:199], v6 offset:27648
    s_waitcnt lgkmcnt(12)
    v_mfma_f32_16x16x32_bf16 v[216:219], v[100:103], v[200:203], v[216:219]
    ds_read_b128 v[200:203], v6 offset:28672
    v_mfma_f32_16x16x32_bf16 v[220:223], v[100:103], v[204:207], v[220:223]
    ds_read_b128 v[204:207], v6 offset:29696
    buffer_load_dwordx4 v[132:135], v5, s[24:27], s52 offen offset:3072 sc1
    v_mfma_f32_16x16x32_bf16 v[224:227], v[100:103], v[208:211], v[224:227]
    ds_read_b128 v[208:211], v6 offset:30720
    v_mfma_f32_16x16x32_bf16 v[228:231], v[100:103], v[212:215], v[228:231]
    ds_read_b128 v[212:215], v6 offset:31744
    s_waitcnt vmcnt(4)
    v_max3_u32 v234, v104, v108, v112
    v_max_u32 v234, v234, v116
    v_cmp_eq_u32 vcc, -1, v234
    s_cbranch_vccnz L_slow_22
L_ok_21:
    s_waitcnt lgkmcnt(12)
    v_mfma_f32_16x16x32_bf16 v[216:219], v[104:107], v[152:155], v[216:219]
    ds_read_b128 v[152:155], v6 offset:32768
    v_mfma_f32_16x16x32_bf16 v[220:223], v[104:107], v[156:159], v[220:223]
    ds_read_b128 v[156:159], v6 offset:33792
    buffer_load_dwordx4 v[136:139], v5, s[24:27], s53 offen offset:0 sc1
    v_mfma_f32_16x16x32_bf16 v[224:227], v[104:107], v[160:163], v[224:227]
    ds_read_b128 v[160:163], v6 offset:34816
    v_mfma_f32_16x16x32_bf16 v[228:231], v[104:107], v[164:167], v[228:231]
    ds_read_b128 v[164:167], v6 offset:35840
    s_waitcnt lgkmcnt(12)
    v_mfma_f32_16x16x32_bf16 v[216:219], v[108:111], v[168:171], v[216:219]
    ds_read_b128 v[168:171], v6 offset:36864
    v_mfma_f32_16x16x32_bf16 v[220:223], v[108:111], v[172:175], v[220:223]
    ds_read_b128 v[172:175], v6 offset:37888
    buffer_load_dwordx4 v[140:143], v5, s[24:27], s53 offen offset:1024 sc1
    v_mfma_f32_16x16x32_bf16 v[224:227], v[108:111], v[176:179], v[224:227]
    ds_read_b128 v[176:179], v6 offset:38912
    v_mfma_f32_16x16x32_bf16 v[228:231], v[108:111], v[180:183], v[228:231]
    ds_read_b128 v[180:183], v6 offset:39936
    s_waitcnt lgkmcnt(12)
    v_mfma_f32_16x16x32_bf16 v[216:219], v[112:115], v[184:187], v[216:219]
    ds_read_b128 v[184:187], v6 offset:40960
    v_mfma_f32_16x16x32_bf16 v[220:223], v[112:115], v[188:191], v[220:223]
    ds_read_b128 v[188:191], v6 offset:41984
    buffer_load_dwordx4 v[144:147], v5, s[24:27], s53 offen offset:2048 sc1
    v_mfma_f32_16x16x32_bf16 v[224:227], v[112:115], v[192:195], v[224:227]
    ds_read_b128 v[192:195], v6 offset:43008
    v_mfma_f32_16x16x32_bf16 v[228:231], v[112:115], v[196:199], v[228:231]
    ds_read_b128 v[196:199], v6 offset:44032
    s_waitcnt lgkmcnt(12)
    v_mfma_f32_16x16x32_bf16 v[216:219], v[116:119], v[200:203], v[216:219]
    ds_read_b128 v[200:203], v6 offset:45056
    v_mfma_f32_16x16x32_bf16 v[220:223], v[116:119], v[204:207], v[220:223]
    ds_read_b128 v[204:207], v6 offset:46080
    buffer_load_dwordx4 v[148:151], v5, s[24:27], s53 offen offset:3072 sc1
    v_mfma_f32_16x16x32_bf16 v[224:227], v[116:119], v[208:211], v[224:227]
    ds_read_b128 v[208:211], v6 offset:47104
    v_mfma_f32_16x16x32_bf16 v[228:231], v[116:119], v[212:215], v[228:231]
    ds_read_b128 v[212:215], v6 offset:48128
    s_waitcnt vmcnt(4)
    v_max3_u32 v234, v120, v124, v128
    v_max_u32 v234, v234, v132
    v_cmp_eq_u32 vcc, -1, v234
    s_cbranch_vccnz L_slow_24
L_ok_23:
    s_waitcnt lgkmcnt(12)
    v_mfma_f32_16x16x32_bf16 v[216:219], v[120:123], v[152:155], v[216:219]
    ds_read_b128 v[152:155], v6 offset:49152
    v_mfma_f32_16x16x32_bf16 v[220:223], v[120:123], v[156:159], v[220:223]
    ds_read_b128 v[156:159], v6 offset:50176
    v_mfma_f32_16x16x32_bf16 v[224:227], v[120:123], v[160:163], v[224:227]
    ds_read_b128 v[160:163], v6 offset:51200
    v_mfma_f32_16x16x32_bf16 v[228:231], v[120:123], v[164:167], v[228:231]
    ds_read_b128 v[164:167], v6 offset:52224
    s_waitcnt lgkmcnt(12)
    v_mfma_f32_16x16x32_bf16 v[216:219], v[124:127], v[168:171], v[216:219]
    ds_read_b128 v[168:171], v6 offset:53248
    v_mfma_f32_16x16x32_bf16 v[220:223], v[124:127], v[172:175], v[220:223]
    ds_read_b128 v[172:175], v6 offset:54272
    v_mfma_f32_16x16x32_bf16 v[224:227], v[124:127], v[176:179], v[224:227]
    ds_read_b128 v[176:179], v6 offset:55296
    v_mfma_f32_16x16x32_bf16 v[228:231], v[124:127], v[180:183], v[228:231]
    ds_read_b128 v[180:183], v6 offset:56320
    s_waitcnt lgkmcnt(12)
    v_mfma_f32_16x16x32_bf16 v[216:219], v[128:131], v[184:187], v[216:219]
    ds_read_b128 v[184:187], v6 offset:57344
    v_mfma_f32_16x16x32_bf16 v[220:223], v[128:131], v[188:191], v[220:223]
    ds_read_b128 v[188:191], v6 offset:58368
    v_mfma_f32_16x16x32_bf16 v[224:227], v[128:131], v[192:195], v[224:227]
    ds_read_b128 v[192:195], v6 offset:59392
    v_mfma_f32_16x16x32_bf16 v[228:231], v[128:131], v[196:199], v[228:231]
    ds_read_b128 v[196:199], v6 offset:60416
    s_waitcnt lgkmcnt(12)
    v_mfma_f32_16x16x32_bf16 v[216:219], v[132:135], v[200:203], v[216:219]
    ds_read_b128 v[200:203], v6 offset:61440
    v_mfma_f32_16x16x32_bf16 v[220:223], v[132:135], v[204:207], v[220:223]
    ds_read_b128 v[204:207], v6 offset:62464
    v_mfma_f32_16x16x32_bf16 v[224:227], v[132:135], v[208:211], v[224:227]
    ds_read_b128 v[208:211], v6 offset:63488
    v_mfma_f32_16x16x32_bf16 v[228:231], v[132:135], v[212:215], v[228:231]
    ds_read_b128 v[212:215], v6 offset:64512
    s_waitcnt vmcnt(0)
    v_max3_u32 v234, v136, v140, v144
    v_max_u32 v234, v234, v148
    v_cmp_eq_u32 vcc, -1, v234
    s_cbranch_vccnz L_slow_26
L_ok_25:
    s_waitcnt lgkmcnt(12)
    v_mfma_f32_16x16x32_bf16 v[216:219], v[136:139], v[152:155], v[216:219]
    v_mfma_f32_16x16x32_bf16 v[220:223], v[136:139], v[156:159], v[220:223]
    v_mfma_f32_16x16x32_bf16 v[224:227], v[136:139], v[160:163], v[224:227]
    v_mfma_f32_16x16x32_bf16 v[228:231], v[136:139], v[164:167], v[228:231]
    s_waitcnt lgkmcnt(8)
    v_mfma_f32_16x16x32_bf16 v[216:219], v[140:143], v[168:171], v[216:219]
    v_mfma_f32_16x16x32_bf16 v[220:223], v[140:143], v[172:175], v[220:223]
    v_mfma_f32_16x16x32_bf16 v[224:227], v[140:143], v[176:179], v[224:227]
    v_mfma_f32_16x16x32_bf16 v[228:231], v[140:143], v[180:183], v[228:231]
    s_waitcnt lgkmcnt(4)
    v_mfma_f32_16x16x32_bf16 v[216:219], v[144:147], v[184:187], v[216:219]
    v_mfma_f32_16x16x32_bf16 v[220:223], v[144:147], v[188:191], v[220:223]
    v_mfma_f32_16x16x32_bf16 v[224:227], v[144:147], v[192:195], v[224:227]
    v_mfma_f32_16x16x32_bf16 v[228:231], v[144:147], v[196:199], v[228:231]
    s_waitcnt lgkmcnt(0)
    v_mfma_f32_16x16x32_bf16 v[216:219], v[148:151], v[200:203], v[216:219]
    v_mfma_f32_16x16x32_bf16 v[220:223], v[148:151], v[204:207], v[220:223]
    v_mfma_f32_16x16x32_bf16 v[224:227], v[148:151], v[208:211], v[224:227]
    v_mfma_f32_16x16x32_bf16 v[228:231], v[148:151], v[212:215], v[228:231]
    s_mul_i32 s50, s48, 266240
    s_lshl_b32 s51, s47, 8
    s_add_u32 s50, s50, s51
    s_lshl_b32 s51, s46, 6
    s_add_u32 s50, s50, s51
    s_add_u32 s50, s50, 8126464
    s_add_u32 s51, s50, 133120
    s_mul_i32 s52, s48, 4224
    s_lshl_b32 s53, s47, 7
    s_add_u32 s52, s52, s53
    s_add_u32 s52, s52, 81920
    s_cmp_eq_u32 s48, 0
    s_cselect_b32 s53, 1, 0
    v_cmp_gt_u32 vcc, s53, v2
    s_nop 1
    v_cndmask_b32 v232, v216, 0, vcc
    v_cndmask_b32 v233, v217, 0, vcc
    v_cndmask_b32 v234, v218, 0, vcc
    v_cndmask_b32 v235, v219, 0, vcc
    v_mul_f32 v232, v232, v232
    v_mul_f32 v233, v233, v233
    v_mul_f32 v234, v234, v234
    v_mul_f32 v235, v235, v235
    v_fmac_f32 v232, v220, v220
    v_fmac_f32 v233, v221, v221
    v_fmac_f32 v234, v222, v222
    v_fmac_f32 v235, v223, v223
    v_fmac_f32 v232, v224, v224
    v_fmac_f32 v233, v225, v225
    v_fmac_f32 v234, v226, v226
    v_fmac_f32 v235, v227, v227
    v_fmac_f32 v232, v228, v228
    v_fmac_f32 v233, v229, v229
    v_fmac_f32 v234, v230, v230
    v_fmac_f32 v235, v231, v231
    v_add_f32_dpp v232, v232, v232 row_ror:8 row_mask:0xf bank_mask:0xf
    v_add_f32_dpp v233, v233, v233 row_ror:8 row_mask:0xf bank_mask:0xf
    v_add_f32_dpp v234, v234, v234 row_ror:8 row_mask:0xf bank_mask:0xf
    v_add_f32_dpp v235, v235, v235 row_ror:8 row_mask:0xf bank_mask:0xf
    v_add_f32_dpp v232, v232, v232 row_ror:4 row_mask:0xf bank_mask:0xf
    v_add_f32_dpp v233, v233, v233 row_ror:4 row_mask:0xf bank_mask:0xf
    v_add_f32_dpp v234, v234, v234 row_ror:4 row_mask:0xf bank_mask:0xf
    v_add_f32_dpp v235, v235, v235 row_ror:4 row_mask:0xf bank_mask:0xf
    v_add_f32_dpp v232, v232, v232 row_ror:2 row_mask:0xf bank_mask:0xf
    v_add_f32_dpp v233, v233, v233 row_ror:2 row_mask:0xf bank_mask:0xf
    v_add_f32_dpp v234, v234, v234 row_ror:2 row_mask:0xf bank_mask:0xf
    v_add_f32_dpp v235, v235, v235 row_ror:2 row_mask:0xf bank_mask:0xf
    v_add_f32_dpp v232, v232, v232 row_ror:1 row_mask:0xf bank_mask:0xf
    v_add_f32_dpp v233, v233, v233 row_ror:1 row_mask:0xf bank_mask:0xf
    v_add_f32_dpp v234, v234, v234 row_ror:1 row_mask:0xf bank_mask:0xf
    v_add_f32_dpp v235, v235, v235 row_ror:1 row_mask:0xf bank_mask:0xf
    v_cvt_pk_bf16_f32 v152, v232, v233
    v_cvt_pk_bf16_f32 v153, v234, v235
    s_lshl_b32 s54, s46, 5
    s_add_u32 s54, s54, 152576
    v_lshl_add_u32 v232, v3, 3, s54
    ds_write_b64 v232, v[152:153]
    v_cvt_pk_bf16_f32 v236, v216, v217
    v_cvt_pk_bf16_f32 v237, v218, v219
    v_cvt_pk_bf16_f32 v238, v220, v221
    v_cvt_pk_bf16_f32 v239, v222, v223
    v_cvt_pk_bf16_f32 v240, v224, v225
    v_cvt_pk_bf16_f32 v241, v226, v227
    v_cvt_pk_bf16_f32 v242, v228, v229
    v_cvt_pk_bf16_f32 v243, v230, v231
    v_permlane16_swap_b32 v236, v238
    v_permlane16_swap_b32 v237, v239
    v_min_u32 v236, -2, v236
    buffer_store_dwordx4 v[236:239], v7, s[24:27], s50 offen sc1
    v_permlane16_swap_b32 v240, v242
    v_permlane16_swap_b32 v241, v243
    v_min_u32 v240, -2, v240
    buffer_store_dwordx4 v[240:243], v7, s[24:27], s51 offen sc1
    v_add_u32 v232, 152576, v5
    s_waitcnt lgkmcnt(0)
    s_barrier
    s_cmp_lg_u32 s46, 0
    s_cbranch_scc1 L_nost2
    s_mov_b64 exec, 0xff
    ds_read_b128 v[152:155], v232
    s_waitcnt lgkmcnt(0)
    v_min_u32 v152, -2, v152
    buffer_store_dwordx4 v[152:155], v5, s[24:27], s52 offen sc1
    s_mov_b64 exec, -1
L_nost2:
    s_lshl_b32 s50, s46, 4
    v_add_u32 v240, s50, v2
    v_lshlrev_b32 v7, 6, v240
    v_lshl_add_u32 v7, v3, 4, v7
    v_lshlrev_b32 v6, 7, v240
    v_lshlrev_b32 v249, 2, v240
    v_lshl_add_u32 v249, v3, 10, v249
    v_lshrrev_b32 v241, 1, v3
    v_lshl_add_u32 v6, v241, 6, v6
    v_and_b32 v241, 1, v3
    v_lshl_add_u32 v6, v241, 4, v6
    v_bfe_u32 v241, v2, 1, 2
    v_bfe_u32 v242, v2, 3, 1
    v_lshlrev_b32 v242, 1, v242
    v_xor_b32 v241, v241, v242
    v_xor_b32 v241, v241, v3
    v_lshlrev_b32 v244, 6, v240
    v_lshl_add_u32 v244, v241, 4, v244
    v_add_u32 v244, 135168, v244
    v_lshrrev_b32 v241, 2, v2
    v_lshl_add_u32 v242, v3, 3, v241
    v_lshlrev_b32 v245, 6, v242
    v_lshrrev_b32 v241, 1, v241
    v_bfe_u32 v242, v0, 1, 1
    v_xor_b32 v241, v241, v242
    v_and_b32 v242, 1, v3
    v_lshl_or_b32 v241, v242, 1, v241
    v_lshl_add_u32 v245, v241, 4, v245
    v_and_b32 v241, 1, v0
    v_lshl_add_u32 v245, v241, 3, v245
    v_add_u32 v245, 135168, v245
    v_xor_b32 v246, 32, v245
    v_mul_u32_u24 v247, 144, v2
    v_lshl_add_u32 v247, v3, 3, v247
    s_lshl_b32 s50, s46, 5
    s_add_u32 s50, s50, 143360
    v_add_u32 v247, s50, v247
    v_lshrrev_b32 v241, 2, v2
    v_lshlrev_b32 v241, 3, v241
    v_and_b32 v242, 3, v2
    v_add_u32 v241, v241, v242
    v_mul_u32_u24 v248, 144, v241
    v_lshl_add_u32 v248, v3, 4, v248
    v_add_u32 v248, 143360, v248
    v_add_u32 v243, 131072, v5
    s_mov_b32 s50, 0x80008000
    s_mov_b32 s56, 0x00003b00
    s_mov_b32 s57, 0x3b000000
    ds_read_b128 v[186:189], v243 offset:0
    ds_read_b128 v[192:195], v243 offset:1024
    ds_read_b128 v[198:201], v243 offset:2048
    ds_read_b128 v[204:207], v243 offset:3072
    v_accvgpr_read_b32 v152, a192
    v_accvgpr_read_b32 v153, a193
    v_accvgpr_read_b32 v154, a194
    v_accvgpr_read_b32 v155, a195
    v_accvgpr_read_b32 v156, a196
    v_accvgpr_read_b32 v157, a197
    v_accvgpr_read_b32 v158, a198
    v_accvgpr_read_b32 v159, a199
    v_accvgpr_read_b32 v160, a200
    v_accvgpr_read_b32 v161, a201
    v_accvgpr_read_b32 v162, a202
    v_accvgpr_read_b32 v163, a203
    v_accvgpr_read_b32 v164, a204
    v_accvgpr_read_b32 v165, a205
    v_accvgpr_read_b32 v166, a206
    v_accvgpr_read_b32 v167, a207
    v_accvgpr_read_b32 v208, a248
    v_accvgpr_read_b32 v209, a249
    v_accvgpr_read_b32 v210, a250
    v_accvgpr_read_b32 v211, a251
    v_accvgpr_read_b32 v212, a252
    v_accvgpr_read_b32 v213, a253
    v_accvgpr_read_b32 v214, a254
    v_accvgpr_read_b32 v215, a255
    v_xor_b32 v208, s50, v208
    v_xor_b32 v209, s50, v209
    v_xor_b32 v210, s50, v210
    v_xor_b32 v211, s50, v211
    v_xor_b32 v212, s50, v212
    v_xor_b32 v213, s50, v213
    v_xor_b32 v214, s50, v214
    v_xor_b32 v215, s50, v215
    s_waitcnt vmcnt(0)
    s_barrier
    v_accvgpr_read_b32 v168, a224
    v_accvgpr_read_b32 v169, a225
    v_accvgpr_read_b32 v170, a226
    v_accvgpr_read_b32 v171, a227
    v_accvgpr_read_b32 v172, a228
    v_accvgpr_read_b32 v173, a229
    v_accvgpr_read_b32 v174, a230
    v_accvgpr_read_b32 v175, a231
    v_accvgpr_read_b32 v176, a232
    v_accvgpr_read_b32 v177, a233
    v_accvgpr_read_b32 v178, a234
    v_accvgpr_read_b32 v179, a235
    v_accvgpr_read_b32 v180, a236
    v_accvgpr_read_b32 v181, a237
    v_accvgpr_read_b32 v182, a238
    v_accvgpr_read_b32 v183, a239
    s_waitcnt lgkmcnt(0)
    v_xor_b32 v184, s50, v188
    v_xor_b32 v185, s50, v189
    v_xor_b32 v190, s50, v194
    v_xor_b32 v191, s50, v195
    v_xor_b32 v196, s50, v200
    v_xor_b32 v197, s50, v201
    v_xor_b32 v202, s50, v206
    v_xor_b32 v203, s50, v207
    v_mov_b32 v144, 0x3727c5ac
    v_mov_b32 v145, 0x3727c5ac
    v_mov_b32 v146, 0x3727c5ac
    v_mov_b32 v147, 0x3727c5ac
    v_mov_b32 v148, 0x3727c5ac
    v_mov_b32 v149, 0x3727c5ac
    v_mov_b32 v150, 0x3727c5ac
    v_mov_b32 v151, 0x3727c5ac
    s_cmp_eq_u32 s2, 0
    s_cselect_b32 s58, 0, -1
    s_cselect_b32 s51, 32, 0
    s_mul_i32 s52, s2, 8320
    s_add_u32 s54, s52, 8126464
    s_add_u32 s54, s54, s51
    s_xor_b32 s55, s54, 32
    s_mov_b32 s53, 81920
    buffer_load_dwordx4 v[96:99], v7, s[24:27], s53 offen sc1
    s_mov_b32 s53, 86144
    buffer_load_dwordx4 v[100:103], v7, s[24:27], s53 offen sc1
    buffer_load_dwordx4 v[88:91], v6, s[24:27], s54 offen sc1
    buffer_load_dwordx4 v[92:95], v6, s[24:27], s55 offen sc1
    s_mov_b32 s53, 90368
    buffer_load_dwordx4 v[104:107], v7, s[24:27], s53 offen sc1
    s_mov_b32 s53, 94592
    buffer_load_dwordx4 v[108:111], v7, s[24:27], s53 offen sc1
    s_mov_b32 s53, 98816
    buffer_load_dwordx4 v[112:115], v7, s[24:27], s53 offen sc1
    s_mov_b32 s53, 103040
    buffer_load_dwordx4 v[116:119], v7, s[24:27], s53 offen sc1
    s_mov_b32 s53, 107264
    buffer_load_dwordx4 v[120:123], v7, s[24:27], s53 offen sc1
    s_mov_b32 s53, 111488
    buffer_load_dwordx4 v[124:127], v7, s[24:27], s53 offen sc1
    s_waitcnt vmcnt(9)
    v_dot2_f32_bf16 v144, v96, s56, v144
    v_dot2_f32_bf16 v145, v96, s57, v145
    v_dot2_f32_bf16 v146, v97, s56, v146
    v_dot2_f32_bf16 v147, v97, s57, v147
    v_dot2_f32_bf16 v148, v98, s56, v148
    v_dot2_f32_bf16 v149, v98, s57, v149
    v_dot2_f32_bf16 v150, v99, s56, v150
    v_dot2_f32_bf16 v151, v99, s57, v151
    s_waitcnt vmcnt(8)
    v_dot2_f32_bf16 v144, v100, s56, v144
    v_dot2_f32_bf16 v145, v100, s57, v145
    v_dot2_f32_bf16 v146, v101, s56, v146
    v_dot2_f32_bf16 v147, v101, s57, v147
    v_dot2_f32_bf16 v148, v102, s56, v148
    v_dot2_f32_bf16 v149, v102, s57, v149
    v_dot2_f32_bf16 v150, v103, s56, v150
    v_dot2_f32_bf16 v151, v103, s57, v151
    s_waitcnt vmcnt(6)
    v_lshlrev_b32 v128, 16, v88
    v_and_b32 v129, 0xffff0000, v88
    v_lshlrev_b32 v130, 16, v89
    v_and_b32 v131, 0xffff0000, v89
    v_lshlrev_b32 v132, 16, v90
    v_and_b32 v133, 0xffff0000, v90
    v_lshlrev_b32 v134, 16, v91
    v_and_b32 v135, 0xffff0000, v91
    v_xor_b32 v240, s50, v92
    v_lshlrev_b32 v136, 16, v240
    v_and_b32 v137, 0xffff0000, v240
    v_xor_b32 v240, s50, v93
    v_lshlrev_b32 v138, 16, v240
    v_and_b32 v139, 0xffff0000, v240
    v_xor_b32 v240, s50, v94
    v_lshlrev_b32 v140, 16, v240
    v_and_b32 v141, 0xffff0000, v240
    v_xor_b32 v240, s50, v95
    v_lshlrev_b32 v142, 16, v240
    v_and_b32 v143, 0xffff0000, v240
    v_max3_u32 v241, v96, v100, v88
    s_waitcnt vmcnt(5)
    v_dot2_f32_bf16 v144, v104, s56, v144
    v_dot2_f32_bf16 v145, v104, s57, v145
    v_dot2_f32_bf16 v146, v105, s56, v146
    v_dot2_f32_bf16 v147, v105, s57, v147
    v_dot2_f32_bf16 v148, v106, s56, v148
    v_dot2_f32_bf16 v149, v106, s57, v149
    v_dot2_f32_bf16 v150, v107, s56, v150
    v_dot2_f32_bf16 v151, v107, s57, v151
    v_max3_u32 v241, v241, v92, v104
    s_waitcnt vmcnt(4)
    v_dot2_f32_bf16 v144, v108, s56, v144
    v_dot2_f32_bf16 v145, v108, s57, v145
    v_dot2_f32_bf16 v146, v109, s56, v146
    v_dot2_f32_bf16 v147, v109, s57, v147
    v_dot2_f32_bf16 v148, v110, s56, v148
    v_dot2_f32_bf16 v149, v110, s57, v149
    v_dot2_f32_bf16 v150, v111, s56, v150
    v_dot2_f32_bf16 v151, v111, s57, v151
    s_waitcnt vmcnt(3)
    v_dot2_f32_bf16 v144, v112, s56, v144
    v_dot2_f32_bf16 v145, v112, s57, v145
    v_dot2_f32_bf16 v146, v113, s56, v146
    v_dot2_f32_bf16 v147, v113, s57, v147
    v_dot2_f32_bf16 v148, v114, s56, v148
    v_dot2_f32_bf16 v149, v114, s57, v149
    v_dot2_f32_bf16 v150, v115, s56, v150
    v_dot2_f32_bf16 v151, v115, s57, v151
    v_max3_u32 v241, v241, v108, v112
    s_waitcnt vmcnt(2)
    v_dot2_f32_bf16 v144, v116, s56, v144
    v_dot2_f32_bf16 v145, v116, s57, v145
    v_dot2_f32_bf16 v146, v117, s56, v146
    v_dot2_f32_bf16 v147, v117, s57, v147
    v_dot2_f32_bf16 v148, v118, s56, v148
    v_dot2_f32_bf16 v149, v118, s57, v149
    v_dot2_f32_bf16 v150, v119, s56, v150
    v_dot2_f32_bf16 v151, v119, s57, v151
    s_waitcnt vmcnt(1)
    v_dot2_f32_bf16 v144, v120, s56, v144
    v_dot2_f32_bf16 v145, v120, s57, v145
    v_dot2_f32_bf16 v146, v121, s56, v146
    v_dot2_f32_bf16 v147, v121, s57, v147
    v_dot2_f32_bf16 v148, v122, s56, v148
    v_dot2_f32_bf16 v149, v122, s57, v149
    v_dot2_f32_bf16 v150, v123, s56, v150
    v_dot2_f32_bf16 v151, v123, s57, v151
    v_max3_u32 v241, v241, v116, v120
    s_waitcnt vmcnt(0)
    v_dot2_f32_bf16 v144, v124, s56, v144
    v_dot2_f32_bf16 v145, v124, s57, v145
    v_dot2_f32_bf16 v146, v125, s56, v146
    v_dot2_f32_bf16 v147, v125, s57, v147
    v_dot2_f32_bf16 v148, v126, s56, v148
    v_dot2_f32_bf16 v149, v126, s57, v149
    v_dot2_f32_bf16 v150, v127, s56, v150
    v_dot2_f32_bf16 v151, v127, s57, v151
    v_max_u32 v241, v241, v124
    v_cmp_eq_u32 vcc, -1, v241
    s_cbranch_vccnz L_slow_28
L_ok_27:
    v_rsq_f32 v144, v144
    v_rsq_f32 v145, v145
    v_rsq_f32 v146, v146
    v_rsq_f32 v147, v147
    v_rsq_f32 v148, v148
    v_rsq_f32 v149, v149
    v_rsq_f32 v150, v150
    v_rsq_f32 v151, v151
    v_pk_mul_f32 v[112:113], v[128:129], v[144:145]
    v_pk_mul_f32 v[114:115], v[130:131], v[146:147]
    v_pk_mul_f32 v[116:117], v[132:133], v[148:149]
    v_pk_mul_f32 v[118:119], v[134:135], v[150:151]
    v_cvt_pk_bf16_f32 v232, v112, v113
    v_cvt_pk_bf16_f32 v233, v114, v115
    v_cvt_pk_bf16_f32 v234, v116, v117
    v_cvt_pk_bf16_f32 v235, v118, v119
    ds_write_b128 v244, v[232:235]
    v_pk_mul_f32 v[120:121], v[136:137], v[144:145] neg_lo:[1,0] neg_hi:[1,0]
    v_pk_mul_f32 v[122:123], v[138:139], v[146:147] neg_lo:[1,0] neg_hi:[1,0]
    v_pk_mul_f32 v[124:125], v[140:141], v[148:149] neg_lo:[1,0] neg_hi:[1,0]
    v_pk_mul_f32 v[126:127], v[142:143], v[150:151] neg_lo:[1,0] neg_hi:[1,0]
    v_cvt_pk_bf16_f32 v236, v120, v121
    v_cvt_pk_bf16_f32 v237, v122, v123
    v_cvt_pk_bf16_f32 v238, v124, v125
    v_cvt_pk_bf16_f32 v239, v126, v127
    v_and_b32 v236, s58, v236
    v_and_b32 v237, s58, v237
    v_and_b32 v238, s58, v238
    v_and_b32 v239, s58, v239
    ds_write_b128 v244, v[236:239] offset:4096
    s_waitcnt lgkmcnt(0)
    s_barrier
    ds_read_b64_tr_b16 v[96:97], v245 offset:0
    ds_read_b64_tr_b16 v[98:99], v246 offset:256
    ds_read_b64_tr_b16 v[100:101], v245 offset:2048
    ds_read_b64_tr_b16 v[102:103], v246 offset:2304
    ds_read_b64_tr_b16 v[104:105], v245 offset:4096
    ds_read_b64_tr_b16 v[106:107], v246 offset:4352
    ds_read_b64_tr_b16 v[108:109], v245 offset:6144
    ds_read_b64_tr_b16 v[110:111], v246 offset:6400
    ds_read_b64_tr_b16 v[112:113], v246 offset:0
    ds_read_b64_tr_b16 v[114:115], v245 offset:256
    ds_read_b64_tr_b16 v[116:117], v246 offset:2048
    ds_read_b64_tr_b16 v[118:119], v245 offset:2304
    ds_read_b64_tr_b16 v[120:121], v246 offset:4096
    ds_read_b64_tr_b16 v[122:123], v245 offset:4352
    ds_read_b64_tr_b16 v[124:125], v246 offset:6144
    ds_read_b64_tr_b16 v[126:127], v245 offset:6400
    s_waitcnt lgkmcnt(14)
    v_mfma_f32_16x16x32_bf16 v[216:219], v[96:99], a[240:243], 0
    v_mfma_f32_16x16x32_bf16 v[224:227], v[96:99], v[208:211], 0
    s_waitcnt lgkmcnt(12)
    v_mfma_f32_16x16x32_bf16 v[216:219], v[100:103], a[244:247], v[216:219]
    v_mfma_f32_16x16x32_bf16 v[224:227], v[100:103], v[212:215], v[224:227]
    s_waitcnt lgkmcnt(10)
    v_mfma_f32_16x16x32_bf16 v[216:219], v[104:107], a[248:251], v[216:219]
    v_mfma_f32_16x16x32_bf16 v[224:227], v[104:107], a[240:243], v[224:227]
    s_waitcnt lgkmcnt(8)
    v_mfma_f32_16x16x32_bf16 v[216:219], v[108:111], a[252:255], v[216:219]
    v_mfma_f32_16x16x32_bf16 v[224:227], v[108:111], a[244:247], v[224:227]
    s_waitcnt lgkmcnt(6)
    v_mfma_f32_16x16x32_bf16 v[220:223], v[112:115], a[240:243], 0
    v_mfma_f32_16x16x32_bf16 v[228:231], v[112:115], v[208:211], 0
    s_waitcnt lgkmcnt(4)
    v_mfma_f32_16x16x32_bf16 v[220:223], v[116:119], a[244:247], v[220:223]
    v_mfma_f32_16x16x32_bf16 v[228:231], v[116:119], v[212:215], v[228:231]
    s_waitcnt lgkmcnt(2)
    v_mfma_f32_16x16x32_bf16 v[220:223], v[120:123], a[248:251], v[220:223]
    v_mfma_f32_16x16x32_bf16 v[228:231], v[120:123], a[240:243], v[228:231]
    s_waitcnt lgkmcnt(0)
    v_mfma_f32_16x16x32_bf16 v[220:223], v[124:127], a[252:255], v[220:223]
    v_mfma_f32_16x16x32_bf16 v[228:231], v[124:127], a[244:247], v[228:231]
    v_pk_mul_f32 v[240:241], v[224:225], v[160:161]
    v_pk_mul_f32 v[242:243], v[216:217], v[160:161]
    v_pk_fma_f32 v[216:217], v[216:217], v[152:153], v[240:241] neg_lo:[0,0,1] neg_hi:[0,0,1]
    v_pk_fma_f32 v[224:225], v[224:225], v[152:153], v[242:243]
    v_pk_mul_f32 v[240:241], v[226:227], v[162:163]
    v_pk_mul_f32 v[242:243], v[218:219], v[162:163]
    v_pk_fma_f32 v[218:219], v[218:219], v[154:155], v[240:241] neg_lo:[0,0,1] neg_hi:[0,0,1]
    v_pk_fma_f32 v[226:227], v[226:227], v[154:155], v[242:243]
    v_cvt_pk_bf16_f32 v232, v216, v217
    v_cvt_pk_bf16_f32 v233, v218, v219
    v_cvt_pk_bf16_f32 v234, v224, v225
    v_cvt_pk_bf16_f32 v235, v226, v227
    v_pk_mul_f32 v[240:241], v[228:229], v[164:165]
    v_pk_mul_f32 v[242:243], v[220:221], v[164:165]
    v_pk_fma_f32 v[220:221], v[220:221], v[156:157], v[240:241] neg_lo:[0,0,1] neg_hi:[0,0,1]
    v_pk_fma_f32 v[228:229], v[228:229], v[156:157], v[242:243]
    v_pk_mul_f32 v[240:241], v[230:231], v[166:167]
    v_pk_mul_f32 v[242:243], v[222:223], v[166:167]
    v_pk_fma_f32 v[222:223], v[222:223], v[158:159], v[240:241] neg_lo:[0,0,1] neg_hi:[0,0,1]
    v_pk_fma_f32 v[230:231], v[230:231], v[158:159], v[242:243]
    v_cvt_pk_bf16_f32 v236, v220, v221
    v_cvt_pk_bf16_f32 v237, v222, v223
    v_cvt_pk_bf16_f32 v238, v228, v229
    v_cvt_pk_bf16_f32 v239, v230, v231
    v_mfma_f32_16x16x32_bf16 v[96:99], v[186:189], v[232:235], 0
    v_mfma_f32_16x16x32_bf16 v[104:107], v[184:187], v[232:235], 0
    v_mfma_f32_16x16x32_bf16 v[96:99], v[192:195], v[236:239], v[96:99]
    v_mfma_f32_16x16x32_bf16 v[104:107], v[190:193], v[236:239], v[104:107]
    v_mfma_f32_16x16x32_bf16 v[100:103], v[198:201], v[232:235], 0
    v_mfma_f32_16x16x32_bf16 v[108:111], v[196:199], v[232:235], 0
    v_mfma_f32_16x16x32_bf16 v[100:103], v[204:207], v[236:239], v[100:103]
    v_mfma_f32_16x16x32_bf16 v[108:111], v[202:205], v[236:239], v[108:111]
    v_accvgpr_read_b32 v152, a208
    v_accvgpr_read_b32 v153, a209
    v_accvgpr_read_b32 v154, a210
    v_accvgpr_read_b32 v155, a211
    v_accvgpr_read_b32 v156, a212
    v_accvgpr_read_b32 v157, a213
    v_accvgpr_read_b32 v158, a214
    v_accvgpr_read_b32 v159, a215
    v_accvgpr_read_b32 v160, a216
    v_accvgpr_read_b32 v161, a217
    v_accvgpr_read_b32 v162, a218
    v_accvgpr_read_b32 v163, a219
    v_accvgpr_read_b32 v164, a220
    v_accvgpr_read_b32 v165, a221
    v_accvgpr_read_b32 v166, a222
    v_accvgpr_read_b32 v167, a223
    v_pk_mul_f32 v[240:241], v[104:105], v[176:177]
    v_pk_mul_f32 v[242:243], v[96:97], v[176:177]
    v_pk_fma_f32 v[96:97], v[96:97], v[168:169], v[240:241] neg_lo:[0,0,1] neg_hi:[0,0,1]
    v_pk_fma_f32 v[104:105], v[104:105], v[168:169], v[242:243] neg_lo:[1,0,1] neg_hi:[1,0,1]
    v_pk_mul_f32 v[240:241], v[106:107], v[178:179]
    v_pk_mul_f32 v[242:243], v[98:99], v[178:179]
    v_pk_fma_f32 v[98:99], v[98:99], v[170:171], v[240:241] neg_lo:[0,0,1] neg_hi:[0,0,1]
    v_pk_fma_f32 v[106:107], v[106:107], v[170:171], v[242:243] neg_lo:[1,0,1] neg_hi:[1,0,1]
    v_cvt_pk_bf16_f32 v232, v96, v97
    v_cvt_pk_bf16_f32 v233, v98, v99
    v_cvt_pk_bf16_f32 v234, v104, v105
    v_cvt_pk_bf16_f32 v235, v106, v107
    v_pk_mul_f32 v[240:241], v[108:109], v[180:181]
    v_pk_mul_f32 v[242:243], v[100:101], v[180:181]
    v_pk_fma_f32 v[100:101], v[100:101], v[172:173], v[240:241] neg_lo:[0,0,1] neg_hi:[0,0,1]
    v_pk_fma_f32 v[108:109], v[108:109], v[172:173], v[242:243] neg_lo:[1,0,1] neg_hi:[1,0,1]
    v_pk_mul_f32 v[240:241], v[110:111], v[182:183]
    v_pk_mul_f32 v[242:243], v[102:103], v[182:183]
    v_pk_fma_f32 v[102:103], v[102:103], v[174:175], v[240:241] neg_lo:[0,0,1] neg_hi:[0,0,1]
    v_pk_fma_f32 v[110:111], v[110:111], v[174:175], v[242:243] neg_lo:[1,0,1] neg_hi:[1,0,1]
    v_cvt_pk_bf16_f32 v236, v100, v101
    v_cvt_pk_bf16_f32 v237, v102, v103
    v_cvt_pk_bf16_f32 v238, v108, v109
    v_cvt_pk_bf16_f32 v239, v110, v111
    v_mfma_f32_16x16x32_bf16 v[216:219], v[232:235], v[186:189], 0
    v_mfma_f32_16x16x32_bf16 v[224:227], v[232:235], v[184:187], 0
    v_mfma_f32_16x16x32_bf16 v[216:219], v[236:239], v[192:195], v[216:219]
    v_mfma_f32_16x16x32_bf16 v[224:227], v[236:239], v[190:193], v[224:227]
    v_mfma_f32_16x16x32_bf16 v[220:223], v[232:235], v[198:201], 0
    v_mfma_f32_16x16x32_bf16 v[228:231], v[232:235], v[196:199], 0
    v_mfma_f32_16x16x32_bf16 v[220:223], v[236:239], v[204:207], v[220:223]
    v_mfma_f32_16x16x32_bf16 v[228:231], v[236:239], v[202:205], v[228:231]
    s_mul_i32 s52, s2, 8448
    s_add_u32 s54, s52, 10485760
    s_add_u32 s55, s54, 4224
    s_cmp_eq_u32 s2, 0
    s_cselect_b32 s52, s55, s54
    s_cselect_b32 s53, s54, s55
    v_pk_mul_f32 v[240:241], v[224:225], v[160:161]
    v_pk_mul_f32 v[242:243], v[216:217], v[160:161]
    v_pk_fma_f32 v[216:217], v[216:217], v[152:153], v[240:241] neg_lo:[0,0,1] neg_hi:[0,0,1]
    v_pk_fma_f32 v[224:225], v[224:225], v[152:153], v[242:243]
    v_pk_mul_f32 v[240:241], v[226:227], v[162:163]
    v_pk_mul_f32 v[242:243], v[218:219], v[162:163]
    v_pk_fma_f32 v[218:219], v[218:219], v[154:155], v[240:241] neg_lo:[0,0,1] neg_hi:[0,0,1]
    v_pk_fma_f32 v[226:227], v[226:227], v[154:155], v[242:243]
    v_cvt_pk_bf16_f32 v232, v216, v217
    v_cvt_pk_bf16_f32 v233, v218, v219
    v_cvt_pk_bf16_f32 v234, v224, v225
    v_cvt_pk_bf16_f32 v235, v226, v227
    ds_write_b64 v247, v[232:233] offset:0
    ds_write_b64 v247, v[234:235] offset:4608
    v_pk_mul_f32 v[240:241], v[228:229], v[164:165]
    v_pk_mul_f32 v[242:243], v[220:221], v[164:165]
    v_pk_fma_f32 v[220:221], v[220:221], v[156:157], v[240:241] neg_lo:[0,0,1] neg_hi:[0,0,1]
    v_pk_fma_f32 v[228:229], v[228:229], v[156:157], v[242:243]
    v_pk_mul_f32 v[240:241], v[230:231], v[166:167]
    v_pk_mul_f32 v[242:243], v[222:223], v[166:167]
    v_pk_fma_f32 v[222:223], v[222:223], v[158:159], v[240:241] neg_lo:[0,0,1] neg_hi:[0,0,1]
    v_pk_fma_f32 v[230:231], v[230:231], v[158:159], v[242:243]
    v_cvt_pk_bf16_f32 v236, v220, v221
    v_cvt_pk_bf16_f32 v237, v222, v223
    v_cvt_pk_bf16_f32 v238, v228, v229
    v_cvt_pk_bf16_f32 v239, v230, v231
    ds_write_b64 v247, v[236:237] offset:2304
    ds_write_b64 v247, v[238:239] offset:6912
    s_waitcnt lgkmcnt(0)
    s_barrier
    ds_read_b128 v[96:99], v248 offset:0
    ds_read_b128 v[112:115], v248 offset:576
    ds_read_b128 v[100:103], v248 offset:64
    ds_read_b128 v[116:119], v248 offset:640
    ds_read_b128 v[104:107], v248 offset:4608
    ds_read_b128 v[120:123], v248 offset:5184
    ds_read_b128 v[108:111], v248 offset:4672
    ds_read_b128 v[124:127], v248 offset:5248
    s_waitcnt lgkmcnt(6)
    v_mfma_f32_16x16x32_bf16 v[128:131], v[96:99], a[240:243], v[128:131]
    v_mfma_f32_16x16x32_bf16 v[132:135], v[112:115], a[240:243], v[132:135]
    s_waitcnt lgkmcnt(4)
    v_mfma_f32_16x16x32_bf16 v[128:131], v[100:103], a[244:247], v[128:131]
    v_mfma_f32_16x16x32_bf16 v[132:135], v[116:119], a[244:247], v[132:135]
    s_waitcnt lgkmcnt(2)
    v_mfma_f32_16x16x32_bf16 v[128:131], v[104:107], a[248:251], v[128:131]
    v_mfma_f32_16x16x32_bf16 v[132:135], v[120:123], a[248:251], v[132:135]
    s_waitcnt lgkmcnt(0)
    v_mfma_f32_16x16x32_bf16 v[128:131], v[108:111], a[252:255], v[128:131]
    v_mfma_f32_16x16x32_bf16 v[132:135], v[124:127], a[252:255], v[132:135]
    v_mfma_f32_16x16x32_bf16 v[136:139], v[96:99], v[208:211], v[136:139]
    v_mfma_f32_16x16x32_bf16 v[140:143], v[112:115], v[208:211], v[140:143]
    v_mfma_f32_16x16x32_bf16 v[136:139], v[100:103], v[212:215], v[136:139]
    v_mfma_f32_16x16x32_bf16 v[140:143], v[116:119], v[212:215], v[140:143]
    v_mfma_f32_16x16x32_bf16 v[136:139], v[104:107], a[240:243], v[136:139]
    v_mfma_f32_16x16x32_bf16 v[140:143], v[120:123], a[240:243], v[140:143]
    v_mfma_f32_16x16x32_bf16 v[136:139], v[108:111], a[244:247], v[136:139]
    v_mfma_f32_16x16x32_bf16 v[140:143], v[124:127], a[244:247], v[140:143]
    v_cvt_pk_bf16_f32 v232, v128, v129
    v_cvt_pk_bf16_f32 v233, v130, v131
    v_cvt_pk_bf16_f32 v234, v132, v133
    v_cvt_pk_bf16_f32 v235, v134, v135
    v_min_u32 v232, -2, v232
    buffer_store_dwordx4 v[232:235], v7, s[24:27], s52 offen sc1
    s_nop 0
    v_cvt_pk_bf16_f32 v236, -v136, -v137
    v_cvt_pk_bf16_f32 v237, -v138, -v139
    v_cvt_pk_bf16_f32 v238, -v140, -v141
    v_cvt_pk_bf16_f32 v239, -v142, -v143
    v_bfi_b32 v236, s58, v236, v92
    v_bfi_b32 v237, s58, v237, v93
    v_bfi_b32 v238, s58, v238, v94
    v_bfi_b32 v239, s58, v239, v95
    v_min_u32 v236, -2, v236
    buffer_store_dwordx4 v[236:239], v7, s[24:27], s53 offen sc1
    s_waitcnt vmcnt(0)
    s_barrier
    v_lshrrev_b32 v248, 3, v1
    v_mul_u32_u24 v6, 4224, v248
    v_bfe_u32 v248, v1, 1, 2
    v_bfe_u32 v249, v1, 4, 1
    v_xor_b32 v248, v248, v249
    s_and_b32 s54, s46, 1
    s_lshl_b32 s54, s54, 1
    v_xor_b32 v248, s54, v248
    v_lshl_add_u32 v6, v248, 5, v6
    v_and_b32 v248, 1, v1
    v_lshl_add_u32 v6, v248, 4, v6
    s_lshl_b32 s55, s48, 2
    s_add_u32 s55, s55, s46
    s_lshl_b32 s54, s47, 7
    s_add_u32 s54, s54, 10485760
    s_add_u32 s50, s55, 0
    s_and_b32 s50, s50, 15
    s_lshl_b32 s50, s50, 10
    v_add_u32 v240, s50, v5
    s_add_u32 s51, s55, 4
    s_and_b32 s51, s51, 15
    s_lshl_b32 s51, s51, 10
    v_add_u32 v241, s51, v5
    s_add_u32 s52, s55, 8
    s_and_b32 s52, s52, 15
    s_lshl_b32 s52, s52, 10
    v_add_u32 v242, s52, v5
    s_add_u32 s53, s55, 12
    s_and_b32 s53, s53, 15
    s_lshl_b32 s53, s53, 10
    v_add_u32 v243, s53, v5
    v_lshrrev_b32 v248, 2, v2
    v_lshl_add_u32 v249, v3, 3, v248
    v_lshlrev_b32 v244, 7, v249
    v_lshrrev_b32 v248, 1, v248
    v_and_b32 v249, 1, v3
    v_lshl_or_b32 v248, v249, 1, v248
    v_lshl_add_u32 v244, v248, 5, v244
    v_and_b32 v248, 3, v0
    v_lshl_add_u32 v244, v248, 3, v244
    v_xor_b32 v245, 32, v244
    v_xor_b32 v246, 64, v244
    v_xor_b32 v247, 96, v244
    s_lshl_b32 s55, s46, 5
    v_xor_b32 v7, s55, v244
    v_cmp_gt_u32 vcc, 16, v1
    v_mov_b32 v138, 0xffff0000
    s_nop 0
    v_cndmask_b32 v138, -1, v138, vcc
    v_and_b32 v248, 3, v1
    v_cmp_eq_u32 s[10:11], 1, v248
    v_cmp_eq_u32 s[12:13], 2, v248
    v_cmp_eq_u32 s[14:15], 3, v248
    s_add_u32 s32, s20, 25165824
    s_addc_u32 s33, s21, 0
    s_mov_b32 s34, 4194304
    s_mov_b32 s35, 0x20000
    s_lshl_b32 s62, s48, 16
    s_lshl_b32 s63, s46, 14
    s_add_u32 s62, s62, s63
    s_add_u32 s62, s62, 15466496
    s_add_u32 s63, s63, 65536
    s_mul_i32 s55, s50, 33
    s_add_u32 m0, s50, 0
    s_add_u32 s55, s55, s54
    s_add_u32 s55, s55, 0
    buffer_load_dwordx4 v6, s[24:27], s55 offen sc1 lds
    s_mul_i32 s55, s51, 33
    s_add_u32 m0, s51, 0
    s_add_u32 s55, s55, s54
    s_add_u32 s55, s55, 0
    buffer_load_dwordx4 v6, s[24:27], s55 offen sc1 lds
    s_mul_i32 s55, s52, 33
    s_add_u32 m0, s52, 0
    s_add_u32 s55, s55, s54
    s_add_u32 s55, s55, 0
    buffer_load_dwordx4 v6, s[24:27], s55 offen sc1 lds
    s_mul_i32 s55, s53, 33
    s_add_u32 m0, s53, 0
    s_add_u32 s55, s55, s54
    s_add_u32 s55, s55, 0
    buffer_load_dwordx4 v6, s[24:27], s55 offen sc1 lds
    s_mul_i32 s55, s50, 33
    s_add_u32 m0, s50, 16384
    s_add_u32 s55, s55, s54
    s_add_u32 s55, s55, 540672
    buffer_load_dwordx4 v6, s[24:27], s55 offen sc1 lds
    s_mul_i32 s55, s51, 33
    s_add_u32 m0, s51, 16384
    s_add_u32 s55, s55, s54
    s_add_u32 s55, s55, 540672
    buffer_load_dwordx4 v6, s[24:27], s55 offen sc1 lds
    s_mul_i32 s55, s52, 33
    s_add_u32 m0, s52, 16384
    s_add_u32 s55, s55, s54
    s_add_u32 s55, s55, 540672
    buffer_load_dwordx4 v6, s[24:27], s55 offen sc1 lds
    s_mul_i32 s55, s53, 33
    s_add_u32 m0, s53, 16384
    s_add_u32 s55, s55, s54
    s_add_u32 s55, s55, 540672
    buffer_load_dwordx4 v6, s[24:27], s55 offen sc1 lds
    s_waitcnt vmcnt(4)
    ds_read_b32 v128, v240 offset:0
    ds_read_b32 v129, v241 offset:0
    ds_read_b32 v130, v242 offset:0
    ds_read_b32 v131, v243 offset:0
    s_mul_i32 s55, s50, 33
    s_add_u32 m0, s50, 32768
    s_add_u32 s55, s55, s54
    s_add_u32 s55, s55, 1081344
    buffer_load_dwordx4 v6, s[24:27], s55 offen sc1 lds
    s_mul_i32 s55, s51, 33
    s_add_u32 m0, s51, 32768
    s_add_u32 s55, s55, s54
    s_add_u32 s55, s55, 1081344
    buffer_load_dwordx4 v6, s[24:27], s55 offen sc1 lds
    s_mul_i32 s55, s52, 33
    s_add_u32 m0, s52, 32768
    s_add_u32 s55, s55, s54
    s_add_u32 s55, s55, 1081344
    buffer_load_dwordx4 v6, s[24:27], s55 offen sc1 lds
    s_mul_i32 s55, s53, 33
    s_add_u32 m0, s53, 32768
    s_add_u32 s55, s55, s54
    s_add_u32 s55, s55, 1081344
    buffer_load_dwordx4 v6, s[24:27], s55 offen sc1 lds
    s_waitcnt lgkmcnt(0)
    v_max3_u32 v248, v128, v129, v130
    v_max_u32 v248, v248, v131
    v_cmp_eq_u32 vcc, -1, v248
    s_cbranch_vccnz L_slow_30
L_ok_29:
    s_barrier
    ds_read_b64_tr_b16 v[184:185], v7 offset:0
    ds_read_b64_tr_b16 v[186:187], v7 offset:512
    ds_read_b64_tr_b16 v[152:153], v244 offset:0
    ds_read_b64_tr_b16 v[154:155], v244 offset:512
    ds_read_b64_tr_b16 v[156:157], v245 offset:0
    ds_read_b64_tr_b16 v[158:159], v245 offset:512
    ds_read_b64_tr_b16 v[160:161], v246 offset:0
    ds_read_b64_tr_b16 v[162:163], v246 offset:512
    ds_read_b64_tr_b16 v[164:165], v247 offset:0
    ds_read_b64_tr_b16 v[166:167], v247 offset:512
    s_waitcnt lgkmcnt(0)
    v_and_b32 v184, v138, v184
    v_mfma_f32_16x16x32_bf16 v[192:195], a[64:67], v[152:155], 0
    ds_read_b64_tr_b16 v[168:169], v244 offset:4096
    v_mfma_f32_16x16x32_bf16 v[196:199], a[64:67], v[156:159], 0
    ds_read_b64_tr_b16 v[170:171], v244 offset:4608
    v_mfma_f32_16x16x32_bf16 v[148:151], v[184:187], v[184:187], 0
    ds_read_b64_tr_b16 v[172:173], v245 offset:4096
    s_mul_i32 s55, s50, 33
    s_add_u32 m0, s50, 49152
    s_add_u32 s55, s55, s54
    s_add_u32 s55, s55, 1622016
    buffer_load_dwordx4 v6, s[24:27], s55 offen sc1 lds
    v_mfma_f32_16x16x32_bf16 v[200:203], a[64:67], v[160:163], 0
    ds_read_b64_tr_b16 v[174:175], v245 offset:4608
    v_mfma_f32_16x16x32_bf16 v[204:207], a[64:67], v[164:167], 0
    ds_read_b64_tr_b16 v[176:177], v246 offset:4096
    v_mfma_f32_16x16x32_bf16 v[208:211], v[152:155], a[128:131], 0
    ds_read_b64_tr_b16 v[178:179], v246 offset:4608
    s_mul_i32 s55, s51, 33
    s_add_u32 m0, s51, 49152
    s_add_u32 s55, s55, s54
    s_add_u32 s55, s55, 1622016
    buffer_load_dwordx4 v6, s[24:27], s55 offen sc1 lds
    v_mfma_f32_16x16x32_bf16 v[212:215], v[156:159], a[128:131], 0
    ds_read_b64_tr_b16 v[180:181], v247 offset:4096
    v_mfma_f32_16x16x32_bf16 v[216:219], v[160:163], a[128:131], 0
    ds_read_b64_tr_b16 v[182:183], v247 offset:4608
    s_mul_i32 s55, s52, 33
    s_add_u32 m0, s52, 49152
    s_add_u32 s55, s55, s54
    s_add_u32 s55, s55, 1622016
    buffer_load_dwordx4 v6, s[24:27], s55 offen sc1 lds
    v_mfma_f32_16x16x32_bf16 v[220:223], v[164:167], a[128:131], 0
    ds_read_b64_tr_b16 v[188:189], v7 offset:4096
    v_mfma_f32_16x16x32_bf16 v[224:227], a[0:3], v[152:155], 0
    ds_read_b64_tr_b16 v[190:191], v7 offset:4608
    v_mfma_f32_16x16x32_bf16 v[228:231], a[0:3], v[156:159], 0
    s_mul_i32 s55, s53, 33
    s_add_u32 m0, s53, 49152
    s_add_u32 s55, s55, s54
    s_add_u32 s55, s55, 1622016
    buffer_load_dwordx4 v6, s[24:27], s55 offen sc1 lds
    v_mfma_f32_16x16x32_bf16 v[232:235], a[0:3], v[160:163], 0
    v_mfma_f32_16x16x32_bf16 v[236:239], a[0:3], v[164:167], 0
    s_waitcnt lgkmcnt(0)
    v_mfma_f32_16x16x32_bf16 v[192:195], a[68:71], v[168:171], v[192:195]
    ds_read_b64_tr_b16 v[152:153], v244 offset:8192
    v_mfma_f32_16x16x32_bf16 v[196:199], a[68:71], v[172:175], v[196:199]
    ds_read_b64_tr_b16 v[154:155], v244 offset:8704
    v_mfma_f32_16x16x32_bf16 v[148:151], v[188:191], v[188:191], v[148:151]
    ds_read_b64_tr_b16 v[156:157], v245 offset:8192
    v_mfma_f32_16x16x32_bf16 v[200:203], a[68:71], v[176:179], v[200:203]
    ds_read_b64_tr_b16 v[158:159], v245 offset:8704
    v_mfma_f32_16x16x32_bf16 v[204:207], a[68:71], v[180:183], v[204:207]
    ds_read_b64_tr_b16 v[160:161], v246 offset:8192
    v_mfma_f32_16x16x32_bf16 v[208:211], v[168:171], a[132:135], v[208:211]
    ds_read_b64_tr_b16 v[162:163], v246 offset:8704
    v_mfma_f32_16x16x32_bf16 v[212:215], v[172:175], a[132:135], v[212:215]
    ds_read_b64_tr_b16 v[164:165], v247 offset:8192
    v_mfma_f32_16x16x32_bf16 v[216:219], v[176:179], a[132:135], v[216:219]
    ds_read_b64_tr_b16 v[166:167], v247 offset:8704
    v_mfma_f32_16x16x32_bf16 v[220:223], v[180:183], a[132:135], v[220:223]
    ds_read_b64_tr_b16 v[184:185], v7 offset:8192
    v_mfma_f32_16x16x32_bf16 v[224:227], a[4:7], v[168:171], v[224:227]
    ds_read_b64_tr_b16 v[186:187], v7 offset:8704
    v_mfma_f32_16x16x32_bf16 v[228:231], a[4:7], v[172:175], v[228:231]
    v_mfma_f32_16x16x32_bf16 v[232:235], a[4:7], v[176:179], v[232:235]
    v_mfma_f32_16x16x32_bf16 v[236:239], a[4:7], v[180:183], v[236:239]
    s_waitcnt lgkmcnt(0)
    v_mfma_f32_16x16x32_bf16 v[192:195], a[72:75], v[152:155], v[192:195]
    ds_read_b64_tr_b16 v[168:169], v244 offset:12288
    v_mfma_f32_16x16x32_bf16 v[196:199], a[72:75], v[156:159], v[196:199]
    ds_read_b64_tr_b16 v[170:171], v244 offset:12800
    v_mfma_f32_16x16x32_bf16 v[148:151], v[184:187], v[184:187], v[148:151]
    ds_read_b64_tr_b16 v[172:173], v245 offset:12288
    v_mfma_f32_16x16x32_bf16 v[200:203], a[72:75], v[160:163], v[200:203]
    ds_read_b64_tr_b16 v[174:175], v245 offset:12800
    v_mfma_f32_16x16x32_bf16 v[204:207], a[72:75], v[164:167], v[204:207]
    ds_read_b64_tr_b16 v[176:177], v246 offset:12288
    v_mfma_f32_16x16x32_bf16 v[208:211], v[152:155], a[136:139], v[208:211]
    ds_read_b64_tr_b16 v[178:179], v246 offset:12800
    v_mfma_f32_16x16x32_bf16 v[212:215], v[156:159], a[136:139], v[212:215]
    ds_read_b64_tr_b16 v[180:181], v247 offset:12288
    v_mfma_f32_16x16x32_bf16 v[216:219], v[160:163], a[136:139], v[216:219]
    ds_read_b64_tr_b16 v[182:183], v247 offset:12800
    v_mfma_f32_16x16x32_bf16 v[220:223], v[164:167], a[136:139], v[220:223]
    ds_read_b64_tr_b16 v[188:189], v7 offset:12288
    v_mfma_f32_16x16x32_bf16 v[224:227], a[8:11], v[152:155], v[224:227]
    ds_read_b64_tr_b16 v[190:191], v7 offset:12800
    v_mfma_f32_16x16x32_bf16 v[228:231], a[8:11], v[156:159], v[228:231]
    v_mfma_f32_16x16x32_bf16 v[232:235], a[8:11], v[160:163], v[232:235]
    v_mfma_f32_16x16x32_bf16 v[236:239], a[8:11], v[164:167], v[236:239]
    s_waitcnt vmcnt(8)
    ds_read_b32 v132, v240 offset:16384
    ds_read_b32 v133, v241 offset:16384
    ds_read_b32 v134, v242 offset:16384
    ds_read_b32 v135, v243 offset:16384
    s_waitcnt lgkmcnt(0)
    v_max3_u32 v248, v132, v133, v134
    v_max_u32 v248, v248, v135
    v_cmp_eq_u32 vcc, -1, v248
    s_cbranch_vccnz L_slow_32
L_ok_31:
    s_barrier
    v_mfma_f32_16x16x32_bf16 v[192:195], a[76:79], v[168:171], v[192:195]
    ds_read_b64_tr_b16 v[152:153], v244 offset:16384
    v_mfma_f32_16x16x32_bf16 v[196:199], a[76:79], v[172:175], v[196:199]
    ds_read_b64_tr_b16 v[154:155], v244 offset:16896
    v_mfma_f32_16x16x32_bf16 v[148:151], v[188:191], v[188:191], v[148:151]
    ds_read_b64_tr_b16 v[156:157], v245 offset:16384
    v_mfma_f32_16x16x32_bf16 v[200:203], a[76:79], v[176:179], v[200:203]
    ds_read_b64_tr_b16 v[158:159], v245 offset:16896
    v_mfma_f32_16x16x32_bf16 v[204:207], a[76:79], v[180:183], v[204:207]
    ds_read_b64_tr_b16 v[160:161], v246 offset:16384
    v_mfma_f32_16x16x32_bf16 v[208:211], v[168:171], a[140:143], v[208:211]
    ds_read_b64_tr_b16 v[162:163], v246 offset:16896
    v_mfma_f32_16x16x32_bf16 v[212:215], v[172:175], a[140:143], v[212:215]
    ds_read_b64_tr_b16 v[164:165], v247 offset:16384
    v_mfma_f32_16x16x32_bf16 v[216:219], v[176:179], a[140:143], v[216:219]
    ds_read_b64_tr_b16 v[166:167], v247 offset:16896
    v_mfma_f32_16x16x32_bf16 v[220:223], v[180:183], a[140:143], v[220:223]
    ds_read_b64_tr_b16 v[184:185], v7 offset:16384
    v_mfma_f32_16x16x32_bf16 v[224:227], a[12:15], v[168:171], v[224:227]
    ds_read_b64_tr_b16 v[186:187], v7 offset:16896
    v_mfma_f32_16x16x32_bf16 v[228:231], a[12:15], v[172:175], v[228:231]
    v_mfma_f32_16x16x32_bf16 v[232:235], a[12:15], v[176:179], v[232:235]
    v_mfma_f32_16x16x32_bf16 v[236:239], a[12:15], v[180:183], v[236:239]
    s_waitcnt lgkmcnt(0)
    v_mfma_f32_16x16x32_bf16 v[192:195], a[80:83], v[152:155], v[192:195]
    ds_read_b64_tr_b16 v[168:169], v244 offset:20480
    ds_read_b64_tr_b16 v[170:171], v244 offset:20992
    v_mfma_f32_16x16x32_bf16 v[196:199], a[80:83], v[156:159], v[196:199]
    ds_read_b64_tr_b16 v[172:173], v245 offset:20480
    v_mfma_f32_16x16x32_bf16 v[148:151], v[184:187], v[184:187], v[148:151]
    ds_read_b64_tr_b16 v[174:175], v245 offset:20992
    ds_read_b64_tr_b16 v[176:177], v246 offset:20480
    v_mfma_f32_16x16x32_bf16 v[200:203], a[80:83], v[160:163], v[200:203]
    ds_read_b64_tr_b16 v[178:179], v246 offset:20992
    v_mfma_f32_16x16x32_bf16 v[204:207], a[80:83], v[164:167], v[204:207]
    ds_read_b64_tr_b16 v[180:181], v247 offset:20480
    ds_read_b64_tr_b16 v[182:183], v247 offset:20992
    v_mfma_f32_16x16x32_bf16 v[208:211], v[152:155], a[144:147], v[208:211]
    ds_read_b64_tr_b16 v[188:189], v7 offset:20480
    v_mfma_f32_16x16x32_bf16 v[212:215], v[156:159], a[144:147], v[212:215]
    ds_read_b64_tr_b16 v[190:191], v7 offset:20992
    v_mfma_f32_16x16x32_bf16 v[216:219], v[160:163], a[144:147], v[216:219]
    v_mfma_f32_16x16x32_bf16 v[220:223], v[164:167], a[144:147], v[220:223]
    s_add_u32 m0, s63, 0
    s_nop 0
    buffer_load_dwordx4 v5, s[24:27], s62 offen offset:0 sc1 lds
    buffer_load_dwordx4 v5, s[24:27], s62 offen offset:1024 sc1 lds
    s_waitcnt lgkmcnt(0)
    v_mfma_f32_16x16x32_bf16 v[192:195], a[84:87], v[168:171], v[192:195]
    ds_read_b64_tr_b16 v[152:153], v244 offset:24576
    ds_read_b64_tr_b16 v[154:155], v244 offset:25088
    v_mfma_f32_16x16x32_bf16 v[196:199], a[84:87], v[172:175], v[196:199]
    ds_read_b64_tr_b16 v[156:157], v245 offset:24576
    v_mfma_f32_16x16x32_bf16 v[148:151], v[188:191], v[188:191], v[148:151]
    ds_read_b64_tr_b16 v[158:159], v245 offset:25088
    ds_read_b64_tr_b16 v[160:161], v246 offset:24576
    v_mfma_f32_16x16x32_bf16 v[200:203], a[84:87], v[176:179], v[200:203]
    ds_read_b64_tr_b16 v[162:163], v246 offset:25088
    v_mfma_f32_16x16x32_bf16 v[204:207], a[84:87], v[180:183], v[204:207]
    ds_read_b64_tr_b16 v[164:165], v247 offset:24576
    ds_read_b64_tr_b16 v[166:167], v247 offset:25088
    v_mfma_f32_16x16x32_bf16 v[208:211], v[168:171], a[148:151], v[208:211]
    ds_read_b64_tr_b16 v[184:185], v7 offset:24576
    v_mfma_f32_16x16x32_bf16 v[212:215], v[172:175], a[148:151], v[212:215]
    ds_read_b64_tr_b16 v[186:187], v7 offset:25088
    v_mfma_f32_16x16x32_bf16 v[216:219], v[176:179], a[148:151], v[216:219]
    v_mfma_f32_16x16x32_bf16 v[220:223], v[180:183], a[148:151], v[220:223]
    s_add_u32 m0, s63, 0
    s_nop 0
    buffer_load_dwordx4 v5, s[24:27], s62 offen offset:2048 sc1 lds
    buffer_load_dwordx4 v5, s[24:27], s62 offen offset:3072 sc1 lds
    s_add_u32 s62, s62, 4096
    s_waitcnt lgkmcnt(0)
    v_mfma_f32_16x16x32_bf16 v[192:195], a[88:91], v[152:155], v[192:195]
    ds_read_b64_tr_b16 v[168:169], v244 offset:28672
    ds_read_b64_tr_b16 v[170:171], v244 offset:29184
    v_mfma_f32_16x16x32_bf16 v[196:199], a[88:91], v[156:159], v[196:199]
    ds_read_b64_tr_b16 v[172:173], v245 offset:28672
    v_mfma_f32_16x16x32_bf16 v[148:151], v[184:187], v[184:187], v[148:151]
    ds_read_b64_tr_b16 v[174:175], v245 offset:29184
    ds_read_b64_tr_b16 v[176:177], v246 offset:28672
    v_mfma_f32_16x16x32_bf16 v[200:203], a[88:91], v[160:163], v[200:203]
    ds_read_b64_tr_b16 v[178:179], v246 offset:29184
    v_mfma_f32_16x16x32_bf16 v[204:207], a[88:91], v[164:167], v[204:207]
    ds_read_b64_tr_b16 v[180:181], v247 offset:28672
    ds_read_b64_tr_b16 v[182:183], v247 offset:29184
    s_waitcnt vmcnt(8)
    ds_read_b32 v128, v240 offset:32768
    ds_read_b32 v129, v241 offset:32768
    ds_read_b32 v130, v242 offset:32768
    ds_read_b32 v131, v243 offset:32768
    v_mfma_f32_16x16x32_bf16 v[208:211], v[152:155], a[152:155], v[208:211]
    ds_read_b64_tr_b16 v[188:189], v7 offset:28672
    v_mfma_f32_16x16x32_bf16 v[212:215], v[156:159], a[152:155], v[212:215]
    ds_read_b64_tr_b16 v[190:191], v7 offset:29184
    v_mfma_f32_16x16x32_bf16 v[216:219], v[160:163], a[152:155], v[216:219]
    v_mfma_f32_16x16x32_bf16 v[220:223], v[164:167], a[152:155], v[220:223]
    s_add_u32 m0, s63, 4096
    s_nop 0
    buffer_load_dwordx4 v5, s[24:27], s62 offen offset:0 sc1 lds
    buffer_load_dwordx4 v5, s[24:27], s62 offen offset:1024 sc1 lds
    s_waitcnt lgkmcnt(0)
    v_max3_u32 v248, v128, v129, v130
    v_max_u32 v248, v248, v131
    v_cmp_eq_u32 vcc, -1, v248
    s_cbranch_vccnz L_slow_34
L_ok_33:
    s_barrier
    v_mfma_f32_16x16x32_bf16 v[192:195], a[92:95], v[168:171], v[192:195]
    ds_read_b64_tr_b16 v[152:153], v244 offset:32768
    ds_read_b64_tr_b16 v[154:155], v244 offset:33280
    v_mfma_f32_16x16x32_bf16 v[196:199], a[92:95], v[172:175], v[196:199]
    ds_read_b64_tr_b16 v[156:157], v245 offset:32768
    v_mfma_f32_16x16x32_bf16 v[148:151], v[188:191], v[188:191], v[148:151]
    ds_read_b64_tr_b16 v[158:159], v245 offset:33280
    ds_read_b64_tr_b16 v[160:161], v246 offset:32768
    v_mfma_f32_16x16x32_bf16 v[200:203], a[92:95], v[176:179], v[200:203]
    ds_read_b64_tr_b16 v[162:163], v246 offset:33280
    v_mfma_f32_16x16x32_bf16 v[204:207], a[92:95], v[180:183], v[204:207]
    ds_read_b64_tr_b16 v[164:165], v247 offset:32768
    ds_read_b64_tr_b16 v[166:167], v247 offset:33280
    v_mfma_f32_16x16x32_bf16 v[208:211], v[168:171], a[156:159], v[208:211]
    ds_read_b64_tr_b16 v[184:185], v7 offset:32768
    v_mfma_f32_16x16x32_bf16 v[212:215], v[172:175], a[156:159], v[212:215]
    ds_read_b64_tr_b16 v[186:187], v7 offset:33280
    v_mfma_f32_16x16x32_bf16 v[216:219], v[176:179], a[156:159], v[216:219]
    v_mfma_f32_16x16x32_bf16 v[220:223], v[180:183], a[156:159], v[220:223]
    s_add_u32 m0, s63, 4096
    s_nop 0
    buffer_load_dwordx4 v5, s[24:27], s62 offen offset:2048 sc1 lds
    buffer_load_dwordx4 v5, s[24:27], s62 offen offset:3072 sc1 lds
    s_add_u32 s62, s62, 4096
    s_waitcnt lgkmcnt(0)
    v_mfma_f32_16x16x32_bf16 v[192:195], a[96:99], v[152:155], v[192:195]
    ds_read_b64_tr_b16 v[168:169], v244 offset:36864
    ds_read_b64_tr_b16 v[170:171], v244 offset:37376
    v_mfma_f32_16x16x32_bf16 v[196:199], a[96:99], v[156:159], v[196:199]
    ds_read_b64_tr_b16 v[172:173], v245 offset:36864
    v_mfma_f32_16x16x32_bf16 v[148:151], v[184:187], v[184:187], v[148:151]
    ds_read_b64_tr_b16 v[174:175], v245 offset:37376
    ds_read_b64_tr_b16 v[176:177], v246 offset:36864
    v_mfma_f32_16x16x32_bf16 v[200:203], a[96:99], v[160:163], v[200:203]
    ds_read_b64_tr_b16 v[178:179], v246 offset:37376
    v_mfma_f32_16x16x32_bf16 v[204:207], a[96:99], v[164:167], v[204:207]
    ds_read_b64_tr_b16 v[180:181], v247 offset:36864
    ds_read_b64_tr_b16 v[182:183], v247 offset:37376
    v_mfma_f32_16x16x32_bf16 v[208:211], v[152:155], a[160:163], v[208:211]
    ds_read_b64_tr_b16 v[188:189], v7 offset:36864
    v_mfma_f32_16x16x32_bf16 v[212:215], v[156:159], a[160:163], v[212:215]
    ds_read_b64_tr_b16 v[190:191], v7 offset:37376
    v_mfma_f32_16x16x32_bf16 v[216:219], v[160:163], a[160:163], v[216:219]
    v_mfma_f32_16x16x32_bf16 v[220:223], v[164:167], a[160:163], v[220:223]
    s_add_u32 m0, s63, 8192
    s_nop 0
    buffer_load_dwordx4 v5, s[24:27], s62 offen offset:0 sc1 lds
    buffer_load_dwordx4 v5, s[24:27], s62 offen offset:1024 sc1 lds
    s_waitcnt lgkmcnt(0)
    v_mfma_f32_16x16x32_bf16 v[192:195], a[100:103], v[168:171], v[192:195]
    ds_read_b64_tr_b16 v[152:153], v244 offset:40960
    ds_read_b64_tr_b16 v[154:155], v244 offset:41472
    v_mfma_f32_16x16x32_bf16 v[196:199], a[100:103], v[172:175], v[196:199]
    ds_read_b64_tr_b16 v[156:157], v245 offset:40960
    v_mfma_f32_16x16x32_bf16 v[148:151], v[188:191], v[188:191], v[148:151]
    ds_read_b64_tr_b16 v[158:159], v245 offset:41472
    ds_read_b64_tr_b16 v[160:161], v246 offset:40960
    v_mfma_f32_16x16x32_bf16 v[200:203], a[100:103], v[176:179], v[200:203]
    ds_read_b64_tr_b16 v[162:163], v246 offset:41472
    v_mfma_f32_16x16x32_bf16 v[204:207], a[100:103], v[180:183], v[204:207]
    ds_read_b64_tr_b16 v[164:165], v247 offset:40960
    ds_read_b64_tr_b16 v[166:167], v247 offset:41472
    v_mfma_f32_16x16x32_bf16 v[208:211], v[168:171], a[164:167], v[208:211]
    ds_read_b64_tr_b16 v[184:185], v7 offset:40960
    v_mfma_f32_16x16x32_bf16 v[212:215], v[172:175], a[164:167], v[212:215]
    ds_read_b64_tr_b16 v[186:187], v7 offset:41472
    v_mfma_f32_16x16x32_bf16 v[216:219], v[176:179], a[164:167], v[216:219]
    v_mfma_f32_16x16x32_bf16 v[220:223], v[180:183], a[164:167], v[220:223]
    s_add_u32 m0, s63, 8192
    s_nop 0
    buffer_load_dwordx4 v5, s[24:27], s62 offen offset:2048 sc1 lds
    buffer_load_dwordx4 v5, s[24:27], s62 offen offset:3072 sc1 lds
    s_add_u32 s62, s62, 4096
    s_waitcnt lgkmcnt(0)
    v_mfma_f32_16x16x32_bf16 v[192:195], a[104:107], v[152:155], v[192:195]
    ds_read_b64_tr_b16 v[168:169], v244 offset:45056
    ds_read_b64_tr_b16 v[170:171], v244 offset:45568
    v_mfma_f32_16x16x32_bf16 v[196:199], a[104:107], v[156:159], v[196:199]
    ds_read_b64_tr_b16 v[172:173], v245 offset:45056
    v_mfma_f32_16x16x32_bf16 v[148:151], v[184:187], v[184:187], v[148:151]
    ds_read_b64_tr_b16 v[174:175], v245 offset:45568
    ds_read_b64_tr_b16 v[176:177], v246 offset:45056
    v_mfma_f32_16x16x32_bf16 v[200:203], a[104:107], v[160:163], v[200:203]
    ds_read_b64_tr_b16 v[178:179], v246 offset:45568
    v_mfma_f32_16x16x32_bf16 v[204:207], a[104:107], v[164:167], v[204:207]
    ds_read_b64_tr_b16 v[180:181], v247 offset:45056
    ds_read_b64_tr_b16 v[182:183], v247 offset:45568
    s_waitcnt vmcnt(12)
    ds_read_b32 v132, v240 offset:49152
    ds_read_b32 v133, v241 offset:49152
    ds_read_b32 v134, v242 offset:49152
    ds_read_b32 v135, v243 offset:49152
    v_mfma_f32_16x16x32_bf16 v[208:211], v[152:155], a[168:171], v[208:211]
    ds_read_b64_tr_b16 v[188:189], v7 offset:45056
    v_mfma_f32_16x16x32_bf16 v[212:215], v[156:159], a[168:171], v[212:215]
    ds_read_b64_tr_b16 v[190:191], v7 offset:45568
    v_mfma_f32_16x16x32_bf16 v[216:219], v[160:163], a[168:171], v[216:219]
    v_mfma_f32_16x16x32_bf16 v[220:223], v[164:167], a[168:171], v[220:223]
    s_add_u32 m0, s63, 12288
    s_nop 0
    buffer_load_dwordx4 v5, s[24:27], s62 offen offset:0 sc1 lds
    buffer_load_dwordx4 v5, s[24:27], s62 offen offset:1024 sc1 lds
    s_waitcnt lgkmcnt(0)
    v_max3_u32 v248, v132, v133, v134
    v_max_u32 v248, v248, v135
    v_cmp_eq_u32 vcc, -1, v248
    s_cbranch_vccnz L_slow_36
L_ok_35:
    s_barrier
    v_mfma_f32_16x16x32_bf16 v[192:195], a[108:111], v[168:171], v[192:195]
    ds_read_b64_tr_b16 v[88:89], v244 offset:49152
    ds_read_b64_tr_b16 v[90:91], v244 offset:49664
    ds_read_b64_tr_b16 v[92:93], v245 offset:49152
    v_mfma_f32_16x16x32_bf16 v[196:199], a[108:111], v[172:175], v[196:199]
    ds_read_b64_tr_b16 v[94:95], v245 offset:49664
    ds_read_b64_tr_b16 v[96:97], v246 offset:49152
    v_mfma_f32_16x16x32_bf16 v[148:151], v[188:191], v[188:191], v[148:151]
    ds_read_b64_tr_b16 v[98:99], v246 offset:49664
    ds_read_b64_tr_b16 v[100:101], v247 offset:49152
    v_mfma_f32_16x16x32_bf16 v[200:203], a[108:111], v[176:179], v[200:203]
    ds_read_b64_tr_b16 v[102:103], v247 offset:49664
    ds_read_b64_tr_b16 v[104:105], v7 offset:49152
    ds_read_b64_tr_b16 v[106:107], v7 offset:49664
    v_mfma_f32_16x16x32_bf16 v[204:207], a[108:111], v[180:183], v[204:207]
    ds_read_b64_tr_b16 v[108:109], v7 offset:53248
    ds_read_b64_tr_b16 v[110:111], v7 offset:53760
    v_mfma_f32_16x16x32_bf16 v[208:211], v[168:171], a[172:175], v[208:211]
    ds_read_b64_tr_b16 v[112:113], v7 offset:57344
    ds_read_b64_tr_b16 v[114:115], v7 offset:57856
    v_mfma_f32_16x16x32_bf16 v[212:215], v[172:175], a[172:175], v[212:215]
    ds_read_b64_tr_b16 v[116:117], v7 offset:61440
    ds_read_b64_tr_b16 v[118:119], v7 offset:61952
    v_mfma_f32_16x16x32_bf16 v[216:219], v[176:179], a[172:175], v[216:219]
    v_mfma_f32_16x16x32_bf16 v[220:223], v[180:183], a[172:175], v[220:223]
    s_add_u32 m0, s63, 12288
    s_nop 0
    buffer_load_dwordx4 v5, s[24:27], s62 offen offset:2048 sc1 lds
    buffer_load_dwordx4 v5, s[24:27], s62 offen offset:3072 sc1 lds
    s_add_u32 s62, s62, 4096
    s_waitcnt lgkmcnt(0)
    v_mfma_f32_16x16x32_bf16 v[148:151], v[104:107], v[104:107], v[148:151]
    ds_read_b64_tr_b16 v[120:121], v244 offset:53248
    v_mfma_f32_16x16x32_bf16 v[192:195], a[112:115], v[88:91], v[192:195]
    ds_read_b64_tr_b16 v[122:123], v244 offset:53760
    v_mfma_f32_16x16x32_bf16 v[148:151], v[108:111], v[108:111], v[148:151]
    ds_read_b64_tr_b16 v[124:125], v245 offset:53248
    v_mfma_f32_16x16x32_bf16 v[196:199], a[112:115], v[92:95], v[196:199]
    ds_read_b64_tr_b16 v[126:127], v245 offset:53760
    v_mfma_f32_16x16x32_bf16 v[148:151], v[112:115], v[112:115], v[148:151]
    v_mfma_f32_16x16x32_bf16 v[200:203], a[112:115], v[96:99], v[200:203]
    ds_read_b64_tr_b16 v[128:129], v246 offset:53248
    v_mfma_f32_16x16x32_bf16 v[148:151], v[116:119], v[116:119], v[148:151]
    ds_read_b64_tr_b16 v[130:131], v246 offset:53760
    v_mfma_f32_16x16x32_bf16 v[204:207], a[112:115], v[100:103], v[204:207]
    ds_read_b64_tr_b16 v[132:133], v247 offset:53248
    v_mfma_f32_16x16x32_bf16 v[208:211], v[88:91], a[176:179], v[208:211]
    ds_read_b64_tr_b16 v[134:135], v247 offset:53760
    v_mfma_f32_16x16x32_bf16 v[212:215], v[92:95], a[176:179], v[212:215]
    v_mfma_f32_16x16x32_bf16 v[216:219], v[96:99], a[176:179], v[216:219]
    v_mfma_f32_16x16x32_bf16 v[220:223], v[100:103], a[176:179], v[220:223]
    s_waitcnt lgkmcnt(0)
    v_mfma_f32_16x16x32_bf16 v[192:195], a[116:119], v[120:123], v[192:195]
    ds_read_b64_tr_b16 v[152:153], v244 offset:57344
    ds_read_b64_tr_b16 v[154:155], v244 offset:57856
    v_mfma_f32_16x16x32_bf16 v[196:199], a[116:119], v[124:127], v[196:199]
    ds_read_b64_tr_b16 v[156:157], v245 offset:57344
    v_cndmask_b32 v248, v148, v149, s[10:11]
    v_cndmask_b32 v248, v248, v150, s[12:13]
    v_mfma_f32_16x16x32_bf16 v[200:203], a[116:119], v[128:131], v[200:203]
    ds_read_b64_tr_b16 v[158:159], v245 offset:57856
    v_cndmask_b32 v248, v248, v151, s[14:15]
    v_mov_b32 v249, 0x3727c5ac
    v_mfma_f32_16x16x32_bf16 v[204:207], a[116:119], v[132:135], v[204:207]
    ds_read_b64_tr_b16 v[160:161], v246 offset:57344
    ds_read_b64_tr_b16 v[162:163], v246 offset:57856
    v_fmac_f32 v249, 0x3b000000, v248
    s_lshl_b32 s55, s46, 6
    s_add_u32 s55, s55, 152576
    v_mfma_f32_16x16x32_bf16 v[208:211], v[120:123], a[180:183], v[208:211]
    ds_read_b64_tr_b16 v[164:165], v247 offset:57344
    v_rsq_f32 v249, v249
    v_lshl_add_u32 v248, v2, 2, s55
    s_mov_b32 s60, 0x00f0000f
    s_mov_b32 s61, 0xf0000f00
    v_mfma_f32_16x16x32_bf16 v[212:215], v[124:127], a[180:183], v[212:215]
    ds_read_b64_tr_b16 v[166:167], v247 offset:57856
    s_mov_b64 exec, s[60:61]
    ds_write_b32 v248, v249
    s_mov_b64 exec, -1
    v_mfma_f32_16x16x32_bf16 v[216:219], v[128:131], a[180:183], v[216:219]
    v_lshlrev_b32 v248, 2, v2
    v_lshlrev_b32 v249, 4, v3
    v_mfma_f32_16x16x32_bf16 v[220:223], v[132:135], a[180:183], v[220:223]
    v_add_u32 v248, 152576, v248
    v_add_u32 v249, 152576, v249
    s_waitcnt lgkmcnt(0)
    s_barrier
    v_mfma_f32_16x16x32_bf16 v[192:195], a[120:123], v[152:155], v[192:195]
    ds_read_b64_tr_b16 v[168:169], v244 offset:61440
    ds_read_b64_tr_b16 v[170:171], v244 offset:61952
    ds_read_b64_tr_b16 v[172:173], v245 offset:61440
    v_mfma_f32_16x16x32_bf16 v[196:199], a[120:123], v[156:159], v[196:199]
    ds_read_b64_tr_b16 v[174:175], v245 offset:61952
    ds_read_b64_tr_b16 v[176:177], v246 offset:61440
    ds_read_b64_tr_b16 v[178:179], v246 offset:61952
    v_mfma_f32_16x16x32_bf16 v[200:203], a[120:123], v[160:163], v[200:203]
    ds_read_b64_tr_b16 v[180:181], v247 offset:61440
    ds_read_b64_tr_b16 v[182:183], v247 offset:61952
    v_mfma_f32_16x16x32_bf16 v[204:207], a[120:123], v[164:167], v[204:207]
    ds_read_b32 v184, v248 offset:0
    ds_read_b32 v185, v248 offset:64
    ds_read_b32 v186, v248 offset:128
    v_mfma_f32_16x16x32_bf16 v[208:211], v[152:155], a[184:187], v[208:211]
    ds_read_b32 v187, v248 offset:192
    ds_read_b128 v[136:139], v249 offset:0
    ds_read_b128 v[140:143], v249 offset:64
    v_mfma_f32_16x16x32_bf16 v[212:215], v[156:159], a[184:187], v[212:215]
    ds_read_b128 v[144:147], v249 offset:128
    ds_read_b128 v[148:151], v249 offset:192
    v_mfma_f32_16x16x32_bf16 v[216:219], v[160:163], a[184:187], v[216:219]
    v_mfma_f32_16x16x32_bf16 v[220:223], v[164:167], a[184:187], v[220:223]
    s_waitcnt lgkmcnt(0)
    v_mfma_f32_16x16x32_bf16 v[192:195], a[124:127], v[168:171], v[192:195]
    v_mfma_f32_16x16x32_bf16 v[196:199], a[124:127], v[172:175], v[196:199]
    s_lshl_b32 s50, s48, 2
    s_add_u32 s50, s50, s46
    s_lshl_b32 s50, s50, 5
    s_add_u32 s50, s50, s47
    s_lshl_b32 s23, s50, 12
    s_lshl_b32 s51, s46, 11
    s_add_u32 s51, s51, 152832
    v_mfma_f32_16x16x32_bf16 v[200:203], a[124:127], v[176:179], v[200:203]
    v_mfma_f32_16x16x32_bf16 v[204:207], a[124:127], v[180:183], v[204:207]
    v_add_u32 v6, s51, v5
    v_lshrrev_b32 v7, 5, v1
    v_mfma_f32_16x16x32_bf16 v[208:211], v[168:171], a[188:191], v[208:211]
    v_mfma_f32_16x16x32_bf16 v[212:215], v[172:175], a[188:191], v[212:215]
    v_lshlrev_b32 v7, 8, v7
    v_lshl_add_u32 v7, v2, 4, v7
    v_mfma_f32_16x16x32_bf16 v[216:219], v[176:179], a[188:191], v[216:219]
    v_mfma_f32_16x16x32_bf16 v[220:223], v[180:183], a[188:191], v[220:223]
    v_add_u32 v240, s51, v7
    v_mul_f32 v192, v184, v192
    v_mul_f32 v193, v184, v193
    v_mul_f32 v194, v184, v194
    v_mul_f32 v195, v184, v195
    v_mfma_f32_16x16x32_bf16 v[224:227], a[48:51], v[88:91], v[224:227]
    v_cvt_pk_bf16_f32 v104, v192, v193
    v_cvt_pk_bf16_f32 v105, v194, v195
    v_mul_f32 v196, v185, v196
    v_mul_f32 v197, v185, v197
    v_mul_f32 v198, v185, v198
    v_mul_f32 v199, v185, v199
    v_mfma_f32_16x16x32_bf16 v[228:231], a[48:51], v[92:95], v[228:231]
    v_cvt_pk_bf16_f32 v106, v196, v197
    v_cvt_pk_bf16_f32 v107, v198, v199
    v_mul_f32 v200, v186, v200
    v_mul_f32 v201, v186, v201
    v_mul_f32 v202, v186, v202
    v_mul_f32 v203, v186, v203
    v_mfma_f32_16x16x32_bf16 v[232:235], a[48:51], v[96:99], v[232:235]
    v_cvt_pk_bf16_f32 v108, v200, v201
    v_cvt_pk_bf16_f32 v109, v202, v203
    v_mul_f32 v204, v187, v204
    v_mul_f32 v205, v187, v205
    v_mul_f32 v206, v187, v206
    v_mul_f32 v207, v187, v207
    v_mfma_f32_16x16x32_bf16 v[236:239], a[48:51], v[100:103], v[236:239]
    v_cvt_pk_bf16_f32 v110, v204, v205
    v_cvt_pk_bf16_f32 v111, v206, v207
    v_permlane16_swap_b32 v104, v106
    v_permlane16_swap_b32 v105, v107
    v_min_u32 v104, -2, v104
    buffer_store_dwordx4 v[104:107], v5, s[32:35], s23 offen offset:0 sc1
    v_permlane16_swap_b32 v108, v110
    v_permlane16_swap_b32 v109, v111
    v_min_u32 v108, -2, v108
    buffer_store_dwordx4 v[108:111], v5, s[32:35], s23 offen offset:2048 sc1
    v_pk_mul_f32 v[208:209], v[208:209], v[136:137]
    v_pk_mul_f32 v[210:211], v[210:211], v[138:139]
    v_mfma_f32_16x16x32_bf16 v[224:227], a[52:55], v[120:123], v[224:227]
    v_cvt_pk_bf16_f32 v112, v208, v209
    v_cvt_pk_bf16_f32 v113, v210, v211
    v_pk_mul_f32 v[212:213], v[212:213], v[140:141]
    v_pk_mul_f32 v[214:215], v[214:215], v[142:143]
    v_mfma_f32_16x16x32_bf16 v[228:231], a[52:55], v[124:127], v[228:231]
    v_cvt_pk_bf16_f32 v114, v212, v213
    v_cvt_pk_bf16_f32 v115, v214, v215
    v_min_u32 v112, -2, v112
    buffer_store_dwordx4 v[112:115], v5, s[32:35], s23 offen offset:1024 sc1
    v_pk_mul_f32 v[216:217], v[216:217], v[144:145]
    v_pk_mul_f32 v[218:219], v[218:219], v[146:147]
    v_mfma_f32_16x16x32_bf16 v[232:235], a[52:55], v[128:131], v[232:235]
    v_cvt_pk_bf16_f32 v116, v216, v217
    v_cvt_pk_bf16_f32 v117, v218, v219
    v_pk_mul_f32 v[220:221], v[220:221], v[148:149]
    v_pk_mul_f32 v[222:223], v[222:223], v[150:151]
    v_mfma_f32_16x16x32_bf16 v[236:239], a[52:55], v[132:135], v[236:239]
    v_cvt_pk_bf16_f32 v118, v220, v221
    v_cvt_pk_bf16_f32 v119, v222, v223
    v_min_u32 v116, -2, v116
    buffer_store_dwordx4 v[116:119], v5, s[32:35], s23 offen offset:3072 sc1
    ds_write_b128 v6, v[112:115] offset:0
    ds_write_b128 v6, v[116:119] offset:1024
    v_mfma_f32_16x16x32_bf16 v[224:227], a[56:59], v[152:155], v[224:227]
    ds_read_b64_tr_b16 v[192:193], v244 offset:16384
    ds_read_b64_tr_b16 v[194:195], v244 offset:16896
    s_mov_b32 s60, 0x0000ffff
    s_mov_b32 s61, 0x0000ffff
    s_mov_b32 s50, 0xff800000
    v_and_b32 v248, 31, v1
    v_lshrrev_b32 v249, 5, v1
    v_mfma_f32_16x16x32_bf16 v[228:231], a[56:59], v[156:159], v[228:231]
    ds_read_b64_tr_b16 v[196:197], v245 offset:16384
    ds_read_b64_tr_b16 v[198:199], v245 offset:16896
    v_lshlrev_b32 v249, 2, v249
    v_sub_u32 v248, v248, v249
    v_mfma_f32_16x16x32_bf16 v[232:235], a[56:59], v[160:163], v[232:235]
    ds_read_b64_tr_b16 v[200:201], v246 offset:16384
    ds_read_b64_tr_b16 v[202:203], v246 offset:16896
    s_sub_u32 s51, s23, 4096
    s_cmp_ge_u32 s47, 1
    s_cselect_b32 s51, s51, 0x7f000000
    v_add_u32 v253, s51, v5
    v_add_u32 v191, s51, v7
    v_mfma_f32_16x16x32_bf16 v[236:239], a[56:59], v[164:167], v[236:239]
    ds_read_b64_tr_b16 v[204:205], v247 offset:16384
    ds_read_b64_tr_b16 v[206:207], v247 offset:16896
    s_sub_u32 s51, s23, 8192
    s_cmp_ge_u32 s47, 2
    s_cselect_b32 s51, s51, 0x7f000000
    v_add_u32 v252, s51, v5
    v_add_u32 v190, s51, v7
    v_mfma_f32_16x16x32_bf16 v[224:227], a[60:63], v[168:171], v[224:227]
    ds_read_b64_tr_b16 v[208:209], v244 offset:20480
    ds_read_b64_tr_b16 v[210:211], v244 offset:20992
    s_sub_u32 s51, s23, 12288
    s_cmp_ge_u32 s47, 3
    s_cselect_b32 s51, s51, 0x7f000000
    v_add_u32 v251, s51, v5
    v_add_u32 v189, s51, v7
    v_mfma_f32_16x16x32_bf16 v[228:231], a[60:63], v[172:175], v[228:231]
    ds_read_b64_tr_b16 v[212:213], v245 offset:20480
    ds_read_b64_tr_b16 v[214:215], v245 offset:20992
    s_sub_u32 s51, s23, 16384
    s_cmp_ge_u32 s47, 4
    s_cselect_b32 s51, s51, 0x7f000000
    v_add_u32 v250, s51, v5
    v_add_u32 v188, s51, v7
    v_mfma_f32_16x16x32_bf16 v[232:235], a[60:63], v[176:179], v[232:235]
    ds_read_b64_tr_b16 v[216:217], v246 offset:20480
    ds_read_b64_tr_b16 v[218:219], v246 offset:20992
    v_mfma_f32_16x16x32_bf16 v[236:239], a[60:63], v[180:183], v[236:239]
    ds_read_b64_tr_b16 v[220:221], v247 offset:20480
    ds_read_b64_tr_b16 v[222:223], v247 offset:20992
    s_waitcnt lgkmcnt(8)
    v_mfma_f32_16x16x32_bf16 v[224:227], a[16:19], v[192:195], v[224:227]
    ds_read_b64_tr_b16 v[152:153], v244 offset:24576
    ds_read_b64_tr_b16 v[154:155], v244 offset:25088
    v_subrev_u32 v136, 0, v248
    v_ashrrev_i32 v136, 31, v136
    v_and_b32 v136, s50, v136
    v_mfma_f32_16x16x32_bf16 v[228:231], a[16:19], v[196:199], v[228:231]
    ds_read_b64_tr_b16 v[156:157], v245 offset:24576
    ds_read_b64_tr_b16 v[158:159], v245 offset:25088
    v_subrev_u32 v137, 1, v248
    v_ashrrev_i32 v137, 31, v137
    v_and_b32 v137, s50, v137
    v_mfma_f32_16x16x32_bf16 v[232:235], a[16:19], v[200:203], v[232:235]
    ds_read_b64_tr_b16 v[160:161], v246 offset:24576
    ds_read_b64_tr_b16 v[162:163], v246 offset:25088
    v_subrev_u32 v138, 2, v248
    v_ashrrev_i32 v138, 31, v138
    v_and_b32 v138, s50, v138
    v_mfma_f32_16x16x32_bf16 v[236:239], a[16:19], v[204:207], v[236:239]
    ds_read_b64_tr_b16 v[164:165], v247 offset:24576
    ds_read_b64_tr_b16 v[166:167], v247 offset:25088
    v_subrev_u32 v139, 3, v248
    v_ashrrev_i32 v139, 31, v139
    v_and_b32 v139, s50, v139
    s_waitcnt lgkmcnt(8)
    v_mfma_f32_16x16x32_bf16 v[224:227], a[20:23], v[208:211], v[224:227]
    ds_read_b64_tr_b16 v[168:169], v244 offset:28672
    ds_read_b64_tr_b16 v[170:171], v244 offset:29184
    v_subrev_u32 v140, 8, v248
    v_ashrrev_i32 v140, 31, v140
    v_and_b32 v140, s50, v140
    v_mfma_f32_16x16x32_bf16 v[228:231], a[20:23], v[212:215], v[228:231]
    ds_read_b64_tr_b16 v[172:173], v245 offset:28672
    ds_read_b64_tr_b16 v[174:175], v245 offset:29184
    v_subrev_u32 v141, 9, v248
    v_ashrrev_i32 v141, 31, v141
    v_and_b32 v141, s50, v141
    v_mfma_f32_16x16x32_bf16 v[232:235], a[20:23], v[216:219], v[232:235]
    ds_read_b64_tr_b16 v[176:177], v246 offset:28672
    ds_read_b64_tr_b16 v[178:179], v246 offset:29184
    v_subrev_u32 v142, 10, v248
    v_ashrrev_i32 v142, 31, v142
    v_and_b32 v142, s50, v142
    v_mfma_f32_16x16x32_bf16 v[236:239], a[20:23], v[220:223], v[236:239]
    ds_read_b64_tr_b16 v[180:181], v247 offset:28672
    ds_read_b64_tr_b16 v[182:183], v247 offset:29184
    v_subrev_u32 v143, 11, v248
    v_ashrrev_i32 v143, 31, v143
    v_and_b32 v143, s50, v143
    s_waitcnt lgkmcnt(8)
    v_mfma_f32_16x16x32_bf16 v[224:227], a[24:27], v[152:155], v[224:227]
    ds_read_b64_tr_b16 v[192:193], v244 offset:32768
    ds_read_b64_tr_b16 v[194:195], v244 offset:33280
    v_subrev_u32 v144, 16, v248
    v_ashrrev_i32 v144, 31, v144
    v_and_b32 v144, s50, v144
    v_mfma_f32_16x16x32_bf16 v[228:231], a[24:27], v[156:159], v[228:231]
    ds_read_b64_tr_b16 v[196:197], v245 offset:32768
    ds_read_b64_tr_b16 v[198:199], v245 offset:33280
    v_subrev_u32 v145, 17, v248
    v_ashrrev_i32 v145, 31, v145
    v_and_b32 v145, s50, v145
    v_mfma_f32_16x16x32_bf16 v[232:235], a[24:27], v[160:163], v[232:235]
    ds_read_b64_tr_b16 v[200:201], v246 offset:32768
    ds_read_b64_tr_b16 v[202:203], v246 offset:33280
    v_subrev_u32 v146, 18, v248
    v_ashrrev_i32 v146, 31, v146
    v_and_b32 v146, s50, v146
    v_mfma_f32_16x16x32_bf16 v[236:239], a[24:27], v[164:167], v[236:239]
    ds_read_b64_tr_b16 v[204:205], v247 offset:32768
    ds_read_b64_tr_b16 v[206:207], v247 offset:33280
    v_subrev_u32 v147, 19, v248
    v_ashrrev_i32 v147, 31, v147
    v_and_b32 v147, s50, v147
    s_waitcnt lgkmcnt(8)
    v_mfma_f32_16x16x32_bf16 v[224:227], a[28:31], v[168:171], v[224:227]
    ds_read_b64_tr_b16 v[208:209], v244 offset:36864
    ds_read_b64_tr_b16 v[210:211], v244 offset:37376
    v_subrev_u32 v148, 24, v248
    v_ashrrev_i32 v148, 31, v148
    v_and_b32 v148, s50, v148
    v_mfma_f32_16x16x32_bf16 v[228:231], a[28:31], v[172:175], v[228:231]
    ds_read_b64_tr_b16 v[212:213], v245 offset:36864
    ds_read_b64_tr_b16 v[214:215], v245 offset:37376
    v_subrev_u32 v149, 25, v248
    v_ashrrev_i32 v149, 31, v149
    v_and_b32 v149, s50, v149
    v_mfma_f32_16x16x32_bf16 v[232:235], a[28:31], v[176:179], v[232:235]
    ds_read_b64_tr_b16 v[216:217], v246 offset:36864
    ds_read_b64_tr_b16 v[218:219], v246 offset:37376
    v_subrev_u32 v150, 26, v248
    v_ashrrev_i32 v150, 31, v150
    v_and_b32 v150, s50, v150
    v_mfma_f32_16x16x32_bf16 v[236:239], a[28:31], v[180:183], v[236:239]
    ds_read_b64_tr_b16 v[220:221], v247 offset:36864
    ds_read_b64_tr_b16 v[222:223], v247 offset:37376
    v_subrev_u32 v151, 27, v248
    v_ashrrev_i32 v151, 31, v151
    v_and_b32 v151, s50, v151
    s_waitcnt lgkmcnt(8)
    v_mfma_f32_16x16x32_bf16 v[224:227], a[32:35], v[192:195], v[224:227]
    ds_read_b64_tr_b16 v[152:153], v244 offset:40960
    ds_read_b64_tr_b16 v[154:155], v244 offset:41472
    v_mfma_f32_16x16x32_bf16 v[228:231], a[32:35], v[196:199], v[228:231]
    ds_read_b64_tr_b16 v[156:157], v245 offset:40960
    ds_read_b64_tr_b16 v[158:159], v245 offset:41472
    v_mfma_f32_16x16x32_bf16 v[232:235], a[32:35], v[200:203], v[232:235]
    ds_read_b64_tr_b16 v[160:161], v246 offset:40960
    ds_read_b64_tr_b16 v[162:163], v246 offset:41472
    v_mfma_f32_16x16x32_bf16 v[236:239], a[32:35], v[204:207], v[236:239]
    ds_read_b64_tr_b16 v[164:165], v247 offset:40960
    ds_read_b64_tr_b16 v[166:167], v247 offset:41472
    s_waitcnt lgkmcnt(8)
    v_mfma_f32_16x16x32_bf16 v[224:227], a[36:39], v[208:211], v[224:227]
    ds_read_b64_tr_b16 v[168:169], v244 offset:45056
    ds_read_b64_tr_b16 v[170:171], v244 offset:45568
    v_mfma_f32_16x16x32_bf16 v[228:231], a[36:39], v[212:215], v[228:231]
    ds_read_b64_tr_b16 v[172:173], v245 offset:45056
    ds_read_b64_tr_b16 v[174:175], v245 offset:45568
    v_mfma_f32_16x16x32_bf16 v[232:235], a[36:39], v[216:219], v[232:235]
    ds_read_b64_tr_b16 v[176:177], v246 offset:45056
    ds_read_b64_tr_b16 v[178:179], v246 offset:45568
    v_mfma_f32_16x16x32_bf16 v[236:239], a[36:39], v[220:223], v[236:239]
    ds_read_b64_tr_b16 v[180:181], v247 offset:45056
    ds_read_b64_tr_b16 v[182:183], v247 offset:45568
    s_waitcnt lgkmcnt(8)
    v_mfma_f32_16x16x32_bf16 v[224:227], a[40:43], v[152:155], v[224:227]
    v_mfma_f32_16x16x32_bf16 v[228:231], a[40:43], v[156:159], v[228:231]
    v_mfma_f32_16x16x32_bf16 v[232:235], a[40:43], v[160:163], v[232:235]
    v_mfma_f32_16x16x32_bf16 v[236:239], a[40:43], v[164:167], v[236:239]
    s_waitcnt lgkmcnt(0)
    v_mfma_f32_16x16x32_bf16 v[224:227], a[44:47], v[168:171], v[224:227]
    v_mfma_f32_16x16x32_bf16 v[228:231], a[44:47], v[172:175], v[228:231]
    v_mfma_f32_16x16x32_bf16 v[232:235], a[44:47], v[176:179], v[232:235]
    v_mfma_f32_16x16x32_bf16 v[236:239], a[44:47], v[180:183], v[236:239]
    s_mov_b64 exec, s[60:61]
    ds_read_b128 v[72:75], v240 offset:0
    ds_read_b128 v[76:79], v240 offset:512
    ds_read_b128 v[80:83], v240 offset:1024
    ds_read_b128 v[84:87], v240 offset:1536
    s_mov_b64 exec, -1
    v_mul_f32 v224, v184, v224
    v_mul_f32 v225, v184, v225
    v_mul_f32 v226, v184, v226
    v_mul_f32 v227, v184, v227
    v_cvt_pk_bf16_f32 v112, v224, v225
    v_cvt_pk_bf16_f32 v113, v226, v227
    v_mul_f32 v228, v185, v228
    v_mul_f32 v229, v185, v229
    v_mul_f32 v230, v185, v230
    v_mul_f32 v231, v185, v231
    v_cvt_pk_bf16_f32 v114, v228, v229
    v_cvt_pk_bf16_f32 v115, v230, v231
    v_mul_f32 v232, v186, v232
    v_mul_f32 v233, v186, v233
    v_mul_f32 v234, v186, v234
    v_mul_f32 v235, v186, v235
    v_cvt_pk_bf16_f32 v116, v232, v233
    v_cvt_pk_bf16_f32 v117, v234, v235
    v_mul_f32 v236, v187, v236
    v_mul_f32 v237, v187, v237
    v_mul_f32 v238, v187, v238
    v_mul_f32 v239, v187, v239
    v_cvt_pk_bf16_f32 v118, v236, v237
    v_cvt_pk_bf16_f32 v119, v238, v239
    v_permlane16_swap_b32 v112, v114
    v_permlane16_swap_b32 v113, v115
    v_permlane16_swap_b32 v116, v118
    v_permlane16_swap_b32 v117, v119
    s_lshl_b32 s62, s48, 2
    s_add_u32 s62, s62, s46
    s_lshl_b32 s62, s62, 14
    s_add_u32 s62, s62, 14942208
    v_mfma_f32_32x32x16_bf16 v[152:167], v[104:107], v[116:119], 0
    s_waitcnt lgkmcnt(0)
    s_waitcnt vmcnt(0)
    s_barrier
    buffer_load_dwordx4 v[88:91], v253, s[32:35], 0 offen offset:2048 sc1
    s_mov_b64 exec, s[60:61]
    buffer_load_dwordx4 v[64:67], v191, s[32:35], 0 offen offset:3072 sc1
    buffer_load_dwordx4 v[68:71], v191, s[32:35], 0 offen offset:3584 sc1
    s_mov_b64 exec, -1
    buffer_load_dwordx4 v[92:95], v253, s[32:35], 0 offen offset:0 sc1
    s_mov_b64 exec, s[60:61]
    buffer_load_dwordx4 v[56:59], v191, s[32:35], 0 offen offset:1024 sc1
    buffer_load_dwordx4 v[60:63], v191, s[32:35], 0 offen offset:1536 sc1
    s_mov_b64 exec, -1
    buffer_load_dwordx4 v[96:99], v252, s[32:35], 0 offen offset:2048 sc1
    s_mov_b64 exec, s[60:61]
    buffer_load_dwordx4 v[48:51], v190, s[32:35], 0 offen offset:3072 sc1
    buffer_load_dwordx4 v[52:55], v190, s[32:35], 0 offen offset:3584 sc1
    s_mov_b64 exec, -1
    buffer_load_dwordx4 v[100:103], v252, s[32:35], 0 offen offset:0 sc1
    s_mov_b64 exec, s[60:61]
    buffer_load_dwordx4 v[40:43], v190, s[32:35], 0 offen offset:1024 sc1
    buffer_load_dwordx4 v[44:47], v190, s[32:35], 0 offen offset:1536 sc1
    s_mov_b64 exec, -1
    v_exp_f32 v152, v152
    v_exp_f32 v153, v153
    v_exp_f32 v154, v154
    v_exp_f32 v155, v155
    v_exp_f32 v160, v160
    v_exp_f32 v161, v161
    v_mfma_f32_32x32x16_bf16 v[168:183], v[104:107], v[112:115], v[136:151]
    v_exp_f32 v162, v162
    v_exp_f32 v163, v163
    v_cvt_pk_bf16_f32 v224, v152, v153
    v_cvt_pk_bf16_f32 v225, v154, v155
    v_cvt_pk_bf16_f32 v226, v160, v161
    v_cvt_pk_bf16_f32 v227, v162, v163
    v_exp_f32 v156, v156
    buffer_load_dwordx4 v[120:123], v251, s[32:35], 0 offen offset:2048 sc1
    v_exp_f32 v157, v157
    v_mfma_f32_32x32x16_bf16 v[208:223], v[72:75], v[224:227], 0
    v_exp_f32 v158, v158
    v_exp_f32 v159, v159
    v_exp_f32 v164, v164
    v_exp_f32 v165, v165
    v_exp_f32 v166, v166
    v_exp_f32 v167, v167
    v_cvt_pk_bf16_f32 v228, v156, v157
    v_cvt_pk_bf16_f32 v229, v158, v159
    v_cvt_pk_bf16_f32 v230, v164, v165
    v_cvt_pk_bf16_f32 v231, v166, v167
    v_exp_f32 v168, v168
    v_exp_f32 v169, v169
    s_mov_b64 exec, s[60:61]
    buffer_load_dwordx4 v[32:35], v189, s[32:35], 0 offen offset:3072 sc1
    buffer_load_dwordx4 v[36:39], v189, s[32:35], 0 offen offset:3584 sc1
    s_mov_b64 exec, -1
    v_mfma_f32_32x32x16_bf16 v[208:223], v[76:79], v[228:231], v[208:223]
    v_exp_f32 v170, v170
    v_exp_f32 v171, v171
    v_exp_f32 v176, v176
    v_exp_f32 v177, v177
    v_mfma_f32_32x32x16_bf16 v[152:167], v[108:111], v[116:119], v[136:151]
    v_exp_f32 v178, v178
    v_exp_f32 v179, v179
    v_cvt_pk_bf16_f32 v232, v168, v169
    v_cvt_pk_bf16_f32 v233, v170, v171
    v_cvt_pk_bf16_f32 v234, v176, v177
    v_cvt_pk_bf16_f32 v235, v178, v179
    v_exp_f32 v172, v172
    v_exp_f32 v173, v173
    buffer_load_dwordx4 v[124:127], v251, s[32:35], 0 offen offset:0 sc1
    v_mfma_f32_32x32x16_bf16 v[192:207], v[72:75], v[232:235], 0
    v_exp_f32 v174, v174
    v_exp_f32 v175, v175
    v_exp_f32 v180, v180
    v_exp_f32 v181, v181
    v_exp_f32 v182, v182
    v_exp_f32 v183, v183
    v_cvt_pk_bf16_f32 v236, v172, v173
    v_cvt_pk_bf16_f32 v237, v174, v175
    v_cvt_pk_bf16_f32 v238, v180, v181
    v_cvt_pk_bf16_f32 v239, v182, v183
    v_exp_f32 v152, v152
    v_exp_f32 v153, v153
    v_mfma_f32_32x32x16_bf16 v[192:207], v[76:79], v[236:239], v[192:207]
    s_mov_b64 exec, s[60:61]
    buffer_load_dwordx4 v[24:27], v189, s[32:35], 0 offen offset:1024 sc1
    buffer_load_dwordx4 v[28:31], v189, s[32:35], 0 offen offset:1536 sc1
    s_mov_b64 exec, -1
    v_exp_f32 v154, v154
    v_exp_f32 v155, v155
    v_exp_f32 v160, v160
    v_exp_f32 v161, v161
    v_xor_b32 v136, s50, v136
    v_xor_b32 v137, s50, v137
    v_xor_b32 v138, s50, v138
    v_xor_b32 v139, s50, v139
    v_xor_b32 v140, s50, v140
    v_xor_b32 v141, s50, v141
    v_xor_b32 v142, s50, v142
    v_xor_b32 v143, s50, v143
    v_xor_b32 v144, s50, v144
    v_xor_b32 v145, s50, v145
    v_xor_b32 v146, s50, v146
    v_xor_b32 v147, s50, v147
    v_xor_b32 v148, s50, v148
    v_xor_b32 v149, s50, v149
    v_xor_b32 v150, s50, v150
    v_xor_b32 v151, s50, v151
    s_waitcnt vmcnt(12)
    v_max3_u32 v248, v88, v92, v64
    v_max3_u32 v248, v248, v68, v56
    v_max_u32 v248, v248, v60
    v_cmp_eq_u32 vcc, -1, v248
    s_cbranch_vccnz L_slow_38
L_ok_37:
    v_mfma_f32_32x32x16_bf16 v[168:183], v[88:91], v[112:115], 0
    v_exp_f32 v162, v162
    v_exp_f32 v163, v163
    v_cvt_pk_bf16_f32 v224, v152, v153
    v_cvt_pk_bf16_f32 v225, v154, v155
    v_cvt_pk_bf16_f32 v226, v160, v161
    v_cvt_pk_bf16_f32 v227, v162, v163
    v_exp_f32 v156, v156
    v_exp_f32 v157, v157
    v_mfma_f32_32x32x16_bf16 v[208:223], v[80:83], v[224:227], v[208:223]
    buffer_load_dwordx4 v[128:131], v250, s[32:35], 0 offen offset:2048 sc1
    v_exp_f32 v158, v158
    v_exp_f32 v159, v159
    v_exp_f32 v164, v164
    v_exp_f32 v165, v165
    v_exp_f32 v166, v166
    v_exp_f32 v167, v167
    v_cvt_pk_bf16_f32 v228, v156, v157
    v_cvt_pk_bf16_f32 v229, v158, v159
    v_cvt_pk_bf16_f32 v230, v164, v165
    v_cvt_pk_bf16_f32 v231, v166, v167
    v_exp_f32 v168, v168
    v_exp_f32 v169, v169
    v_mfma_f32_32x32x16_bf16 v[208:223], v[84:87], v[228:231], v[208:223]
    v_exp_f32 v170, v170
    s_mov_b64 exec, s[60:61]
    buffer_load_dwordx4 v[16:19], v188, s[32:35], 0 offen offset:3072 sc1
    buffer_load_dwordx4 v[20:23], v188, s[32:35], 0 offen offset:3584 sc1
    s_mov_b64 exec, -1
    v_exp_f32 v171, v171
    v_exp_f32 v176, v176
    v_exp_f32 v177, v177
    v_mfma_f32_32x32x16_bf16 v[152:167], v[88:91], v[116:119], 0
    v_exp_f32 v178, v178
    v_exp_f32 v179, v179
    v_cvt_pk_bf16_f32 v232, v168, v169
    v_cvt_pk_bf16_f32 v233, v170, v171
    v_cvt_pk_bf16_f32 v234, v176, v177
    v_cvt_pk_bf16_f32 v235, v178, v179
    v_exp_f32 v172, v172
    v_exp_f32 v173, v173
    v_mfma_f32_32x32x16_bf16 v[192:207], v[64:67], v[232:235], v[192:207]
    v_exp_f32 v174, v174
    buffer_load_dwordx4 v[132:135], v250, s[32:35], 0 offen offset:0 sc1
    v_exp_f32 v175, v175
    v_exp_f32 v180, v180
    v_exp_f32 v181, v181
    v_exp_f32 v182, v182
    v_exp_f32 v183, v183
    v_cvt_pk_bf16_f32 v236, v172, v173
    v_cvt_pk_bf16_f32 v237, v174, v175
    v_cvt_pk_bf16_f32 v238, v180, v181
    v_cvt_pk_bf16_f32 v239, v182, v183
    v_exp_f32 v152, v152
    v_exp_f32 v153, v153
    v_mfma_f32_32x32x16_bf16 v[192:207], v[68:71], v[236:239], v[192:207]
    v_exp_f32 v154, v154
    v_exp_f32 v155, v155
    s_mov_b64 exec, s[60:61]
    buffer_load_dwordx4 v[8:11], v188, s[32:35], 0 offen offset:1024 sc1
    buffer_load_dwordx4 v[12:15], v188, s[32:35], 0 offen offset:1536 sc1
    s_mov_b64 exec, -1
    v_exp_f32 v160, v160
    v_exp_f32 v161, v161
    v_mfma_f32_32x32x16_bf16 v[168:183], v[92:95], v[112:115], 0
    v_exp_f32 v162, v162
    v_exp_f32 v163, v163
    v_cvt_pk_bf16_f32 v224, v152, v153
    v_cvt_pk_bf16_f32 v225, v154, v155
    v_cvt_pk_bf16_f32 v226, v160, v161
    v_cvt_pk_bf16_f32 v227, v162, v163
    v_exp_f32 v156, v156
    v_exp_f32 v157, v157
    v_mfma_f32_32x32x16_bf16 v[208:223], v[64:67], v[224:227], v[208:223]
    v_exp_f32 v158, v158
    v_exp_f32 v159, v159
    buffer_load_dwordx4 a[192:195], v5, s[24:27], s62 offen offset:0 sc1
    v_exp_f32 v164, v164
    v_exp_f32 v165, v165
    v_exp_f32 v166, v166
    v_exp_f32 v167, v167
    v_cvt_pk_bf16_f32 v228, v156, v157
    v_cvt_pk_bf16_f32 v229, v158, v159
    v_cvt_pk_bf16_f32 v230, v164, v165
    v_cvt_pk_bf16_f32 v231, v166, v167
    v_exp_f32 v168, v168
    v_exp_f32 v169, v169
    v_mfma_f32_32x32x16_bf16 v[208:223], v[68:71], v[228:231], v[208:223]
    v_exp_f32 v170, v170
    v_exp_f32 v171, v171
    v_exp_f32 v176, v176
    buffer_load_dwordx4 a[196:199], v5, s[24:27], s62 offen offset:1024 sc1
    v_exp_f32 v177, v177
    v_mfma_f32_32x32x16_bf16 v[152:167], v[92:95], v[116:119], 0
    v_exp_f32 v178, v178
    v_exp_f32 v179, v179
    v_cvt_pk_bf16_f32 v232, v168, v169
    v_cvt_pk_bf16_f32 v233, v170, v171
    v_cvt_pk_bf16_f32 v234, v176, v177
    v_cvt_pk_bf16_f32 v235, v178, v179
    v_exp_f32 v172, v172
    v_exp_f32 v173, v173
    v_mfma_f32_32x32x16_bf16 v[192:207], v[56:59], v[232:235], v[192:207]
    v_exp_f32 v174, v174
    v_exp_f32 v175, v175
    v_exp_f32 v180, v180
    buffer_load_dwordx4 a[200:203], v5, s[24:27], s62 offen offset:2048 sc1
    v_exp_f32 v181, v181
    v_exp_f32 v182, v182
    v_exp_f32 v183, v183
    v_cvt_pk_bf16_f32 v236, v172, v173
    v_cvt_pk_bf16_f32 v237, v174, v175
    v_cvt_pk_bf16_f32 v238, v180, v181
    v_cvt_pk_bf16_f32 v239, v182, v183
    v_exp_f32 v152, v152
    v_exp_f32 v153, v153
    v_mfma_f32_32x32x16_bf16 v[192:207], v[60:63], v[236:239], v[192:207]
    v_exp_f32 v154, v154
    v_exp_f32 v155, v155
    v_exp_f32 v160, v160
    v_exp_f32 v161, v161
    buffer_load_dwordx4 a[204:207], v5, s[24:27], s62 offen offset:3072 sc1
    s_add_u32 s62, s62, 4096
    s_waitcnt vmcnt(16)
    v_max3_u32 v248, v96, v100, v48
    v_max3_u32 v248, v248, v52, v40
    v_max_u32 v248, v248, v44
    v_cmp_eq_u32 vcc, -1, v248
    s_cbranch_vccnz L_slow_40
L_ok_39:
    v_mfma_f32_32x32x16_bf16 v[168:183], v[96:99], v[112:115], 0
    v_exp_f32 v162, v162
    v_exp_f32 v163, v163
    v_cvt_pk_bf16_f32 v224, v152, v153
    v_cvt_pk_bf16_f32 v225, v154, v155
    v_cvt_pk_bf16_f32 v226, v160, v161
    v_cvt_pk_bf16_f32 v227, v162, v163
    v_exp_f32 v156, v156
    v_exp_f32 v157, v157
    v_mfma_f32_32x32x16_bf16 v[208:223], v[56:59], v[224:227], v[208:223]
    v_exp_f32 v158, v158
    v_exp_f32 v159, v159
    v_exp_f32 v164, v164
    v_exp_f32 v165, v165
    buffer_load_dwordx4 a[208:211], v5, s[24:27], s62 offen offset:0 sc1
    v_exp_f32 v166, v166
    v_exp_f32 v167, v167
    v_cvt_pk_bf16_f32 v228, v156, v157
    v_cvt_pk_bf16_f32 v229, v158, v159
    v_cvt_pk_bf16_f32 v230, v164, v165
    v_cvt_pk_bf16_f32 v231, v166, v167
    v_exp_f32 v168, v168
    v_exp_f32 v169, v169
    v_mfma_f32_32x32x16_bf16 v[208:223], v[60:63], v[228:231], v[208:223]
    v_exp_f32 v170, v170
    v_exp_f32 v171, v171
    v_exp_f32 v176, v176
    v_exp_f32 v177, v177
    v_mfma_f32_32x32x16_bf16 v[152:167], v[96:99], v[116:119], 0
    buffer_load_dwordx4 a[212:215], v5, s[24:27], s62 offen offset:1024 sc1
    v_exp_f32 v178, v178
    v_exp_f32 v179, v179
    v_cvt_pk_bf16_f32 v232, v168, v169
    v_cvt_pk_bf16_f32 v233, v170, v171
    v_cvt_pk_bf16_f32 v234, v176, v177
    v_cvt_pk_bf16_f32 v235, v178, v179
    v_exp_f32 v172, v172
    v_exp_f32 v173, v173
    v_mfma_f32_32x32x16_bf16 v[192:207], v[48:51], v[232:235], v[192:207]
    v_exp_f32 v174, v174
    v_exp_f32 v175, v175
    v_exp_f32 v180, v180
    v_exp_f32 v181, v181
    v_exp_f32 v182, v182
    buffer_load_dwordx4 a[216:219], v5, s[24:27], s62 offen offset:2048 sc1
    v_exp_f32 v183, v183
    v_cvt_pk_bf16_f32 v236, v172, v173
    v_cvt_pk_bf16_f32 v237, v174, v175
    v_cvt_pk_bf16_f32 v238, v180, v181
    v_cvt_pk_bf16_f32 v239, v182, v183
    v_exp_f32 v152, v152
    v_exp_f32 v153, v153
    v_mfma_f32_32x32x16_bf16 v[192:207], v[52:55], v[236:239], v[192:207]
    v_exp_f32 v154, v154
    v_exp_f32 v155, v155
    v_exp_f32 v160, v160
    v_exp_f32 v161, v161
    v_mfma_f32_32x32x16_bf16 v[168:183], v[100:103], v[112:115], 0
    v_exp_f32 v162, v162
    buffer_load_dwordx4 a[220:223], v5, s[24:27], s62 offen offset:3072 sc1
    s_add_u32 s62, s62, 4096
    v_exp_f32 v163, v163
    v_cvt_pk_bf16_f32 v224, v152, v153
    v_cvt_pk_bf16_f32 v225, v154, v155
    v_cvt_pk_bf16_f32 v226, v160, v161
    v_cvt_pk_bf16_f32 v227, v162, v163
    v_exp_f32 v156, v156
    v_exp_f32 v157, v157
    v_mfma_f32_32x32x16_bf16 v[208:223], v[48:51], v[224:227], v[208:223]
    v_exp_f32 v158, v158
    v_exp_f32 v159, v159
    v_exp_f32 v164, v164
    v_exp_f32 v165, v165
    v_exp_f32 v166, v166
    v_exp_f32 v167, v167
    buffer_load_dwordx4 a[224:227], v5, s[24:27], s62 offen offset:0 sc1
    v_cvt_pk_bf16_f32 v228, v156, v157
    v_cvt_pk_bf16_f32 v229, v158, v159
    v_cvt_pk_bf16_f32 v230, v164, v165
    v_cvt_pk_bf16_f32 v231, v166, v167
    v_exp_f32 v168, v168
    v_exp_f32 v169, v169
    v_mfma_f32_32x32x16_bf16 v[208:223], v[52:55], v[228:231], v[208:223]
    v_exp_f32 v170, v170
    v_exp_f32 v171, v171
    v_exp_f32 v176, v176
    v_exp_f32 v177, v177
    v_mfma_f32_32x32x16_bf16 v[152:167], v[100:103], v[116:119], 0
    v_exp_f32 v178, v178
    v_exp_f32 v179, v179
    buffer_load_dwordx4 a[228:231], v5, s[24:27], s62 offen offset:1024 sc1
    v_cvt_pk_bf16_f32 v232, v168, v169
    v_cvt_pk_bf16_f32 v233, v170, v171
    v_cvt_pk_bf16_f32 v234, v176, v177
    v_cvt_pk_bf16_f32 v235, v178, v179
    v_exp_f32 v172, v172
    v_exp_f32 v173, v173
    v_mfma_f32_32x32x16_bf16 v[192:207], v[40:43], v[232:235], v[192:207]
    v_exp_f32 v174, v174
    v_exp_f32 v175, v175
    v_exp_f32 v180, v180
    v_exp_f32 v181, v181
    v_exp_f32 v182, v182
    v_exp_f32 v183, v183
    v_cvt_pk_bf16_f32 v236, v172, v173
    buffer_load_dwordx4 a[232:235], v5, s[24:27], s62 offen offset:2048 sc1
    v_cvt_pk_bf16_f32 v237, v174, v175
    v_cvt_pk_bf16_f32 v238, v180, v181
    v_cvt_pk_bf16_f32 v239, v182, v183
    v_exp_f32 v152, v152
    v_exp_f32 v153, v153
    v_mfma_f32_32x32x16_bf16 v[192:207], v[44:47], v[236:239], v[192:207]
    v_exp_f32 v154, v154
    v_exp_f32 v155, v155
    v_exp_f32 v160, v160
    v_exp_f32 v161, v161
    s_waitcnt vmcnt(17)
    v_max3_u32 v248, v120, v124, v32
    v_max3_u32 v248, v248, v36, v24
    v_max_u32 v248, v248, v28
    v_cmp_eq_u32 vcc, -1, v248
    s_cbranch_vccnz L_slow_42
L_ok_41:
    v_mfma_f32_32x32x16_bf16 v[168:183], v[120:123], v[112:115], 0
    v_exp_f32 v162, v162
    v_exp_f32 v163, v163
    buffer_load_dwordx4 a[236:239], v5, s[24:27], s62 offen offset:3072 sc1
    s_add_u32 s62, s62, 4096
    v_cvt_pk_bf16_f32 v224, v152, v153
    v_cvt_pk_bf16_f32 v225, v154, v155
    v_cvt_pk_bf16_f32 v226, v160, v161
    v_cvt_pk_bf16_f32 v227, v162, v163
    v_exp_f32 v156, v156
    v_exp_f32 v157, v157
    v_mfma_f32_32x32x16_bf16 v[208:223], v[40:43], v[224:227], v[208:223]
    v_exp_f32 v158, v158
    v_exp_f32 v159, v159
    v_exp_f32 v164, v164
    v_exp_f32 v165, v165
    v_exp_f32 v166, v166
    v_exp_f32 v167, v167
    v_cvt_pk_bf16_f32 v228, v156, v157
    buffer_load_dwordx4 a[240:243], v5, s[24:27], s62 offen offset:0 sc1
    v_cvt_pk_bf16_f32 v229, v158, v159
    v_cvt_pk_bf16_f32 v230, v164, v165
    v_cvt_pk_bf16_f32 v231, v166, v167
    v_exp_f32 v168, v168
    v_exp_f32 v169, v169
    v_mfma_f32_32x32x16_bf16 v[208:223], v[44:47], v[228:231], v[208:223]
    v_exp_f32 v170, v170
    v_exp_f32 v171, v171
    v_exp_f32 v176, v176
    v_exp_f32 v177, v177
    v_mfma_f32_32x32x16_bf16 v[152:167], v[120:123], v[116:119], 0
    v_exp_f32 v178, v178
    v_exp_f32 v179, v179
    buffer_load_dwordx4 a[244:247], v5, s[24:27], s62 offen offset:1024 sc1
    v_cvt_pk_bf16_f32 v232, v168, v169
    v_cvt_pk_bf16_f32 v233, v170, v171
    v_cvt_pk_bf16_f32 v234, v176, v177
    v_cvt_pk_bf16_f32 v235, v178, v179
    v_exp_f32 v172, v172
    v_exp_f32 v173, v173
    v_mfma_f32_32x32x16_bf16 v[192:207], v[32:35], v[232:235], v[192:207]
    v_exp_f32 v174, v174
    v_exp_f32 v175, v175
    v_exp_f32 v180, v180
    v_exp_f32 v181, v181
    v_exp_f32 v182, v182
    v_exp_f32 v183, v183
    v_cvt_pk_bf16_f32 v236, v172, v173
    buffer_load_dwordx4 a[248:251], v5, s[24:27], s62 offen offset:2048 sc1
    v_cvt_pk_bf16_f32 v237, v174, v175
    v_cvt_pk_bf16_f32 v238, v180, v181
    v_cvt_pk_bf16_f32 v239, v182, v183
    v_exp_f32 v152, v152
    v_exp_f32 v153, v153
    v_mfma_f32_32x32x16_bf16 v[192:207], v[36:39], v[236:239], v[192:207]
    v_exp_f32 v154, v154
    v_exp_f32 v155, v155
    v_exp_f32 v160, v160
    v_exp_f32 v161, v161
    v_mfma_f32_32x32x16_bf16 v[168:183], v[124:127], v[112:115], 0
    v_exp_f32 v162, v162
    v_exp_f32 v163, v163
    buffer_load_dwordx4 a[252:255], v5, s[24:27], s62 offen offset:3072 sc1
    s_add_u32 s62, s62, 4096
    v_cvt_pk_bf16_f32 v224, v152, v153
    v_cvt_pk_bf16_f32 v225, v154, v155
    v_cvt_pk_bf16_f32 v226, v160, v161
    v_cvt_pk_bf16_f32 v227, v162, v163
    v_exp_f32 v156, v156
    v_exp_f32 v157, v157
    v_mfma_f32_32x32x16_bf16 v[208:223], v[32:35], v[224:227], v[208:223]
    v_exp_f32 v158, v158
    v_exp_f32 v159, v159
    v_exp_f32 v164, v164
    v_exp_f32 v165, v165
    v_exp_f32 v166, v166
    v_exp_f32 v167, v167
    v_cvt_pk_bf16_f32 v228, v156, v157
    v_cvt_pk_bf16_f32 v229, v158, v159
    v_cvt_pk_bf16_f32 v230, v164, v165
    v_cvt_pk_bf16_f32 v231, v166, v167
    v_exp_f32 v168, v168
    v_exp_f32 v169, v169
    v_mfma_f32_32x32x16_bf16 v[208:223], v[36:39], v[228:231], v[208:223]
    v_exp_f32 v170, v170
    v_exp_f32 v171, v171
    v_exp_f32 v176, v176
    v_exp_f32 v177, v177
    v_mfma_f32_32x32x16_bf16 v[152:167], v[124:127], v[116:119], 0
    v_exp_f32 v178, v178
    v_exp_f32 v179, v179
    v_cvt_pk_bf16_f32 v232, v168, v169
    v_cvt_pk_bf16_f32 v233, v170, v171
    v_cvt_pk_bf16_f32 v234, v176, v177
    v_cvt_pk_bf16_f32 v235, v178, v179
    v_exp_f32 v172, v172
    v_exp_f32 v173, v173
    v_mfma_f32_32x32x16_bf16 v[192:207], v[24:27], v[232:235], v[192:207]
    v_exp_f32 v174, v174
    v_exp_f32 v175, v175
    v_exp_f32 v180, v180
    v_exp_f32 v181, v181
    v_exp_f32 v182, v182
    v_exp_f32 v183, v183
    v_cvt_pk_bf16_f32 v236, v172, v173
    v_cvt_pk_bf16_f32 v237, v174, v175
    v_cvt_pk_bf16_f32 v238, v180, v181
    v_cvt_pk_bf16_f32 v239, v182, v183
    v_exp_f32 v152, v152
    v_exp_f32 v153, v153
    v_mfma_f32_32x32x16_bf16 v[192:207], v[28:31], v[236:239], v[192:207]
    v_exp_f32 v154, v154
    v_exp_f32 v155, v155
    v_exp_f32 v160, v160
    v_exp_f32 v161, v161
    s_waitcnt vmcnt(16)
    v_max3_u32 v248, v128, v132, v16
    v_max3_u32 v248, v248, v20, v8
    v_max_u32 v248, v248, v12
    v_cmp_eq_u32 vcc, -1, v248
    s_cbranch_vccnz L_slow_44
L_ok_43:
    v_mfma_f32_32x32x16_bf16 v[168:183], v[128:131], v[112:115], 0
    v_exp_f32 v162, v162
    v_exp_f32 v163, v163
    v_cvt_pk_bf16_f32 v224, v152, v153
    v_cvt_pk_bf16_f32 v225, v154, v155
    v_cvt_pk_bf16_f32 v226, v160, v161
    v_cvt_pk_bf16_f32 v227, v162, v163
    v_exp_f32 v156, v156
    v_exp_f32 v157, v157
    v_mfma_f32_32x32x16_bf16 v[208:223], v[24:27], v[224:227], v[208:223]
    v_exp_f32 v158, v158
    v_exp_f32 v159, v159
    v_exp_f32 v164, v164
    v_exp_f32 v165, v165
    v_exp_f32 v166, v166
    v_exp_f32 v167, v167
    v_cvt_pk_bf16_f32 v228, v156, v157
    v_cvt_pk_bf16_f32 v229, v158, v159
    v_cvt_pk_bf16_f32 v230, v164, v165
    v_cvt_pk_bf16_f32 v231, v166, v167
    v_exp_f32 v168, v168
    v_exp_f32 v169, v169
    v_mfma_f32_32x32x16_bf16 v[208:223], v[28:31], v[228:231], v[208:223]
    v_exp_f32 v170, v170
    v_exp_f32 v171, v171
    v_exp_f32 v176, v176
    v_exp_f32 v177, v177
    v_mfma_f32_32x32x16_bf16 v[152:167], v[128:131], v[116:119], v[136:151]
    v_exp_f32 v178, v178
    v_exp_f32 v179, v179
    v_cvt_pk_bf16_f32 v232, v168, v169
    v_cvt_pk_bf16_f32 v233, v170, v171
    v_cvt_pk_bf16_f32 v234, v176, v177
    v_cvt_pk_bf16_f32 v235, v178, v179
    v_exp_f32 v172, v172
    v_exp_f32 v173, v173
    v_mfma_f32_32x32x16_bf16 v[192:207], v[16:19], v[232:235], v[192:207]
    v_exp_f32 v174, v174
    v_exp_f32 v175, v175
    v_exp_f32 v180, v180
    v_exp_f32 v181, v181
    v_exp_f32 v182, v182
    v_exp_f32 v183, v183
    v_cvt_pk_bf16_f32 v236, v172, v173
    v_cvt_pk_bf16_f32 v237, v174, v175
    v_cvt_pk_bf16_f32 v238, v180, v181
    v_cvt_pk_bf16_f32 v239, v182, v183
    v_exp_f32 v152, v152
    v_exp_f32 v153, v153
    v_mfma_f32_32x32x16_bf16 v[192:207], v[20:23], v[236:239], v[192:207]
    v_exp_f32 v154, v154
    v_exp_f32 v155, v155
    v_exp_f32 v160, v160
    v_exp_f32 v161, v161
    v_mfma_f32_32x32x16_bf16 v[168:183], v[132:135], v[112:115], v[136:151]
    v_exp_f32 v162, v162
    v_exp_f32 v163, v163
    v_cvt_pk_bf16_f32 v224, v152, v153
    v_cvt_pk_bf16_f32 v225, v154, v155
    v_cvt_pk_bf16_f32 v226, v160, v161
    v_cvt_pk_bf16_f32 v227, v162, v163
    v_exp_f32 v156, v156
    v_exp_f32 v157, v157
    v_mfma_f32_32x32x16_bf16 v[208:223], v[16:19], v[224:227], v[208:223]
    v_exp_f32 v158, v158
    v_exp_f32 v159, v159
    v_exp_f32 v164, v164
    v_exp_f32 v165, v165
    v_exp_f32 v166, v166
    v_exp_f32 v167, v167
    v_cvt_pk_bf16_f32 v228, v156, v157
    v_cvt_pk_bf16_f32 v229, v158, v159
    v_cvt_pk_bf16_f32 v230, v164, v165
    v_cvt_pk_bf16_f32 v231, v166, v167
    v_exp_f32 v168, v168
    v_exp_f32 v169, v169
    v_mfma_f32_32x32x16_bf16 v[208:223], v[20:23], v[228:231], v[208:223]
    v_exp_f32 v170, v170
    v_exp_f32 v171, v171
    v_exp_f32 v176, v176
    v_exp_f32 v177, v177
    v_exp_f32 v178, v178
    v_exp_f32 v179, v179
    v_cvt_pk_bf16_f32 v232, v168, v169
    v_cvt_pk_bf16_f32 v233, v170, v171
    v_cvt_pk_bf16_f32 v234, v176, v177
    v_cvt_pk_bf16_f32 v235, v178, v179
    v_exp_f32 v172, v172
    v_exp_f32 v173, v173
    v_mfma_f32_32x32x16_bf16 v[192:207], v[8:11], v[232:235], v[192:207]
    v_exp_f32 v174, v174
    v_exp_f32 v175, v175
    v_exp_f32 v180, v180
    v_exp_f32 v181, v181
    v_exp_f32 v182, v182
    v_exp_f32 v183, v183
    v_cvt_pk_bf16_f32 v236, v172, v173
    v_cvt_pk_bf16_f32 v237, v174, v175
    v_cvt_pk_bf16_f32 v238, v180, v181
    v_cvt_pk_bf16_f32 v239, v182, v183
    v_bfe_u32 v248, v1, 4, 1
    v_lshlrev_b32 v250, 14, v248
    v_mfma_f32_32x32x16_bf16 v[192:207], v[12:15], v[236:239], v[192:207]
    v_lshrrev_b32 v248, 5, v1
    v_lshl_add_u32 v250, v248, 8, v250
    v_lshl_add_u32 v250, v2, 4, v250
    s_lshl_b32 s50, s47, 16
    s_lshl_b32 s51, s48, 11
    s_add_u32 s50, s50, s51
    s_lshl_b32 s51, s46, 9
    s_add_u32 s50, s50, s51
    s_add_u32 s50, s50, 23068672
    s_add_u32 s51, s50, 32768
    s_mov_b32 s52, 0x1f800000
    s_mov_b32 s53, 0x40000000
    v_pk_add_f32 v[164:165], v[208:209], v[210:211]
    v_pk_add_f32 v[166:167], v[212:213], v[214:215]
    v_pk_add_f32 v[164:165], v[164:165], v[166:167]
    v_add_f32 v164, v164, v165
    v_fma_f32 v164, v164, 0, v216
    v_subrev_u32 v164, s52, v164
    v_pk_add_f32 v[160:161], v[192:193], v[194:195]
    v_pk_add_f32 v[162:163], v[196:197], v[198:199]
    v_pk_add_f32 v[160:161], v[160:161], v[162:163]
    v_add_f32 v160, v160, v161
    v_fma_f32 v160, v160, 0, v200
    v_subrev_u32 v160, s52, v160
    v_max_u32 v160, v160, v164
    v_cmp_lt_u32 vcc, s53, v160
    s_cbranch_vccnz L_smax_call1
L_smax_ret1:
    v_rcp_f32 v248, v216
    s_nop 0
    v_mul_f32 v208, v248, v208
    v_mul_f32 v209, v248, v209
    v_mul_f32 v210, v248, v210
    v_mul_f32 v211, v248, v211
    v_mul_f32 v212, v248, v212
    v_mul_f32 v213, v248, v213
    v_mul_f32 v214, v248, v214
    v_mul_f32 v215, v248, v215
    v_cvt_pk_bf16_f32 v156, v208, v209
    v_cvt_pk_bf16_f32 v157, v210, v211
    v_cvt_pk_bf16_f32 v158, v212, v213
    v_cvt_pk_bf16_f32 v159, v214, v215
    v_min_u32 v156, -2, v156
    buffer_store_dwordx4 v[156:159], v250, s[24:27], s51 offen sc1
    v_rcp_f32 v248, v200
    s_nop 0
    v_mul_f32 v192, v248, v192
    v_mul_f32 v193, v248, v193
    v_mul_f32 v194, v248, v194
    v_mul_f32 v195, v248, v195
    v_mul_f32 v196, v248, v196
    v_mul_f32 v197, v248, v197
    v_mul_f32 v198, v248, v198
    v_mul_f32 v199, v248, v199
    v_cvt_pk_bf16_f32 v152, v192, v193
    v_cvt_pk_bf16_f32 v153, v194, v195
    v_cvt_pk_bf16_f32 v154, v196, v197
    v_cvt_pk_bf16_f32 v155, v198, v199
    v_min_u32 v152, -2, v152
    buffer_store_dwordx4 v[152:155], v250, s[24:27], s50 offen sc1
    v_add_u32 v6, 65536, v5
    s_lshl_b32 s50, s47, 16
    s_lshl_b32 s51, s46, 14
    s_add_u32 s50, s50, s51
    s_add_u32 s50, s50, 23068672
    s_add_u32 s51, s50, 4096
    s_add_u32 s52, s50, 8192
    s_add_u32 s53, s50, 12288
    v_lshrrev_b32 v152, 2, v2
    v_lshl_add_u32 v153, v3, 3, v152
    v_lshlrev_b32 v212, 7, v153
    v_lshrrev_b32 v152, 1, v152
    v_and_b32 v153, 1, v3
    v_lshl_or_b32 v152, v153, 1, v152
    v_lshl_add_u32 v212, v152, 5, v212
    v_and_b32 v152, 3, v0
    v_lshl_add_u32 v212, v152, 3, v212
    v_xor_b32 v213, 32, v212
    v_xor_b32 v214, 64, v212
    v_xor_b32 v215, 96, v212
    ds_read_b64_tr_b16 v[164:165], v212 offset:0
    ds_read_b64_tr_b16 v[166:167], v212 offset:512
    ds_read_b64_tr_b16 v[168:169], v213 offset:0
    ds_read_b64_tr_b16 v[170:171], v213 offset:512
    ds_read_b64_tr_b16 v[172:173], v214 offset:0
    ds_read_b64_tr_b16 v[174:175], v214 offset:512
    ds_read_b64_tr_b16 v[176:177], v215 offset:0
    ds_read_b64_tr_b16 v[178:179], v215 offset:512
    ds_read_b64_tr_b16 v[180:181], v212 offset:4096
    ds_read_b64_tr_b16 v[182:183], v212 offset:4608
    ds_read_b64_tr_b16 v[184:185], v213 offset:4096
    ds_read_b64_tr_b16 v[186:187], v213 offset:4608
    ds_read_b64_tr_b16 v[188:189], v214 offset:4096
    ds_read_b64_tr_b16 v[190:191], v214 offset:4608
    ds_read_b64_tr_b16 v[192:193], v215 offset:4096
    ds_read_b64_tr_b16 v[194:195], v215 offset:4608
    v_and_b32 v152, 1, v3
    v_lshlrev_b32 v7, 5, v152
    v_lshrrev_b32 v152, 1, v3
    v_lshl_add_u32 v7, v152, 4, v7
    v_lshl_add_u32 v7, v2, 10, v7
    s_lshl_b32 s54, s46, 12
    s_add_u32 s54, s54, 135168
    v_add_u32 v152, s54, v5
    s_lshl_b32 s54, s46, 10
    s_add_u32 s54, s54, 135168
    v_add_u32 v153, s54, v5
    s_waitcnt vmcnt(2)
    s_barrier
    s_waitcnt lgkmcnt(8)
    v_mfma_f32_16x16x32_bf16 a[64:67], a[192:195], v[164:167], 0
    ds_read_b64_tr_b16 v[196:197], v212 offset:8192
    ds_read_b64_tr_b16 v[198:199], v212 offset:8704
    v_mfma_f32_16x16x32_bf16 a[68:71], a[192:195], v[168:171], 0
    ds_read_b64_tr_b16 v[200:201], v213 offset:8192
    ds_read_b64_tr_b16 v[202:203], v213 offset:8704
    v_mfma_f32_16x16x32_bf16 a[72:75], a[192:195], v[172:175], 0
    ds_read_b64_tr_b16 v[204:205], v214 offset:8192
    ds_read_b64_tr_b16 v[206:207], v214 offset:8704
    v_mfma_f32_16x16x32_bf16 a[76:79], a[192:195], v[176:179], 0
    ds_read_b64_tr_b16 v[208:209], v215 offset:8192
    ds_read_b64_tr_b16 v[210:211], v215 offset:8704
    s_waitcnt lgkmcnt(8)
    v_mfma_f32_16x16x32_bf16 a[64:67], a[196:199], v[180:183], a[64:67]
    ds_read_b64_tr_b16 v[164:165], v212 offset:12288
    ds_read_b64_tr_b16 v[166:167], v212 offset:12800
    v_mfma_f32_16x16x32_bf16 a[68:71], a[196:199], v[184:187], a[68:71]
    ds_read_b64_tr_b16 v[168:169], v213 offset:12288
    ds_read_b64_tr_b16 v[170:171], v213 offset:12800
    v_mfma_f32_16x16x32_bf16 a[72:75], a[196:199], v[188:191], a[72:75]
    ds_read_b64_tr_b16 v[172:173], v214 offset:12288
    ds_read_b64_tr_b16 v[174:175], v214 offset:12800
    v_mfma_f32_16x16x32_bf16 a[76:79], a[196:199], v[192:195], a[76:79]
    ds_read_b64_tr_b16 v[176:177], v215 offset:12288
    ds_read_b64_tr_b16 v[178:179], v215 offset:12800
    s_waitcnt lgkmcnt(8)
    v_mfma_f32_16x16x32_bf16 a[64:67], a[200:203], v[196:199], a[64:67]
    ds_read_b64_tr_b16 v[180:181], v212 offset:16384
    ds_read_b64_tr_b16 v[182:183], v212 offset:16896
    v_mfma_f32_16x16x32_bf16 a[68:71], a[200:203], v[200:203], a[68:71]
    ds_read_b64_tr_b16 v[184:185], v213 offset:16384
    ds_read_b64_tr_b16 v[186:187], v213 offset:16896
    v_mfma_f32_16x16x32_bf16 a[72:75], a[200:203], v[204:207], a[72:75]
    ds_read_b64_tr_b16 v[188:189], v214 offset:16384
    ds_read_b64_tr_b16 v[190:191], v214 offset:16896
    v_mfma_f32_16x16x32_bf16 a[76:79], a[200:203], v[208:211], a[76:79]
    ds_read_b64_tr_b16 v[192:193], v215 offset:16384
    ds_read_b64_tr_b16 v[194:195], v215 offset:16896
    s_waitcnt lgkmcnt(8)
    v_mfma_f32_16x16x32_bf16 a[64:67], a[204:207], v[164:167], a[64:67]
    ds_read_b64_tr_b16 v[196:197], v212 offset:20480
    ds_read_b64_tr_b16 v[198:199], v212 offset:20992
    v_mfma_f32_16x16x32_bf16 a[68:71], a[204:207], v[168:171], a[68:71]
    ds_read_b64_tr_b16 v[200:201], v213 offset:20480
    ds_read_b64_tr_b16 v[202:203], v213 offset:20992
    v_mfma_f32_16x16x32_bf16 a[72:75], a[204:207], v[172:175], a[72:75]
    ds_read_b64_tr_b16 v[204:205], v214 offset:20480
    ds_read_b64_tr_b16 v[206:207], v214 offset:20992
    v_mfma_f32_16x16x32_bf16 a[76:79], a[204:207], v[176:179], a[76:79]
    ds_read_b64_tr_b16 v[208:209], v215 offset:20480
    ds_read_b64_tr_b16 v[210:211], v215 offset:20992
    s_waitcnt lgkmcnt(8)
    v_mfma_f32_16x16x32_bf16 a[64:67], a[208:211], v[180:183], a[64:67]
    ds_read_b64_tr_b16 v[164:165], v212 offset:24576
    ds_read_b64_tr_b16 v[166:167], v212 offset:25088
    v_mfma_f32_16x16x32_bf16 a[68:71], a[208:211], v[184:187], a[68:71]
    ds_read_b64_tr_b16 v[168:169], v213 offset:24576
    ds_read_b64_tr_b16 v[170:171], v213 offset:25088
    v_mfma_f32_16x16x32_bf16 a[72:75], a[208:211], v[188:191], a[72:75]
    ds_read_b64_tr_b16 v[172:173], v214 offset:24576
    ds_read_b64_tr_b16 v[174:175], v214 offset:25088
    v_mfma_f32_16x16x32_bf16 a[76:79], a[208:211], v[192:195], a[76:79]
    ds_read_b64_tr_b16 v[176:177], v215 offset:24576
    ds_read_b64_tr_b16 v[178:179], v215 offset:25088
    s_waitcnt lgkmcnt(8)
    v_mfma_f32_16x16x32_bf16 a[64:67], a[212:215], v[196:199], a[64:67]
    ds_read_b64_tr_b16 v[180:181], v212 offset:28672
    ds_read_b64_tr_b16 v[182:183], v212 offset:29184
    v_mfma_f32_16x16x32_bf16 a[68:71], a[212:215], v[200:203], a[68:71]
    ds_read_b64_tr_b16 v[184:185], v213 offset:28672
    ds_read_b64_tr_b16 v[186:187], v213 offset:29184
    v_mfma_f32_16x16x32_bf16 a[72:75], a[212:215], v[204:207], a[72:75]
    ds_read_b64_tr_b16 v[188:189], v214 offset:28672
    ds_read_b64_tr_b16 v[190:191], v214 offset:29184
    v_mfma_f32_16x16x32_bf16 a[76:79], a[212:215], v[208:211], a[76:79]
    ds_read_b64_tr_b16 v[192:193], v215 offset:28672
    ds_read_b64_tr_b16 v[194:195], v215 offset:29184
    s_waitcnt lgkmcnt(8)
    v_mfma_f32_16x16x32_bf16 a[64:67], a[216:219], v[164:167], a[64:67]
    ds_read_b64_tr_b16 v[196:197], v212 offset:32768
    ds_read_b64_tr_b16 v[198:199], v212 offset:33280
    v_mfma_f32_16x16x32_bf16 a[68:71], a[216:219], v[168:171], a[68:71]
    ds_read_b64_tr_b16 v[200:201], v213 offset:32768
    ds_read_b64_tr_b16 v[202:203], v213 offset:33280
    v_mfma_f32_16x16x32_bf16 a[72:75], a[216:219], v[172:175], a[72:75]
    ds_read_b64_tr_b16 v[204:205], v214 offset:32768
    ds_read_b64_tr_b16 v[206:207], v214 offset:33280
    v_mfma_f32_16x16x32_bf16 a[76:79], a[216:219], v[176:179], a[76:79]
    ds_read_b64_tr_b16 v[208:209], v215 offset:32768
    ds_read_b64_tr_b16 v[210:211], v215 offset:33280
    s_waitcnt lgkmcnt(8)
    v_mfma_f32_16x16x32_bf16 a[64:67], a[220:223], v[180:183], a[64:67]
    ds_read_b64_tr_b16 v[164:165], v212 offset:36864
    ds_read_b64_tr_b16 v[166:167], v212 offset:37376
    v_mfma_f32_16x16x32_bf16 a[68:71], a[220:223], v[184:187], a[68:71]
    ds_read_b64_tr_b16 v[168:169], v213 offset:36864
    ds_read_b64_tr_b16 v[170:171], v213 offset:37376
    v_mfma_f32_16x16x32_bf16 a[72:75], a[220:223], v[188:191], a[72:75]
    ds_read_b64_tr_b16 v[172:173], v214 offset:36864
    ds_read_b64_tr_b16 v[174:175], v214 offset:37376
    v_mfma_f32_16x16x32_bf16 a[76:79], a[220:223], v[192:195], a[76:79]
    ds_read_b64_tr_b16 v[176:177], v215 offset:36864
    ds_read_b64_tr_b16 v[178:179], v215 offset:37376
    s_waitcnt lgkmcnt(8)
    v_mfma_f32_16x16x32_bf16 a[64:67], a[224:227], v[196:199], a[64:67]
    ds_read_b64_tr_b16 v[180:181], v212 offset:40960
    ds_read_b64_tr_b16 v[182:183], v212 offset:41472
    v_mfma_f32_16x16x32_bf16 a[68:71], a[224:227], v[200:203], a[68:71]
    ds_read_b64_tr_b16 v[184:185], v213 offset:40960
    ds_read_b64_tr_b16 v[186:187], v213 offset:41472
    v_mfma_f32_16x16x32_bf16 a[72:75], a[224:227], v[204:207], a[72:75]
    ds_read_b64_tr_b16 v[188:189], v214 offset:40960
    ds_read_b64_tr_b16 v[190:191], v214 offset:41472
    v_mfma_f32_16x16x32_bf16 a[76:79], a[224:227], v[208:211], a[76:79]
    ds_read_b64_tr_b16 v[192:193], v215 offset:40960
    ds_read_b64_tr_b16 v[194:195], v215 offset:41472
    s_waitcnt vmcnt(0)
    s_barrier
    s_waitcnt lgkmcnt(8)
    v_mfma_f32_16x16x32_bf16 a[64:67], a[228:231], v[164:167], a[64:67]
    ds_read_b64_tr_b16 v[196:197], v212 offset:45056
    ds_read_b64_tr_b16 v[198:199], v212 offset:45568
    v_mfma_f32_16x16x32_bf16 a[68:71], a[228:231], v[168:171], a[68:71]
    ds_read_b64_tr_b16 v[200:201], v213 offset:45056
    ds_read_b64_tr_b16 v[202:203], v213 offset:45568
    buffer_load_dwordx4 v[8:11], v5, s[24:27], s50 offen offset:0 sc1
    v_mfma_f32_16x16x32_bf16 a[72:75], a[228:231], v[172:175], a[72:75]
    ds_read_b64_tr_b16 v[204:205], v214 offset:45056
    ds_read_b64_tr_b16 v[206:207], v214 offset:45568
    v_mfma_f32_16x16x32_bf16 a[76:79], a[228:231], v[176:179], a[76:79]
    ds_read_b64_tr_b16 v[208:209], v215 offset:45056
    ds_read_b64_tr_b16 v[210:211], v215 offset:45568
    buffer_load_dwordx4 v[12:15], v5, s[24:27], s50 offen offset:1024 sc1
    s_waitcnt lgkmcnt(8)
    v_mfma_f32_16x16x32_bf16 a[64:67], a[232:235], v[180:183], a[64:67]
    ds_read_b64_tr_b16 v[164:165], v212 offset:49152
    ds_read_b64_tr_b16 v[166:167], v212 offset:49664
    v_mfma_f32_16x16x32_bf16 a[68:71], a[232:235], v[184:187], a[68:71]
    ds_read_b64_tr_b16 v[168:169], v213 offset:49152
    ds_read_b64_tr_b16 v[170:171], v213 offset:49664
    buffer_load_dwordx4 v[16:19], v5, s[24:27], s50 offen offset:2048 sc1
    v_mfma_f32_16x16x32_bf16 a[72:75], a[232:235], v[188:191], a[72:75]
    ds_read_b64_tr_b16 v[172:173], v214 offset:49152
    ds_read_b64_tr_b16 v[174:175], v214 offset:49664
    v_mfma_f32_16x16x32_bf16 a[76:79], a[232:235], v[192:195], a[76:79]
    ds_read_b64_tr_b16 v[176:177], v215 offset:49152
    ds_read_b64_tr_b16 v[178:179], v215 offset:49664
    buffer_load_dwordx4 v[20:23], v5, s[24:27], s50 offen offset:3072 sc1
    s_waitcnt lgkmcnt(8)
    v_mfma_f32_16x16x32_bf16 a[64:67], a[236:239], v[196:199], a[64:67]
    ds_read_b64_tr_b16 v[180:181], v212 offset:53248
    ds_read_b64_tr_b16 v[182:183], v212 offset:53760
    v_mfma_f32_16x16x32_bf16 a[68:71], a[236:239], v[200:203], a[68:71]
    ds_read_b64_tr_b16 v[184:185], v213 offset:53248
    ds_read_b64_tr_b16 v[186:187], v213 offset:53760
    buffer_load_dwordx4 v[24:27], v5, s[24:27], s51 offen offset:0 sc1
    v_mfma_f32_16x16x32_bf16 a[72:75], a[236:239], v[204:207], a[72:75]
    ds_read_b64_tr_b16 v[188:189], v214 offset:53248
    ds_read_b64_tr_b16 v[190:191], v214 offset:53760
    v_mfma_f32_16x16x32_bf16 a[76:79], a[236:239], v[208:211], a[76:79]
    ds_read_b64_tr_b16 v[192:193], v215 offset:53248
    ds_read_b64_tr_b16 v[194:195], v215 offset:53760
    buffer_load_dwordx4 v[28:31], v5, s[24:27], s51 offen offset:1024 sc1
    s_waitcnt lgkmcnt(8)
    v_mfma_f32_16x16x32_bf16 a[64:67], a[240:243], v[164:167], a[64:67]
    ds_read_b64_tr_b16 v[196:197], v212 offset:57344
    ds_read_b64_tr_b16 v[198:199], v212 offset:57856
    v_mfma_f32_16x16x32_bf16 a[68:71], a[240:243], v[168:171], a[68:71]
    ds_read_b64_tr_b16 v[200:201], v213 offset:57344
    ds_read_b64_tr_b16 v[202:203], v213 offset:57856
    buffer_load_dwordx4 v[32:35], v5, s[24:27], s51 offen offset:2048 sc1
    v_mfma_f32_16x16x32_bf16 a[72:75], a[240:243], v[172:175], a[72:75]
    ds_read_b64_tr_b16 v[204:205], v214 offset:57344
    ds_read_b64_tr_b16 v[206:207], v214 offset:57856
    v_mfma_f32_16x16x32_bf16 a[76:79], a[240:243], v[176:179], a[76:79]
    ds_read_b64_tr_b16 v[208:209], v215 offset:57344
    ds_read_b64_tr_b16 v[210:211], v215 offset:57856
    buffer_load_dwordx4 v[36:39], v5, s[24:27], s51 offen offset:3072 sc1
    s_waitcnt lgkmcnt(8)
    v_mfma_f32_16x16x32_bf16 a[64:67], a[244:247], v[180:183], a[64:67]
    ds_read_b64_tr_b16 v[164:165], v212 offset:61440
    ds_read_b64_tr_b16 v[166:167], v212 offset:61952
    v_mfma_f32_16x16x32_bf16 a[68:71], a[244:247], v[184:187], a[68:71]
    ds_read_b64_tr_b16 v[168:169], v213 offset:61440
    ds_read_b64_tr_b16 v[170:171], v213 offset:61952
    buffer_load_dwordx4 v[40:43], v5, s[24:27], s52 offen offset:0 sc1
    v_mfma_f32_16x16x32_bf16 a[72:75], a[244:247], v[188:191], a[72:75]
    ds_read_b64_tr_b16 v[172:173], v214 offset:61440
    ds_read_b64_tr_b16 v[174:175], v214 offset:61952
    v_mfma_f32_16x16x32_bf16 a[76:79], a[244:247], v[192:195], a[76:79]
    ds_read_b64_tr_b16 v[176:177], v215 offset:61440
    ds_read_b64_tr_b16 v[178:179], v215 offset:61952
    buffer_load_dwordx4 v[44:47], v5, s[24:27], s52 offen offset:1024 sc1
    s_waitcnt lgkmcnt(8)
    v_mfma_f32_16x16x32_bf16 a[64:67], a[248:251], v[196:199], a[64:67]
    v_mfma_f32_16x16x32_bf16 a[68:71], a[248:251], v[200:203], a[68:71]
    v_mfma_f32_16x16x32_bf16 a[72:75], a[248:251], v[204:207], a[72:75]
    v_mfma_f32_16x16x32_bf16 a[76:79], a[248:251], v[208:211], a[76:79]
    s_waitcnt lgkmcnt(0)
    v_mfma_f32_16x16x32_bf16 a[64:67], a[252:255], v[164:167], a[64:67]
    v_mfma_f32_16x16x32_bf16 a[68:71], a[252:255], v[168:171], a[68:71]
    v_mfma_f32_16x16x32_bf16 a[72:75], a[252:255], v[172:175], a[72:75]
    v_mfma_f32_16x16x32_bf16 a[76:79], a[252:255], v[176:179], a[76:79]
    ds_read_b128 v[72:75], v6 offset:0
    ds_read_b128 v[76:79], v6 offset:1024
    ds_read_b128 v[80:83], v6 offset:2048
    ds_read_b128 v[84:87], v6 offset:3072
    ds_read_b128 v[88:91], v6 offset:4096
    ds_read_b128 v[92:95], v6 offset:5120
    ds_read_b128 v[96:99], v6 offset:6144
    ds_read_b128 v[100:103], v6 offset:7168
    ds_read_b128 v[104:107], v6 offset:8192
    ds_read_b128 v[108:111], v6 offset:9216
    ds_read_b128 v[112:115], v6 offset:10240
    ds_read_b128 v[116:119], v6 offset:11264
    ds_write_b128 v153, a[64:67] offset:0
    ds_write_b128 v153, a[68:71] offset:4096
    ds_write_b128 v153, a[72:75] offset:8192
    ds_write_b128 v153, a[76:79] offset:12288
    s_waitcnt lgkmcnt(0)
    s_barrier
    ds_read_b128 v[136:139], v152 offset:0
    ds_read_b128 v[140:143], v152 offset:1024
    ds_read_b128 v[144:147], v152 offset:2048
    ds_read_b128 v[148:151], v152 offset:3072
    ds_read_b128 v[120:123], v6 offset:12288
    ds_read_b128 v[124:127], v6 offset:13312
    ds_read_b128 v[128:131], v6 offset:14336
    ds_read_b128 v[132:135], v6 offset:15360
    s_waitcnt vmcnt(6)
    v_max3_u32 v154, v8, v12, v16
    v_max_u32 v154, v154, v20
    v_cmp_eq_u32 vcc, -1, v154
    s_cbranch_vccnz L_slow_46
L_ok_45:
    s_waitcnt lgkmcnt(4)
    v_mfma_f32_16x16x32_bf16 v[136:139], v[72:75], v[8:11], v[136:139]
    ds_read_b128 v[72:75], v6 offset:16384
    v_mfma_f32_16x16x32_bf16 v[140:143], v[76:79], v[8:11], v[140:143]
    ds_read_b128 v[76:79], v6 offset:17408
    buffer_load_dwordx4 v[48:51], v5, s[24:27], s52 offen offset:2048 sc1
    v_mfma_f32_16x16x32_bf16 v[144:147], v[80:83], v[8:11], v[144:147]
    ds_read_b128 v[80:83], v6 offset:18432
    v_mfma_f32_16x16x32_bf16 v[148:151], v[84:87], v[8:11], v[148:151]
    ds_read_b128 v[84:87], v6 offset:19456
    s_waitcnt lgkmcnt(12)
    v_mfma_f32_16x16x32_bf16 v[136:139], v[88:91], v[12:15], v[136:139]
    ds_read_b128 v[88:91], v6 offset:20480
    v_mfma_f32_16x16x32_bf16 v[140:143], v[92:95], v[12:15], v[140:143]
    ds_read_b128 v[92:95], v6 offset:21504
    buffer_load_dwordx4 v[52:55], v5, s[24:27], s52 offen offset:3072 sc1
    v_mfma_f32_16x16x32_bf16 v[144:147], v[96:99], v[12:15], v[144:147]
    ds_read_b128 v[96:99], v6 offset:22528
    v_mfma_f32_16x16x32_bf16 v[148:151], v[100:103], v[12:15], v[148:151]
    ds_read_b128 v[100:103], v6 offset:23552
    s_waitcnt lgkmcnt(12)
    v_mfma_f32_16x16x32_bf16 v[136:139], v[104:107], v[16:19], v[136:139]
    ds_read_b128 v[104:107], v6 offset:24576
    v_mfma_f32_16x16x32_bf16 v[140:143], v[108:111], v[16:19], v[140:143]
    ds_read_b128 v[108:111], v6 offset:25600
    buffer_load_dwordx4 v[56:59], v5, s[24:27], s53 offen offset:0 sc1
    v_mfma_f32_16x16x32_bf16 v[144:147], v[112:115], v[16:19], v[144:147]
    ds_read_b128 v[112:115], v6 offset:26624
    v_mfma_f32_16x16x32_bf16 v[148:151], v[116:119], v[16:19], v[148:151]
    ds_read_b128 v[116:119], v6 offset:27648
    s_waitcnt lgkmcnt(12)
    v_mfma_f32_16x16x32_bf16 v[136:139], v[120:123], v[20:23], v[136:139]
    ds_read_b128 v[120:123], v6 offset:28672
    v_mfma_f32_16x16x32_bf16 v[140:143], v[124:127], v[20:23], v[140:143]
    ds_read_b128 v[124:127], v6 offset:29696
    buffer_load_dwordx4 v[60:63], v5, s[24:27], s53 offen offset:1024 sc1
    v_mfma_f32_16x16x32_bf16 v[144:147], v[128:131], v[20:23], v[144:147]
    ds_read_b128 v[128:131], v6 offset:30720
    v_mfma_f32_16x16x32_bf16 v[148:151], v[132:135], v[20:23], v[148:151]
    ds_read_b128 v[132:135], v6 offset:31744
    s_waitcnt vmcnt(6)
    v_max3_u32 v154, v24, v28, v32
    v_max_u32 v154, v154, v36
    v_cmp_eq_u32 vcc, -1, v154
    s_cbranch_vccnz L_slow_48
L_ok_47:
    s_waitcnt lgkmcnt(12)
    v_mfma_f32_16x16x32_bf16 v[136:139], v[72:75], v[24:27], v[136:139]
    ds_read_b128 v[72:75], v6 offset:32768
    v_mfma_f32_16x16x32_bf16 v[140:143], v[76:79], v[24:27], v[140:143]
    ds_read_b128 v[76:79], v6 offset:33792
    buffer_load_dwordx4 v[64:67], v5, s[24:27], s53 offen offset:2048 sc1
    v_mfma_f32_16x16x32_bf16 v[144:147], v[80:83], v[24:27], v[144:147]
    ds_read_b128 v[80:83], v6 offset:34816
    v_mfma_f32_16x16x32_bf16 v[148:151], v[84:87], v[24:27], v[148:151]
    ds_read_b128 v[84:87], v6 offset:35840
    s_waitcnt lgkmcnt(12)
    v_mfma_f32_16x16x32_bf16 v[136:139], v[88:91], v[28:31], v[136:139]
    ds_read_b128 v[88:91], v6 offset:36864
    v_mfma_f32_16x16x32_bf16 v[140:143], v[92:95], v[28:31], v[140:143]
    ds_read_b128 v[92:95], v6 offset:37888
    buffer_load_dwordx4 v[68:71], v5, s[24:27], s53 offen offset:3072 sc1
    v_mfma_f32_16x16x32_bf16 v[144:147], v[96:99], v[28:31], v[144:147]
    ds_read_b128 v[96:99], v6 offset:38912
    v_mfma_f32_16x16x32_bf16 v[148:151], v[100:103], v[28:31], v[148:151]
    ds_read_b128 v[100:103], v6 offset:39936
    s_waitcnt lgkmcnt(12)
    v_mfma_f32_16x16x32_bf16 v[136:139], v[104:107], v[32:35], v[136:139]
    ds_read_b128 v[104:107], v6 offset:40960
    v_mfma_f32_16x16x32_bf16 v[140:143], v[108:111], v[32:35], v[140:143]
    ds_read_b128 v[108:111], v6 offset:41984
    v_mfma_f32_16x16x32_bf16 v[144:147], v[112:115], v[32:35], v[144:147]
    ds_read_b128 v[112:115], v6 offset:43008
    v_mfma_f32_16x16x32_bf16 v[148:151], v[116:119], v[32:35], v[148:151]
    ds_read_b128 v[116:119], v6 offset:44032
    s_waitcnt lgkmcnt(12)
    v_mfma_f32_16x16x32_bf16 v[136:139], v[120:123], v[36:39], v[136:139]
    ds_read_b128 v[120:123], v6 offset:45056
    v_mfma_f32_16x16x32_bf16 v[140:143], v[124:127], v[36:39], v[140:143]
    ds_read_b128 v[124:127], v6 offset:46080
    v_mfma_f32_16x16x32_bf16 v[144:147], v[128:131], v[36:39], v[144:147]
    ds_read_b128 v[128:131], v6 offset:47104
    v_mfma_f32_16x16x32_bf16 v[148:151], v[132:135], v[36:39], v[148:151]
    ds_read_b128 v[132:135], v6 offset:48128
    s_waitcnt vmcnt(4)
    v_max3_u32 v154, v40, v44, v48
    v_max_u32 v154, v154, v52
    v_cmp_eq_u32 vcc, -1, v154
    s_cbranch_vccnz L_slow_50
L_ok_49:
    s_waitcnt lgkmcnt(12)
    v_mfma_f32_16x16x32_bf16 v[136:139], v[72:75], v[40:43], v[136:139]
    ds_read_b128 v[72:75], v6 offset:49152
    v_mfma_f32_16x16x32_bf16 v[140:143], v[76:79], v[40:43], v[140:143]
    ds_read_b128 v[76:79], v6 offset:50176
    v_mfma_f32_16x16x32_bf16 v[144:147], v[80:83], v[40:43], v[144:147]
    ds_read_b128 v[80:83], v6 offset:51200
    v_mfma_f32_16x16x32_bf16 v[148:151], v[84:87], v[40:43], v[148:151]
    ds_read_b128 v[84:87], v6 offset:52224
    s_waitcnt lgkmcnt(12)
    v_mfma_f32_16x16x32_bf16 v[136:139], v[88:91], v[44:47], v[136:139]
    ds_read_b128 v[88:91], v6 offset:53248
    v_mfma_f32_16x16x32_bf16 v[140:143], v[92:95], v[44:47], v[140:143]
    ds_read_b128 v[92:95], v6 offset:54272
    v_mfma_f32_16x16x32_bf16 v[144:147], v[96:99], v[44:47], v[144:147]
    ds_read_b128 v[96:99], v6 offset:55296
    v_mfma_f32_16x16x32_bf16 v[148:151], v[100:103], v[44:47], v[148:151]
    ds_read_b128 v[100:103], v6 offset:56320
    s_waitcnt lgkmcnt(12)
    v_mfma_f32_16x16x32_bf16 v[136:139], v[104:107], v[48:51], v[136:139]
    ds_read_b128 v[104:107], v6 offset:57344
    v_mfma_f32_16x16x32_bf16 v[140:143], v[108:111], v[48:51], v[140:143]
    ds_read_b128 v[108:111], v6 offset:58368
    v_mfma_f32_16x16x32_bf16 v[144:147], v[112:115], v[48:51], v[144:147]
    ds_read_b128 v[112:115], v6 offset:59392
    v_mfma_f32_16x16x32_bf16 v[148:151], v[116:119], v[48:51], v[148:151]
    ds_read_b128 v[116:119], v6 offset:60416
    s_waitcnt lgkmcnt(12)
    v_mfma_f32_16x16x32_bf16 v[136:139], v[120:123], v[52:55], v[136:139]
    ds_read_b128 v[120:123], v6 offset:61440
    v_mfma_f32_16x16x32_bf16 v[140:143], v[124:127], v[52:55], v[140:143]
    ds_read_b128 v[124:127], v6 offset:62464
    v_mfma_f32_16x16x32_bf16 v[144:147], v[128:131], v[52:55], v[144:147]
    ds_read_b128 v[128:131], v6 offset:63488
    v_mfma_f32_16x16x32_bf16 v[148:151], v[132:135], v[52:55], v[148:151]
    ds_read_b128 v[132:135], v6 offset:64512
    s_waitcnt vmcnt(0)
    v_max3_u32 v154, v56, v60, v64
    v_max_u32 v154, v154, v68
    v_cmp_eq_u32 vcc, -1, v154
    s_cbranch_vccnz L_slow_52
L_ok_51:
    s_waitcnt lgkmcnt(12)
    v_mfma_f32_16x16x32_bf16 v[136:139], v[72:75], v[56:59], v[136:139]
    v_mfma_f32_16x16x32_bf16 v[140:143], v[76:79], v[56:59], v[140:143]
    v_mfma_f32_16x16x32_bf16 v[144:147], v[80:83], v[56:59], v[144:147]
    v_mfma_f32_16x16x32_bf16 v[148:151], v[84:87], v[56:59], v[148:151]
    s_waitcnt lgkmcnt(8)
    v_mfma_f32_16x16x32_bf16 v[136:139], v[88:91], v[60:63], v[136:139]
    v_mfma_f32_16x16x32_bf16 v[140:143], v[92:95], v[60:63], v[140:143]
    v_mfma_f32_16x16x32_bf16 v[144:147], v[96:99], v[60:63], v[144:147]
    v_mfma_f32_16x16x32_bf16 v[148:151], v[100:103], v[60:63], v[148:151]
    s_waitcnt lgkmcnt(4)
    v_mfma_f32_16x16x32_bf16 v[136:139], v[104:107], v[64:67], v[136:139]
    v_mfma_f32_16x16x32_bf16 v[140:143], v[108:111], v[64:67], v[140:143]
    v_mfma_f32_16x16x32_bf16 v[144:147], v[112:115], v[64:67], v[144:147]
    v_mfma_f32_16x16x32_bf16 v[148:151], v[116:119], v[64:67], v[148:151]
    s_waitcnt lgkmcnt(0)
    v_mfma_f32_16x16x32_bf16 v[136:139], v[120:123], v[68:71], v[136:139]
    v_mfma_f32_16x16x32_bf16 v[140:143], v[124:127], v[68:71], v[140:143]
    v_mfma_f32_16x16x32_bf16 v[144:147], v[128:131], v[68:71], v[144:147]
    v_mfma_f32_16x16x32_bf16 v[148:151], v[132:135], v[68:71], v[148:151]
    s_mov_b32 s36, s16
    s_mov_b32 s37, s17
    s_mov_b32 s38, 2097152
    s_mov_b32 s39, 0x20000
    s_lshl_b32 s50, s47, 16
    s_lshl_b32 s51, s46, 14
    s_add_u32 s50, s50, s51
    s_lshl_b32 s51, s48, 7
    s_add_u32 s50, s50, s51
    s_add_u32 s51, s50, 64
    v_cvt_pk_bf16_f32 v156, v136, v137
    v_cvt_pk_bf16_f32 v157, v138, v139
    v_cvt_pk_bf16_f32 v158, v140, v141
    v_cvt_pk_bf16_f32 v159, v142, v143
    v_cvt_pk_bf16_f32 v160, v144, v145
    v_cvt_pk_bf16_f32 v161, v146, v147
    v_cvt_pk_bf16_f32 v162, v148, v149
    v_cvt_pk_bf16_f32 v163, v150, v151
    v_permlane16_swap_b32 v156, v158
    v_permlane16_swap_b32 v157, v159
    buffer_store_dwordx4 v[156:159], v7, s[36:39], s50 offen sc1
    v_permlane16_swap_b32 v160, v162
    v_permlane16_swap_b32 v161, v163
    buffer_store_dwordx4 v[160:163], v7, s[36:39], s51 offen sc1
    s_endpgm
L_wq_slow:
    s_cmp_eq_u32 s10, 0
    s_cbranch_scc1 L_wq_slow2
    s_lshl_b32 s50, s48, 2
    s_add_u32 s50, s50, s46
    s_mul_i32 s50, s50, 49152
    s_add_u32 s50, s50, 12845056
    s_add_u32 s51, s50, 16384
    s_add_u32 s52, s50, 32768
    buffer_load_dwordx4 a[64:67], v5, s[24:27], s51 offen offset:0 sc1
    buffer_load_dwordx4 a[128:131], v5, s[24:27], s52 offen offset:0 sc1
    buffer_load_dwordx4 a[0:3], v5, s[24:27], s50 offen offset:0 sc1
    buffer_load_dwordx4 a[68:71], v5, s[24:27], s51 offen offset:1024 sc1
    buffer_load_dwordx4 a[132:135], v5, s[24:27], s52 offen offset:1024 sc1
    buffer_load_dwordx4 a[4:7], v5, s[24:27], s50 offen offset:1024 sc1
    s_waitcnt vmcnt(0)
    s_branch L_wq_ok
L_wq_slow2:
    s_mov_b32 s59, 0
L_wq_lp:
    buffer_load_dword v156, v174, s[24:27], 0 offen sc1
    s_add_u32 s59, s59, 1
    s_cmp_gt_u32 s59, 0x100000
    s_cbranch_scc1 L_end
    s_waitcnt vmcnt(0)
    v_cmp_ne_u32 vcc, s49, v156
    s_cbranch_vccnz L_wq_lp
    s_lshl_b32 s62, s48, 2
    s_add_u32 s62, s62, s46
    s_mul_i32 s62, s62, 49152
    s_add_u32 s62, s62, 12845056
    s_add_u32 s63, s62, 16384
    s_add_u32 s22, s62, 32768
    buffer_load_dwordx4 a[64:67], v5, s[24:27], s63 offen offset:0 sc1
    buffer_load_dwordx4 a[128:131], v5, s[24:27], s22 offen offset:0 sc1
    buffer_load_dwordx4 a[0:3], v5, s[24:27], s62 offen offset:0 sc1
    buffer_load_dwordx4 a[68:71], v5, s[24:27], s63 offen offset:1024 sc1
    buffer_load_dwordx4 a[132:135], v5, s[24:27], s22 offen offset:1024 sc1
    buffer_load_dwordx4 a[4:7], v5, s[24:27], s62 offen offset:1024 sc1
    buffer_load_dwordx4 a[72:75], v5, s[24:27], s63 offen offset:2048 sc1
    buffer_load_dwordx4 a[136:139], v5, s[24:27], s22 offen offset:2048 sc1
    buffer_load_dwordx4 a[8:11], v5, s[24:27], s62 offen offset:2048 sc1
    buffer_load_dwordx4 a[76:79], v5, s[24:27], s63 offen offset:3072 sc1
    s_add_u32 s63, s63, 4096
    buffer_load_dwordx4 a[140:143], v5, s[24:27], s22 offen offset:3072 sc1
    s_add_u32 s22, s22, 4096
    buffer_load_dwordx4 a[12:15], v5, s[24:27], s62 offen offset:3072 sc1
    s_add_u32 s62, s62, 4096
    buffer_load_dwordx4 a[80:83], v5, s[24:27], s63 offen offset:0 sc1
    buffer_load_dwordx4 a[144:147], v5, s[24:27], s22 offen offset:0 sc1
    buffer_load_dwordx4 a[16:19], v5, s[24:27], s62 offen offset:0 sc1
    buffer_load_dwordx4 a[84:87], v5, s[24:27], s63 offen offset:1024 sc1
    buffer_load_dwordx4 a[148:151], v5, s[24:27], s22 offen offset:1024 sc1
    buffer_load_dwordx4 a[20:23], v5, s[24:27], s62 offen offset:1024 sc1
    buffer_load_dwordx4 a[88:91], v5, s[24:27], s63 offen offset:2048 sc1
    buffer_load_dwordx4 a[152:155], v5, s[24:27], s22 offen offset:2048 sc1
    buffer_load_dwordx4 a[24:27], v5, s[24:27], s62 offen offset:2048 sc1
    buffer_load_dwordx4 a[92:95], v5, s[24:27], s63 offen offset:3072 sc1
    s_add_u32 s63, s63, 4096
    buffer_load_dwordx4 a[156:159], v5, s[24:27], s22 offen offset:3072 sc1
    s_add_u32 s22, s22, 4096
    buffer_load_dwordx4 a[28:31], v5, s[24:27], s62 offen offset:3072 sc1
    s_add_u32 s62, s62, 4096
    s_waitcnt vmcnt(0)
    s_branch L_wq_ok
L_slow_4:
    s_mov_b32 s59, 0
L_lp_53:
    s_add_u32 s59, s59, 1
    s_cmp_gt_u32 s59, 0x40000
    s_cbranch_scc1 L_end
    v_cmp_eq_u32 vcc, -1, v128
    s_cbranch_vccz L_sk_54
    s_mul_i32 s55, s50, 33
    s_add_u32 m0, s50, 0
    s_add_u32 s55, s55, s54
    s_add_u32 s55, s55, 0
    buffer_load_dwordx4 v6, s[24:27], s55 offen sc1 lds
L_sk_54:
    v_cmp_eq_u32 vcc, -1, v129
    s_cbranch_vccz L_sk_55
    s_mul_i32 s55, s51, 33
    s_add_u32 m0, s51, 0
    s_add_u32 s55, s55, s54
    s_add_u32 s55, s55, 0
    buffer_load_dwordx4 v6, s[24:27], s55 offen sc1 lds
L_sk_55:
    v_cmp_eq_u32 vcc, -1, v130
    s_cbranch_vccz L_sk_56
    s_mul_i32 s55, s52, 33
    s_add_u32 m0, s52, 0
    s_add_u32 s55, s55, s54
    s_add_u32 s55, s55, 0
    buffer_load_dwordx4 v6, s[24:27], s55 offen sc1 lds
L_sk_56:
    v_cmp_eq_u32 vcc, -1, v131
    s_cbranch_vccz L_sk_57
    s_mul_i32 s55, s53, 33
    s_add_u32 m0, s53, 0
    s_add_u32 s55, s55, s54
    s_add_u32 s55, s55, 0
    buffer_load_dwordx4 v6, s[24:27], s55 offen sc1 lds
L_sk_57:
    s_waitcnt vmcnt(0)
    ds_read_b32 v128, v240 offset:0
    ds_read_b32 v129, v241 offset:0
    ds_read_b32 v130, v242 offset:0
    ds_read_b32 v131, v243 offset:0
    s_waitcnt lgkmcnt(0)
    v_max3_u32 v248, v128, v129, v130
    v_max_u32 v248, v248, v131
    v_cmp_eq_u32 vcc, -1, v248
    s_cbranch_vccnz L_lp_53
    s_branch L_ok_3
L_slow_6:
    s_mov_b32 s59, 0
L_lp_58:
    s_add_u32 s59, s59, 1
    s_cmp_gt_u32 s59, 0x40000
    s_cbranch_scc1 L_end
    v_cmp_eq_u32 vcc, -1, v132
    s_cbranch_vccz L_sk_59
    s_mul_i32 s55, s50, 33
    s_add_u32 m0, s50, 16384
    s_add_u32 s55, s55, s54
    s_add_u32 s55, s55, 540672
    buffer_load_dwordx4 v6, s[24:27], s55 offen sc1 lds
L_sk_59:
    v_cmp_eq_u32 vcc, -1, v133
    s_cbranch_vccz L_sk_60
    s_mul_i32 s55, s51, 33
    s_add_u32 m0, s51, 16384
    s_add_u32 s55, s55, s54
    s_add_u32 s55, s55, 540672
    buffer_load_dwordx4 v6, s[24:27], s55 offen sc1 lds
L_sk_60:
    v_cmp_eq_u32 vcc, -1, v134
    s_cbranch_vccz L_sk_61
    s_mul_i32 s55, s52, 33
    s_add_u32 m0, s52, 16384
    s_add_u32 s55, s55, s54
    s_add_u32 s55, s55, 540672
    buffer_load_dwordx4 v6, s[24:27], s55 offen sc1 lds
L_sk_61:
    v_cmp_eq_u32 vcc, -1, v135
    s_cbranch_vccz L_sk_62
    s_mul_i32 s55, s53, 33
    s_add_u32 m0, s53, 16384
    s_add_u32 s55, s55, s54
    s_add_u32 s55, s55, 540672
    buffer_load_dwordx4 v6, s[24:27], s55 offen sc1 lds
L_sk_62:
    s_waitcnt vmcnt(0)
    ds_read_b32 v132, v240 offset:16384
    ds_read_b32 v133, v241 offset:16384
    ds_read_b32 v134, v242 offset:16384
    ds_read_b32 v135, v243 offset:16384
    s_waitcnt lgkmcnt(0)
    v_max3_u32 v248, v132, v133, v134
    v_max_u32 v248, v248, v135
    v_cmp_eq_u32 vcc, -1, v248
    s_cbranch_vccnz L_lp_58
    s_branch L_ok_5
L_slow_8:
    s_mov_b32 s59, 0
L_lp_63:
    s_add_u32 s59, s59, 1
    s_cmp_gt_u32 s59, 0x40000
    s_cbranch_scc1 L_end
    v_cmp_eq_u32 vcc, -1, v128
    s_cbranch_vccz L_sk_64
    s_mul_i32 s55, s50, 33
    s_add_u32 m0, s50, 32768
    s_add_u32 s55, s55, s54
    s_add_u32 s55, s55, 1081344
    buffer_load_dwordx4 v6, s[24:27], s55 offen sc1 lds
L_sk_64:
    v_cmp_eq_u32 vcc, -1, v129
    s_cbranch_vccz L_sk_65
    s_mul_i32 s55, s51, 33
    s_add_u32 m0, s51, 32768
    s_add_u32 s55, s55, s54
    s_add_u32 s55, s55, 1081344
    buffer_load_dwordx4 v6, s[24:27], s55 offen sc1 lds
L_sk_65:
    v_cmp_eq_u32 vcc, -1, v130
    s_cbranch_vccz L_sk_66
    s_mul_i32 s55, s52, 33
    s_add_u32 m0, s52, 32768
    s_add_u32 s55, s55, s54
    s_add_u32 s55, s55, 1081344
    buffer_load_dwordx4 v6, s[24:27], s55 offen sc1 lds
L_sk_66:
    v_cmp_eq_u32 vcc, -1, v131
    s_cbranch_vccz L_sk_67
    s_mul_i32 s55, s53, 33
    s_add_u32 m0, s53, 32768
    s_add_u32 s55, s55, s54
    s_add_u32 s55, s55, 1081344
    buffer_load_dwordx4 v6, s[24:27], s55 offen sc1 lds
L_sk_67:
    s_waitcnt vmcnt(0)
    ds_read_b32 v128, v240 offset:32768
    ds_read_b32 v129, v241 offset:32768
    ds_read_b32 v130, v242 offset:32768
    ds_read_b32 v131, v243 offset:32768
    s_waitcnt lgkmcnt(0)
    v_max3_u32 v248, v128, v129, v130
    v_max_u32 v248, v248, v131
    v_cmp_eq_u32 vcc, -1, v248
    s_cbranch_vccnz L_lp_63
    s_branch L_ok_7
L_slow_10:
    s_mov_b32 s59, 0
L_lp_68:
    s_add_u32 s59, s59, 1
    s_cmp_gt_u32 s59, 0x40000
    s_cbranch_scc1 L_end
    v_cmp_eq_u32 vcc, -1, v132
    s_cbranch_vccz L_sk_69
    s_mul_i32 s55, s50, 33
    s_add_u32 m0, s50, 49152
    s_add_u32 s55, s55, s54
    s_add_u32 s55, s55, 1622016
    buffer_load_dwordx4 v6, s[24:27], s55 offen sc1 lds
L_sk_69:
    v_cmp_eq_u32 vcc, -1, v133
    s_cbranch_vccz L_sk_70
    s_mul_i32 s55, s51, 33
    s_add_u32 m0, s51, 49152
    s_add_u32 s55, s55, s54
    s_add_u32 s55, s55, 1622016
    buffer_load_dwordx4 v6, s[24:27], s55 offen sc1 lds
L_sk_70:
    v_cmp_eq_u32 vcc, -1, v134
    s_cbranch_vccz L_sk_71
    s_mul_i32 s55, s52, 33
    s_add_u32 m0, s52, 49152
    s_add_u32 s55, s55, s54
    s_add_u32 s55, s55, 1622016
    buffer_load_dwordx4 v6, s[24:27], s55 offen sc1 lds
L_sk_71:
    v_cmp_eq_u32 vcc, -1, v135
    s_cbranch_vccz L_sk_72
    s_mul_i32 s55, s53, 33
    s_add_u32 m0, s53, 49152
    s_add_u32 s55, s55, s54
    s_add_u32 s55, s55, 1622016
    buffer_load_dwordx4 v6, s[24:27], s55 offen sc1 lds
L_sk_72:
    s_waitcnt vmcnt(0)
    ds_read_b32 v132, v240 offset:49152
    ds_read_b32 v133, v241 offset:49152
    ds_read_b32 v134, v242 offset:49152
    ds_read_b32 v135, v243 offset:49152
    s_waitcnt lgkmcnt(0)
    v_max3_u32 v248, v132, v133, v134
    v_max_u32 v248, v248, v135
    v_cmp_eq_u32 vcc, -1, v248
    s_cbranch_vccnz L_lp_68
    s_branch L_ok_9
L_f2_slow:
    s_mov_b32 s59, 0
L_f2_lp:
    v_lshlrev_b32 v137, 6, v0
    s_movk_i32 s55, 16384
    buffer_load_dword v136, v137, s[24:27], s55 offen sc1
    s_add_u32 s59, s59, 1
    s_cmp_gt_u32 s59, 0x100000
    s_cbranch_scc1 L_end
    s_waitcnt vmcnt(0)
    v_cmp_ne_u32 vcc, s49, v136
    s_cbranch_vccnz L_f2_lp
    s_branch L_f2_ok
L_slow_12:
    s_mov_b32 s59, 0
L_lp_73:
    s_add_u32 s59, s59, 1
    s_cmp_gt_u32 s59, 0x40000
    s_cbranch_scc1 L_end
    v_cmp_eq_u32 vcc, -1, v88
    s_cbranch_vccz L_sk_74
    buffer_load_dwordx4 v[88:91], v253, s[32:35], 0 offen offset:2048 sc1
L_sk_74:
    v_cmp_eq_u32 vcc, -1, v92
    s_cbranch_vccz L_sk_75
    buffer_load_dwordx4 v[92:95], v253, s[32:35], 0 offen offset:0 sc1
L_sk_75:
    v_cmp_eq_u32 vcc, -1, v64
    s_cbranch_vccz L_sk_76
    s_mov_b64 exec, s[60:61]
    buffer_load_dwordx4 v[64:67], v191, s[32:35], 0 offen offset:3072 sc1
    s_mov_b64 exec, -1
L_sk_76:
    v_cmp_eq_u32 vcc, -1, v68
    s_cbranch_vccz L_sk_77
    s_mov_b64 exec, s[60:61]
    buffer_load_dwordx4 v[68:71], v191, s[32:35], 0 offen offset:3584 sc1
    s_mov_b64 exec, -1
L_sk_77:
    v_cmp_eq_u32 vcc, -1, v56
    s_cbranch_vccz L_sk_78
    s_mov_b64 exec, s[60:61]
    buffer_load_dwordx4 v[56:59], v191, s[32:35], 0 offen offset:1024 sc1
    s_mov_b64 exec, -1
L_sk_78:
    v_cmp_eq_u32 vcc, -1, v60
    s_cbranch_vccz L_sk_79
    s_mov_b64 exec, s[60:61]
    buffer_load_dwordx4 v[60:63], v191, s[32:35], 0 offen offset:1536 sc1
    s_mov_b64 exec, -1
L_sk_79:
    s_waitcnt vmcnt(0)
    v_max3_u32 v248, v88, v92, v64
    v_max3_u32 v248, v248, v68, v56
    v_max_u32 v248, v248, v60
    v_cmp_eq_u32 vcc, -1, v248
    s_cbranch_vccnz L_lp_73
    s_branch L_ok_11
L_slow_14:
    s_mov_b32 s59, 0
L_lp_80:
    s_add_u32 s59, s59, 1
    s_cmp_gt_u32 s59, 0x40000
    s_cbranch_scc1 L_end
    v_cmp_eq_u32 vcc, -1, v96
    s_cbranch_vccz L_sk_81
    buffer_load_dwordx4 v[96:99], v252, s[32:35], 0 offen offset:2048 sc1
L_sk_81:
    v_cmp_eq_u32 vcc, -1, v100
    s_cbranch_vccz L_sk_82
    buffer_load_dwordx4 v[100:103], v252, s[32:35], 0 offen offset:0 sc1
L_sk_82:
    v_cmp_eq_u32 vcc, -1, v48
    s_cbranch_vccz L_sk_83
    s_mov_b64 exec, s[60:61]
    buffer_load_dwordx4 v[48:51], v190, s[32:35], 0 offen offset:3072 sc1
    s_mov_b64 exec, -1
L_sk_83:
    v_cmp_eq_u32 vcc, -1, v52
    s_cbranch_vccz L_sk_84
    s_mov_b64 exec, s[60:61]
    buffer_load_dwordx4 v[52:55], v190, s[32:35], 0 offen offset:3584 sc1
    s_mov_b64 exec, -1
L_sk_84:
    v_cmp_eq_u32 vcc, -1, v40
    s_cbranch_vccz L_sk_85
    s_mov_b64 exec, s[60:61]
    buffer_load_dwordx4 v[40:43], v190, s[32:35], 0 offen offset:1024 sc1
    s_mov_b64 exec, -1
L_sk_85:
    v_cmp_eq_u32 vcc, -1, v44
    s_cbranch_vccz L_sk_86
    s_mov_b64 exec, s[60:61]
    buffer_load_dwordx4 v[44:47], v190, s[32:35], 0 offen offset:1536 sc1
    s_mov_b64 exec, -1
L_sk_86:
    s_waitcnt vmcnt(0)
    v_max3_u32 v248, v96, v100, v48
    v_max3_u32 v248, v248, v52, v40
    v_max_u32 v248, v248, v44
    v_cmp_eq_u32 vcc, -1, v248
    s_cbranch_vccnz L_lp_80
    s_branch L_ok_13
L_slow_16:
    s_mov_b32 s59, 0
L_lp_87:
    s_add_u32 s59, s59, 1
    s_cmp_gt_u32 s59, 0x40000
    s_cbranch_scc1 L_end
    v_cmp_eq_u32 vcc, -1, v120
    s_cbranch_vccz L_sk_88
    buffer_load_dwordx4 v[120:123], v251, s[32:35], 0 offen offset:2048 sc1
L_sk_88:
    v_cmp_eq_u32 vcc, -1, v124
    s_cbranch_vccz L_sk_89
    buffer_load_dwordx4 v[124:127], v251, s[32:35], 0 offen offset:0 sc1
L_sk_89:
    v_cmp_eq_u32 vcc, -1, v32
    s_cbranch_vccz L_sk_90
    s_mov_b64 exec, s[60:61]
    buffer_load_dwordx4 v[32:35], v189, s[32:35], 0 offen offset:3072 sc1
    s_mov_b64 exec, -1
L_sk_90:
    v_cmp_eq_u32 vcc, -1, v36
    s_cbranch_vccz L_sk_91
    s_mov_b64 exec, s[60:61]
    buffer_load_dwordx4 v[36:39], v189, s[32:35], 0 offen offset:3584 sc1
    s_mov_b64 exec, -1
L_sk_91:
    v_cmp_eq_u32 vcc, -1, v24
    s_cbranch_vccz L_sk_92
    s_mov_b64 exec, s[60:61]
    buffer_load_dwordx4 v[24:27], v189, s[32:35], 0 offen offset:1024 sc1
    s_mov_b64 exec, -1
L_sk_92:
    v_cmp_eq_u32 vcc, -1, v28
    s_cbranch_vccz L_sk_93
    s_mov_b64 exec, s[60:61]
    buffer_load_dwordx4 v[28:31], v189, s[32:35], 0 offen offset:1536 sc1
    s_mov_b64 exec, -1
L_sk_93:
    s_waitcnt vmcnt(0)
    v_max3_u32 v248, v120, v124, v32
    v_max3_u32 v248, v248, v36, v24
    v_max_u32 v248, v248, v28
    v_cmp_eq_u32 vcc, -1, v248
    s_cbranch_vccnz L_lp_87
    s_branch L_ok_15
L_slow_18:
    s_mov_b32 s59, 0
L_lp_94:
    s_add_u32 s59, s59, 1
    s_cmp_gt_u32 s59, 0x40000
    s_cbranch_scc1 L_end
    v_cmp_eq_u32 vcc, -1, v128
    s_cbranch_vccz L_sk_95
    buffer_load_dwordx4 v[128:131], v250, s[32:35], 0 offen offset:2048 sc1
L_sk_95:
    v_cmp_eq_u32 vcc, -1, v132
    s_cbranch_vccz L_sk_96
    buffer_load_dwordx4 v[132:135], v250, s[32:35], 0 offen offset:0 sc1
L_sk_96:
    v_cmp_eq_u32 vcc, -1, v16
    s_cbranch_vccz L_sk_97
    s_mov_b64 exec, s[60:61]
    buffer_load_dwordx4 v[16:19], v188, s[32:35], 0 offen offset:3072 sc1
    s_mov_b64 exec, -1
L_sk_97:
    v_cmp_eq_u32 vcc, -1, v20
    s_cbranch_vccz L_sk_98
    s_mov_b64 exec, s[60:61]
    buffer_load_dwordx4 v[20:23], v188, s[32:35], 0 offen offset:3584 sc1
    s_mov_b64 exec, -1
L_sk_98:
    v_cmp_eq_u32 vcc, -1, v8
    s_cbranch_vccz L_sk_99
    s_mov_b64 exec, s[60:61]
    buffer_load_dwordx4 v[8:11], v188, s[32:35], 0 offen offset:1024 sc1
    s_mov_b64 exec, -1
L_sk_99:
    v_cmp_eq_u32 vcc, -1, v12
    s_cbranch_vccz L_sk_100
    s_mov_b64 exec, s[60:61]
    buffer_load_dwordx4 v[12:15], v188, s[32:35], 0 offen offset:1536 sc1
    s_mov_b64 exec, -1
L_sk_100:
    s_waitcnt vmcnt(0)
    v_max3_u32 v248, v128, v132, v16
    v_max3_u32 v248, v248, v20, v8
    v_max_u32 v248, v248, v12
    v_cmp_eq_u32 vcc, -1, v248
    s_cbranch_vccnz L_lp_94
    s_branch L_ok_17
L_smax_call0:
    s_call_b64 s[10:11], L_smax
    s_branch L_smax_ret0
L_slow_20:
    s_mov_b32 s59, 0
L_lp_101:
    s_add_u32 s59, s59, 1
    s_cmp_gt_u32 s59, 0x40000
    s_cbranch_scc1 L_end
    v_cmp_eq_u32 vcc, -1, v88
    s_cbranch_vccz L_sk_102
    buffer_load_dwordx4 v[88:91], v5, s[24:27], s50 offen offset:0 sc1
L_sk_102:
    v_cmp_eq_u32 vcc, -1, v92
    s_cbranch_vccz L_sk_103
    buffer_load_dwordx4 v[92:95], v5, s[24:27], s50 offen offset:1024 sc1
L_sk_103:
    v_cmp_eq_u32 vcc, -1, v96
    s_cbranch_vccz L_sk_104
    buffer_load_dwordx4 v[96:99], v5, s[24:27], s50 offen offset:2048 sc1
L_sk_104:
    v_cmp_eq_u32 vcc, -1, v100
    s_cbranch_vccz L_sk_105
    buffer_load_dwordx4 v[100:103], v5, s[24:27], s50 offen offset:3072 sc1
L_sk_105:
    s_waitcnt vmcnt(0)
    v_max3_u32 v234, v88, v92, v96
    v_max_u32 v234, v234, v100
    v_cmp_eq_u32 vcc, -1, v234
    s_cbranch_vccnz L_lp_101
    s_branch L_ok_19
L_slow_22:
    s_mov_b32 s59, 0
L_lp_106:
    s_add_u32 s59, s59, 1
    s_cmp_gt_u32 s59, 0x40000
    s_cbranch_scc1 L_end
    v_cmp_eq_u32 vcc, -1, v104
    s_cbranch_vccz L_sk_107
    buffer_load_dwordx4 v[104:107], v5, s[24:27], s51 offen offset:0 sc1
L_sk_107:
    v_cmp_eq_u32 vcc, -1, v108
    s_cbranch_vccz L_sk_108
    buffer_load_dwordx4 v[108:111], v5, s[24:27], s51 offen offset:1024 sc1
L_sk_108:
    v_cmp_eq_u32 vcc, -1, v112
    s_cbranch_vccz L_sk_109
    buffer_load_dwordx4 v[112:115], v5, s[24:27], s51 offen offset:2048 sc1
L_sk_109:
    v_cmp_eq_u32 vcc, -1, v116
    s_cbranch_vccz L_sk_110
    buffer_load_dwordx4 v[116:119], v5, s[24:27], s51 offen offset:3072 sc1
L_sk_110:
    s_waitcnt vmcnt(0)
    v_max3_u32 v234, v104, v108, v112
    v_max_u32 v234, v234, v116
    v_cmp_eq_u32 vcc, -1, v234
    s_cbranch_vccnz L_lp_106
    s_branch L_ok_21
L_slow_24:
    s_mov_b32 s59, 0
L_lp_111:
    s_add_u32 s59, s59, 1
    s_cmp_gt_u32 s59, 0x40000
    s_cbranch_scc1 L_end
    v_cmp_eq_u32 vcc, -1, v120
    s_cbranch_vccz L_sk_112
    buffer_load_dwordx4 v[120:123], v5, s[24:27], s52 offen offset:0 sc1
L_sk_112:
    v_cmp_eq_u32 vcc, -1, v124
    s_cbranch_vccz L_sk_113
    buffer_load_dwordx4 v[124:127], v5, s[24:27], s52 offen offset:1024 sc1
L_sk_113:
    v_cmp_eq_u32 vcc, -1, v128
    s_cbranch_vccz L_sk_114
    buffer_load_dwordx4 v[128:131], v5, s[24:27], s52 offen offset:2048 sc1
L_sk_114:
    v_cmp_eq_u32 vcc, -1, v132
    s_cbranch_vccz L_sk_115
    buffer_load_dwordx4 v[132:135], v5, s[24:27], s52 offen offset:3072 sc1
L_sk_115:
    s_waitcnt vmcnt(0)
    v_max3_u32 v234, v120, v124, v128
    v_max_u32 v234, v234, v132
    v_cmp_eq_u32 vcc, -1, v234
    s_cbranch_vccnz L_lp_111
    s_branch L_ok_23
L_slow_26:
    s_mov_b32 s59, 0
L_lp_116:
    s_add_u32 s59, s59, 1
    s_cmp_gt_u32 s59, 0x40000
    s_cbranch_scc1 L_end
    v_cmp_eq_u32 vcc, -1, v136
    s_cbranch_vccz L_sk_117
    buffer_load_dwordx4 v[136:139], v5, s[24:27], s53 offen offset:0 sc1
L_sk_117:
    v_cmp_eq_u32 vcc, -1, v140
    s_cbranch_vccz L_sk_118
    buffer_load_dwordx4 v[140:143], v5, s[24:27], s53 offen offset:1024 sc1
L_sk_118:
    v_cmp_eq_u32 vcc, -1, v144
    s_cbranch_vccz L_sk_119
    buffer_load_dwordx4 v[144:147], v5, s[24:27], s53 offen offset:2048 sc1
L_sk_119:
    v_cmp_eq_u32 vcc, -1, v148
    s_cbranch_vccz L_sk_120
    buffer_load_dwordx4 v[148:151], v5, s[24:27], s53 offen offset:3072 sc1
L_sk_120:
    s_waitcnt vmcnt(0)
    v_max3_u32 v234, v136, v140, v144
    v_max_u32 v234, v234, v148
    v_cmp_eq_u32 vcc, -1, v234
    s_cbranch_vccnz L_lp_116
    s_branch L_ok_25
L_slow_28:
    s_mov_b32 s59, 0
L_lp_121:
    s_add_u32 s59, s59, 1
    s_cmp_gt_u32 s59, 0x40000
    s_cbranch_scc1 L_end
    v_cmp_eq_u32 vcc, -1, v96
    s_cbranch_vccz L_sk_122
    s_mov_b32 s53, 81920
    buffer_load_dwordx4 v[96:99], v7, s[24:27], s53 offen sc1
L_sk_122:
    v_cmp_eq_u32 vcc, -1, v100
    s_cbranch_vccz L_sk_123
    s_mov_b32 s53, 86144
    buffer_load_dwordx4 v[100:103], v7, s[24:27], s53 offen sc1
L_sk_123:
    v_cmp_eq_u32 vcc, -1, v88
    s_cbranch_vccz L_sk_124
    buffer_load_dwordx4 v[88:91], v6, s[24:27], s54 offen sc1
L_sk_124:
    v_cmp_eq_u32 vcc, -1, v92
    s_cbranch_vccz L_sk_125
    buffer_load_dwordx4 v[92:95], v6, s[24:27], s55 offen sc1
L_sk_125:
    v_cmp_eq_u32 vcc, -1, v104
    s_cbranch_vccz L_sk_126
    s_mov_b32 s53, 90368
    buffer_load_dwordx4 v[104:107], v7, s[24:27], s53 offen sc1
L_sk_126:
    v_cmp_eq_u32 vcc, -1, v108
    s_cbranch_vccz L_sk_127
    s_mov_b32 s53, 94592
    buffer_load_dwordx4 v[108:111], v7, s[24:27], s53 offen sc1
L_sk_127:
    v_cmp_eq_u32 vcc, -1, v112
    s_cbranch_vccz L_sk_128
    s_mov_b32 s53, 98816
    buffer_load_dwordx4 v[112:115], v7, s[24:27], s53 offen sc1
L_sk_128:
    v_cmp_eq_u32 vcc, -1, v116
    s_cbranch_vccz L_sk_129
    s_mov_b32 s53, 103040
    buffer_load_dwordx4 v[116:119], v7, s[24:27], s53 offen sc1
L_sk_129:
    v_cmp_eq_u32 vcc, -1, v120
    s_cbranch_vccz L_sk_130
    s_mov_b32 s53, 107264
    buffer_load_dwordx4 v[120:123], v7, s[24:27], s53 offen sc1
L_sk_130:
    v_cmp_eq_u32 vcc, -1, v124
    s_cbranch_vccz L_sk_131
    s_mov_b32 s53, 111488
    buffer_load_dwordx4 v[124:127], v7, s[24:27], s53 offen sc1
L_sk_131:
    s_waitcnt vmcnt(0)
    v_max3_u32 v241, v96, v100, v88
    v_max3_u32 v241, v241, v92, v104
    v_max3_u32 v241, v241, v108, v112
    v_max3_u32 v241, v241, v116, v120
    v_max_u32 v241, v241, v124
    v_cmp_eq_u32 vcc, -1, v241
    s_cbranch_vccnz L_lp_121
    v_mov_b32 v144, 0x3727c5ac
    v_mov_b32 v145, 0x3727c5ac
    v_mov_b32 v146, 0x3727c5ac
    v_mov_b32 v147, 0x3727c5ac
    v_mov_b32 v148, 0x3727c5ac
    v_mov_b32 v149, 0x3727c5ac
    v_mov_b32 v150, 0x3727c5ac
    v_mov_b32 v151, 0x3727c5ac
    v_lshlrev_b32 v128, 16, v88
    v_and_b32 v129, 0xffff0000, v88
    v_lshlrev_b32 v130, 16, v89
    v_and_b32 v131, 0xffff0000, v89
    v_lshlrev_b32 v132, 16, v90
    v_and_b32 v133, 0xffff0000, v90
    v_lshlrev_b32 v134, 16, v91
    v_and_b32 v135, 0xffff0000, v91
    v_xor_b32 v240, s50, v92
    v_lshlrev_b32 v136, 16, v240
    v_and_b32 v137, 0xffff0000, v240
    v_xor_b32 v240, s50, v93
    v_lshlrev_b32 v138, 16, v240
    v_and_b32 v139, 0xffff0000, v240
    v_xor_b32 v240, s50, v94
    v_lshlrev_b32 v140, 16, v240
    v_and_b32 v141, 0xffff0000, v240
    v_xor_b32 v240, s50, v95
    v_lshlrev_b32 v142, 16, v240
    v_and_b32 v143, 0xffff0000, v240
    v_dot2_f32_bf16 v144, v96, s56, v144
    v_dot2_f32_bf16 v145, v96, s57, v145
    v_dot2_f32_bf16 v146, v97, s56, v146
    v_dot2_f32_bf16 v147, v97, s57, v147
    v_dot2_f32_bf16 v148, v98, s56, v148
    v_dot2_f32_bf16 v149, v98, s57, v149
    v_dot2_f32_bf16 v150, v99, s56, v150
    v_dot2_f32_bf16 v151, v99, s57, v151
    v_dot2_f32_bf16 v144, v100, s56, v144
    v_dot2_f32_bf16 v145, v100, s57, v145
    v_dot2_f32_bf16 v146, v101, s56, v146
    v_dot2_f32_bf16 v147, v101, s57, v147
    v_dot2_f32_bf16 v148, v102, s56, v148
    v_dot2_f32_bf16 v149, v102, s57, v149
    v_dot2_f32_bf16 v150, v103, s56, v150
    v_dot2_f32_bf16 v151, v103, s57, v151
    v_dot2_f32_bf16 v144, v104, s56, v144
    v_dot2_f32_bf16 v145, v104, s57, v145
    v_dot2_f32_bf16 v146, v105, s56, v146
    v_dot2_f32_bf16 v147, v105, s57, v147
    v_dot2_f32_bf16 v148, v106, s56, v148
    v_dot2_f32_bf16 v149, v106, s57, v149
    v_dot2_f32_bf16 v150, v107, s56, v150
    v_dot2_f32_bf16 v151, v107, s57, v151
    v_dot2_f32_bf16 v144, v108, s56, v144
    v_dot2_f32_bf16 v145, v108, s57, v145
    v_dot2_f32_bf16 v146, v109, s56, v146
    v_dot2_f32_bf16 v147, v109, s57, v147
    v_dot2_f32_bf16 v148, v110, s56, v148
    v_dot2_f32_bf16 v149, v110, s57, v149
    v_dot2_f32_bf16 v150, v111, s56, v150
    v_dot2_f32_bf16 v151, v111, s57, v151
    v_dot2_f32_bf16 v144, v112, s56, v144
    v_dot2_f32_bf16 v145, v112, s57, v145
    v_dot2_f32_bf16 v146, v113, s56, v146
    v_dot2_f32_bf16 v147, v113, s57, v147
    v_dot2_f32_bf16 v148, v114, s56, v148
    v_dot2_f32_bf16 v149, v114, s57, v149
    v_dot2_f32_bf16 v150, v115, s56, v150
    v_dot2_f32_bf16 v151, v115, s57, v151
    v_dot2_f32_bf16 v144, v116, s56, v144
    v_dot2_f32_bf16 v145, v116, s57, v145
    v_dot2_f32_bf16 v146, v117, s56, v146
    v_dot2_f32_bf16 v147, v117, s57, v147
    v_dot2_f32_bf16 v148, v118, s56, v148
    v_dot2_f32_bf16 v149, v118, s57, v149
    v_dot2_f32_bf16 v150, v119, s56, v150
    v_dot2_f32_bf16 v151, v119, s57, v151
    v_dot2_f32_bf16 v144, v120, s56, v144
    v_dot2_f32_bf16 v145, v120, s57, v145
    v_dot2_f32_bf16 v146, v121, s56, v146
    v_dot2_f32_bf16 v147, v121, s57, v147
    v_dot2_f32_bf16 v148, v122, s56, v148
    v_dot2_f32_bf16 v149, v122, s57, v149
    v_dot2_f32_bf16 v150, v123, s56, v150
    v_dot2_f32_bf16 v151, v123, s57, v151
    v_dot2_f32_bf16 v144, v124, s56, v144
    v_dot2_f32_bf16 v145, v124, s57, v145
    v_dot2_f32_bf16 v146, v125, s56, v146
    v_dot2_f32_bf16 v147, v125, s57, v147
    v_dot2_f32_bf16 v148, v126, s56, v148
    v_dot2_f32_bf16 v149, v126, s57, v149
    v_dot2_f32_bf16 v150, v127, s56, v150
    v_dot2_f32_bf16 v151, v127, s57, v151
    s_branch L_ok_27
L_slow_30:
    s_mov_b32 s59, 0
L_lp_132:
    s_add_u32 s59, s59, 1
    s_cmp_gt_u32 s59, 0x40000
    s_cbranch_scc1 L_end
    v_cmp_eq_u32 vcc, -1, v128
    s_cbranch_vccz L_sk_133
    s_mul_i32 s55, s50, 33
    s_add_u32 m0, s50, 0
    s_add_u32 s55, s55, s54
    s_add_u32 s55, s55, 0
    buffer_load_dwordx4 v6, s[24:27], s55 offen sc1 lds
L_sk_133:
    v_cmp_eq_u32 vcc, -1, v129
    s_cbranch_vccz L_sk_134
    s_mul_i32 s55, s51, 33
    s_add_u32 m0, s51, 0
    s_add_u32 s55, s55, s54
    s_add_u32 s55, s55, 0
    buffer_load_dwordx4 v6, s[24:27], s55 offen sc1 lds
L_sk_134:
    v_cmp_eq_u32 vcc, -1, v130
    s_cbranch_vccz L_sk_135
    s_mul_i32 s55, s52, 33
    s_add_u32 m0, s52, 0
    s_add_u32 s55, s55, s54
    s_add_u32 s55, s55, 0
    buffer_load_dwordx4 v6, s[24:27], s55 offen sc1 lds
L_sk_135:
    v_cmp_eq_u32 vcc, -1, v131
    s_cbranch_vccz L_sk_136
    s_mul_i32 s55, s53, 33
    s_add_u32 m0, s53, 0
    s_add_u32 s55, s55, s54
    s_add_u32 s55, s55, 0
    buffer_load_dwordx4 v6, s[24:27], s55 offen sc1 lds
L_sk_136:
    s_waitcnt vmcnt(0)
    ds_read_b32 v128, v240 offset:0
    ds_read_b32 v129, v241 offset:0
    ds_read_b32 v130, v242 offset:0
    ds_read_b32 v131, v243 offset:0
    s_waitcnt lgkmcnt(0)
    v_max3_u32 v248, v128, v129, v130
    v_max_u32 v248, v248, v131
    v_cmp_eq_u32 vcc, -1, v248
    s_cbranch_vccnz L_lp_132
    s_branch L_ok_29
L_slow_32:
    s_mov_b32 s59, 0
L_lp_137:
    s_add_u32 s59, s59, 1
    s_cmp_gt_u32 s59, 0x40000
    s_cbranch_scc1 L_end
    v_cmp_eq_u32 vcc, -1, v132
    s_cbranch_vccz L_sk_138
    s_mul_i32 s55, s50, 33
    s_add_u32 m0, s50, 16384
    s_add_u32 s55, s55, s54
    s_add_u32 s55, s55, 540672
    buffer_load_dwordx4 v6, s[24:27], s55 offen sc1 lds
L_sk_138:
    v_cmp_eq_u32 vcc, -1, v133
    s_cbranch_vccz L_sk_139
    s_mul_i32 s55, s51, 33
    s_add_u32 m0, s51, 16384
    s_add_u32 s55, s55, s54
    s_add_u32 s55, s55, 540672
    buffer_load_dwordx4 v6, s[24:27], s55 offen sc1 lds
L_sk_139:
    v_cmp_eq_u32 vcc, -1, v134
    s_cbranch_vccz L_sk_140
    s_mul_i32 s55, s52, 33
    s_add_u32 m0, s52, 16384
    s_add_u32 s55, s55, s54
    s_add_u32 s55, s55, 540672
    buffer_load_dwordx4 v6, s[24:27], s55 offen sc1 lds
L_sk_140:
    v_cmp_eq_u32 vcc, -1, v135
    s_cbranch_vccz L_sk_141
    s_mul_i32 s55, s53, 33
    s_add_u32 m0, s53, 16384
    s_add_u32 s55, s55, s54
    s_add_u32 s55, s55, 540672
    buffer_load_dwordx4 v6, s[24:27], s55 offen sc1 lds
L_sk_141:
    s_waitcnt vmcnt(0)
    ds_read_b32 v132, v240 offset:16384
    ds_read_b32 v133, v241 offset:16384
    ds_read_b32 v134, v242 offset:16384
    ds_read_b32 v135, v243 offset:16384
    s_waitcnt lgkmcnt(0)
    v_max3_u32 v248, v132, v133, v134
    v_max_u32 v248, v248, v135
    v_cmp_eq_u32 vcc, -1, v248
    s_cbranch_vccnz L_lp_137
    s_branch L_ok_31
L_slow_34:
    s_mov_b32 s59, 0
L_lp_142:
    s_add_u32 s59, s59, 1
    s_cmp_gt_u32 s59, 0x40000
    s_cbranch_scc1 L_end
    v_cmp_eq_u32 vcc, -1, v128
    s_cbranch_vccz L_sk_143
    s_mul_i32 s55, s50, 33
    s_add_u32 m0, s50, 32768
    s_add_u32 s55, s55, s54
    s_add_u32 s55, s55, 1081344
    buffer_load_dwordx4 v6, s[24:27], s55 offen sc1 lds
L_sk_143:
    v_cmp_eq_u32 vcc, -1, v129
    s_cbranch_vccz L_sk_144
    s_mul_i32 s55, s51, 33
    s_add_u32 m0, s51, 32768
    s_add_u32 s55, s55, s54
    s_add_u32 s55, s55, 1081344
    buffer_load_dwordx4 v6, s[24:27], s55 offen sc1 lds
L_sk_144:
    v_cmp_eq_u32 vcc, -1, v130
    s_cbranch_vccz L_sk_145
    s_mul_i32 s55, s52, 33
    s_add_u32 m0, s52, 32768
    s_add_u32 s55, s55, s54
    s_add_u32 s55, s55, 1081344
    buffer_load_dwordx4 v6, s[24:27], s55 offen sc1 lds
L_sk_145:
    v_cmp_eq_u32 vcc, -1, v131
    s_cbranch_vccz L_sk_146
    s_mul_i32 s55, s53, 33
    s_add_u32 m0, s53, 32768
    s_add_u32 s55, s55, s54
    s_add_u32 s55, s55, 1081344
    buffer_load_dwordx4 v6, s[24:27], s55 offen sc1 lds
L_sk_146:
    s_waitcnt vmcnt(0)
    ds_read_b32 v128, v240 offset:32768
    ds_read_b32 v129, v241 offset:32768
    ds_read_b32 v130, v242 offset:32768
    ds_read_b32 v131, v243 offset:32768
    s_waitcnt lgkmcnt(0)
    v_max3_u32 v248, v128, v129, v130
    v_max_u32 v248, v248, v131
    v_cmp_eq_u32 vcc, -1, v248
    s_cbranch_vccnz L_lp_142
    s_branch L_ok_33
L_slow_36:
    s_mov_b32 s59, 0
L_lp_147:
    s_add_u32 s59, s59, 1
    s_cmp_gt_u32 s59, 0x40000
    s_cbranch_scc1 L_end
    v_cmp_eq_u32 vcc, -1, v132
    s_cbranch_vccz L_sk_148
    s_mul_i32 s55, s50, 33
    s_add_u32 m0, s50, 49152
    s_add_u32 s55, s55, s54
    s_add_u32 s55, s55, 1622016
    buffer_load_dwordx4 v6, s[24:27], s55 offen sc1 lds
L_sk_148:
    v_cmp_eq_u32 vcc, -1, v133
    s_cbranch_vccz L_sk_149
    s_mul_i32 s55, s51, 33
    s_add_u32 m0, s51, 49152
    s_add_u32 s55, s55, s54
    s_add_u32 s55, s55, 1622016
    buffer_load_dwordx4 v6, s[24:27], s55 offen sc1 lds
L_sk_149:
    v_cmp_eq_u32 vcc, -1, v134
    s_cbranch_vccz L_sk_150
    s_mul_i32 s55, s52, 33
    s_add_u32 m0, s52, 49152
    s_add_u32 s55, s55, s54
    s_add_u32 s55, s55, 1622016
    buffer_load_dwordx4 v6, s[24:27], s55 offen sc1 lds
L_sk_150:
    v_cmp_eq_u32 vcc, -1, v135
    s_cbranch_vccz L_sk_151
    s_mul_i32 s55, s53, 33
    s_add_u32 m0, s53, 49152
    s_add_u32 s55, s55, s54
    s_add_u32 s55, s55, 1622016
    buffer_load_dwordx4 v6, s[24:27], s55 offen sc1 lds
L_sk_151:
    s_waitcnt vmcnt(0)
    ds_read_b32 v132, v240 offset:49152
    ds_read_b32 v133, v241 offset:49152
    ds_read_b32 v134, v242 offset:49152
    ds_read_b32 v135, v243 offset:49152
    s_waitcnt lgkmcnt(0)
    v_max3_u32 v248, v132, v133, v134
    v_max_u32 v248, v248, v135
    v_cmp_eq_u32 vcc, -1, v248
    s_cbranch_vccnz L_lp_147
    s_branch L_ok_35
L_slow_38:
    s_mov_b32 s59, 0
L_lp_152:
    s_add_u32 s59, s59, 1
    s_cmp_gt_u32 s59, 0x40000
    s_cbranch_scc1 L_end
    v_cmp_eq_u32 vcc, -1, v88
    s_cbranch_vccz L_sk_153
    buffer_load_dwordx4 v[88:91], v253, s[32:35], 0 offen offset:2048 sc1
L_sk_153:
    v_cmp_eq_u32 vcc, -1, v92
    s_cbranch_vccz L_sk_154
    buffer_load_dwordx4 v[92:95], v253, s[32:35], 0 offen offset:0 sc1
L_sk_154:
    v_cmp_eq_u32 vcc, -1, v64
    s_cbranch_vccz L_sk_155
    s_mov_b64 exec, s[60:61]
    buffer_load_dwordx4 v[64:67], v191, s[32:35], 0 offen offset:3072 sc1
    s_mov_b64 exec, -1
L_sk_155:
    v_cmp_eq_u32 vcc, -1, v68
    s_cbranch_vccz L_sk_156
    s_mov_b64 exec, s[60:61]
    buffer_load_dwordx4 v[68:71], v191, s[32:35], 0 offen offset:3584 sc1
    s_mov_b64 exec, -1
L_sk_156:
    v_cmp_eq_u32 vcc, -1, v56
    s_cbranch_vccz L_sk_157
    s_mov_b64 exec, s[60:61]
    buffer_load_dwordx4 v[56:59], v191, s[32:35], 0 offen offset:1024 sc1
    s_mov_b64 exec, -1
L_sk_157:
    v_cmp_eq_u32 vcc, -1, v60
    s_cbranch_vccz L_sk_158
    s_mov_b64 exec, s[60:61]
    buffer_load_dwordx4 v[60:63], v191, s[32:35], 0 offen offset:1536 sc1
    s_mov_b64 exec, -1
L_sk_158:
    s_waitcnt vmcnt(0)
    v_max3_u32 v248, v88, v92, v64
    v_max3_u32 v248, v248, v68, v56
    v_max_u32 v248, v248, v60
    v_cmp_eq_u32 vcc, -1, v248
    s_cbranch_vccnz L_lp_152
    s_branch L_ok_37
L_slow_40:
    s_mov_b32 s59, 0
L_lp_159:
    s_add_u32 s59, s59, 1
    s_cmp_gt_u32 s59, 0x40000
    s_cbranch_scc1 L_end
    v_cmp_eq_u32 vcc, -1, v96
    s_cbranch_vccz L_sk_160
    buffer_load_dwordx4 v[96:99], v252, s[32:35], 0 offen offset:2048 sc1
L_sk_160:
    v_cmp_eq_u32 vcc, -1, v100
    s_cbranch_vccz L_sk_161
    buffer_load_dwordx4 v[100:103], v252, s[32:35], 0 offen offset:0 sc1
L_sk_161:
    v_cmp_eq_u32 vcc, -1, v48
    s_cbranch_vccz L_sk_162
    s_mov_b64 exec, s[60:61]
    buffer_load_dwordx4 v[48:51], v190, s[32:35], 0 offen offset:3072 sc1
    s_mov_b64 exec, -1
L_sk_162:
    v_cmp_eq_u32 vcc, -1, v52
    s_cbranch_vccz L_sk_163
    s_mov_b64 exec, s[60:61]
    buffer_load_dwordx4 v[52:55], v190, s[32:35], 0 offen offset:3584 sc1
    s_mov_b64 exec, -1
L_sk_163:
    v_cmp_eq_u32 vcc, -1, v40
    s_cbranch_vccz L_sk_164
    s_mov_b64 exec, s[60:61]
    buffer_load_dwordx4 v[40:43], v190, s[32:35], 0 offen offset:1024 sc1
    s_mov_b64 exec, -1
L_sk_164:
    v_cmp_eq_u32 vcc, -1, v44
    s_cbranch_vccz L_sk_165
    s_mov_b64 exec, s[60:61]
    buffer_load_dwordx4 v[44:47], v190, s[32:35], 0 offen offset:1536 sc1
    s_mov_b64 exec, -1
L_sk_165:
    s_waitcnt vmcnt(0)
    v_max3_u32 v248, v96, v100, v48
    v_max3_u32 v248, v248, v52, v40
    v_max_u32 v248, v248, v44
    v_cmp_eq_u32 vcc, -1, v248
    s_cbranch_vccnz L_lp_159
    s_branch L_ok_39
L_slow_42:
    s_mov_b32 s59, 0
L_lp_166:
    s_add_u32 s59, s59, 1
    s_cmp_gt_u32 s59, 0x40000
    s_cbranch_scc1 L_end
    v_cmp_eq_u32 vcc, -1, v120
    s_cbranch_vccz L_sk_167
    buffer_load_dwordx4 v[120:123], v251, s[32:35], 0 offen offset:2048 sc1
L_sk_167:
    v_cmp_eq_u32 vcc, -1, v124
    s_cbranch_vccz L_sk_168
    buffer_load_dwordx4 v[124:127], v251, s[32:35], 0 offen offset:0 sc1
L_sk_168:
    v_cmp_eq_u32 vcc, -1, v32
    s_cbranch_vccz L_sk_169
    s_mov_b64 exec, s[60:61]
    buffer_load_dwordx4 v[32:35], v189, s[32:35], 0 offen offset:3072 sc1
    s_mov_b64 exec, -1
L_sk_169:
    v_cmp_eq_u32 vcc, -1, v36
    s_cbranch_vccz L_sk_170
    s_mov_b64 exec, s[60:61]
    buffer_load_dwordx4 v[36:39], v189, s[32:35], 0 offen offset:3584 sc1
    s_mov_b64 exec, -1
L_sk_170:
    v_cmp_eq_u32 vcc, -1, v24
    s_cbranch_vccz L_sk_171
    s_mov_b64 exec, s[60:61]
    buffer_load_dwordx4 v[24:27], v189, s[32:35], 0 offen offset:1024 sc1
    s_mov_b64 exec, -1
L_sk_171:
    v_cmp_eq_u32 vcc, -1, v28
    s_cbranch_vccz L_sk_172
    s_mov_b64 exec, s[60:61]
    buffer_load_dwordx4 v[28:31], v189, s[32:35], 0 offen offset:1536 sc1
    s_mov_b64 exec, -1
L_sk_172:
    s_waitcnt vmcnt(0)
    v_max3_u32 v248, v120, v124, v32
    v_max3_u32 v248, v248, v36, v24
    v_max_u32 v248, v248, v28
    v_cmp_eq_u32 vcc, -1, v248
    s_cbranch_vccnz L_lp_166
    s_branch L_ok_41
L_slow_44:
    s_mov_b32 s59, 0
L_lp_173:
    s_add_u32 s59, s59, 1
    s_cmp_gt_u32 s59, 0x40000
    s_cbranch_scc1 L_end
    v_cmp_eq_u32 vcc, -1, v128
    s_cbranch_vccz L_sk_174
    buffer_load_dwordx4 v[128:131], v250, s[32:35], 0 offen offset:2048 sc1
L_sk_174:
    v_cmp_eq_u32 vcc, -1, v132
    s_cbranch_vccz L_sk_175
    buffer_load_dwordx4 v[132:135], v250, s[32:35], 0 offen offset:0 sc1
L_sk_175:
    v_cmp_eq_u32 vcc, -1, v16
    s_cbranch_vccz L_sk_176
    s_mov_b64 exec, s[60:61]
    buffer_load_dwordx4 v[16:19], v188, s[32:35], 0 offen offset:3072 sc1
    s_mov_b64 exec, -1
L_sk_176:
    v_cmp_eq_u32 vcc, -1, v20
    s_cbranch_vccz L_sk_177
    s_mov_b64 exec, s[60:61]
    buffer_load_dwordx4 v[20:23], v188, s[32:35], 0 offen offset:3584 sc1
    s_mov_b64 exec, -1
L_sk_177:
    v_cmp_eq_u32 vcc, -1, v8
    s_cbranch_vccz L_sk_178
    s_mov_b64 exec, s[60:61]
    buffer_load_dwordx4 v[8:11], v188, s[32:35], 0 offen offset:1024 sc1
    s_mov_b64 exec, -1
L_sk_178:
    v_cmp_eq_u32 vcc, -1, v12
    s_cbranch_vccz L_sk_179
    s_mov_b64 exec, s[60:61]
    buffer_load_dwordx4 v[12:15], v188, s[32:35], 0 offen offset:1536 sc1
    s_mov_b64 exec, -1
L_sk_179:
    s_waitcnt vmcnt(0)
    v_max3_u32 v248, v128, v132, v16
    v_max3_u32 v248, v248, v20, v8
    v_max_u32 v248, v248, v12
    v_cmp_eq_u32 vcc, -1, v248
    s_cbranch_vccnz L_lp_173
    s_branch L_ok_43
L_smax_call1:
    s_call_b64 s[10:11], L_smax
    s_branch L_smax_ret1
L_slow_46:
    s_mov_b32 s59, 0
L_lp_180:
    s_add_u32 s59, s59, 1
    s_cmp_gt_u32 s59, 0x40000
    s_cbranch_scc1 L_end
    v_cmp_eq_u32 vcc, -1, v8
    s_cbranch_vccz L_sk_181
    buffer_load_dwordx4 v[8:11], v5, s[24:27], s50 offen offset:0 sc1
L_sk_181:
    v_cmp_eq_u32 vcc, -1, v12
    s_cbranch_vccz L_sk_182
    buffer_load_dwordx4 v[12:15], v5, s[24:27], s50 offen offset:1024 sc1
L_sk_182:
    v_cmp_eq_u32 vcc, -1, v16
    s_cbranch_vccz L_sk_183
    buffer_load_dwordx4 v[16:19], v5, s[24:27], s50 offen offset:2048 sc1
L_sk_183:
    v_cmp_eq_u32 vcc, -1, v20
    s_cbranch_vccz L_sk_184
    buffer_load_dwordx4 v[20:23], v5, s[24:27], s50 offen offset:3072 sc1
L_sk_184:
    s_waitcnt vmcnt(0)
    v_max3_u32 v154, v8, v12, v16
    v_max_u32 v154, v154, v20
    v_cmp_eq_u32 vcc, -1, v154
    s_cbranch_vccnz L_lp_180
    s_branch L_ok_45
L_slow_48:
    s_mov_b32 s59, 0
L_lp_185:
    s_add_u32 s59, s59, 1
    s_cmp_gt_u32 s59, 0x40000
    s_cbranch_scc1 L_end
    v_cmp_eq_u32 vcc, -1, v24
    s_cbranch_vccz L_sk_186
    buffer_load_dwordx4 v[24:27], v5, s[24:27], s51 offen offset:0 sc1
L_sk_186:
    v_cmp_eq_u32 vcc, -1, v28
    s_cbranch_vccz L_sk_187
    buffer_load_dwordx4 v[28:31], v5, s[24:27], s51 offen offset:1024 sc1
L_sk_187:
    v_cmp_eq_u32 vcc, -1, v32
    s_cbranch_vccz L_sk_188
    buffer_load_dwordx4 v[32:35], v5, s[24:27], s51 offen offset:2048 sc1
L_sk_188:
    v_cmp_eq_u32 vcc, -1, v36
    s_cbranch_vccz L_sk_189
    buffer_load_dwordx4 v[36:39], v5, s[24:27], s51 offen offset:3072 sc1
L_sk_189:
    s_waitcnt vmcnt(0)
    v_max3_u32 v154, v24, v28, v32
    v_max_u32 v154, v154, v36
    v_cmp_eq_u32 vcc, -1, v154
    s_cbranch_vccnz L_lp_185
    s_branch L_ok_47
L_slow_50:
    s_mov_b32 s59, 0
L_lp_190:
    s_add_u32 s59, s59, 1
    s_cmp_gt_u32 s59, 0x40000
    s_cbranch_scc1 L_end
    v_cmp_eq_u32 vcc, -1, v40
    s_cbranch_vccz L_sk_191
    buffer_load_dwordx4 v[40:43], v5, s[24:27], s52 offen offset:0 sc1
L_sk_191:
    v_cmp_eq_u32 vcc, -1, v44
    s_cbranch_vccz L_sk_192
    buffer_load_dwordx4 v[44:47], v5, s[24:27], s52 offen offset:1024 sc1
L_sk_192:
    v_cmp_eq_u32 vcc, -1, v48
    s_cbranch_vccz L_sk_193
    buffer_load_dwordx4 v[48:51], v5, s[24:27], s52 offen offset:2048 sc1
L_sk_193:
    v_cmp_eq_u32 vcc, -1, v52
    s_cbranch_vccz L_sk_194
    buffer_load_dwordx4 v[52:55], v5, s[24:27], s52 offen offset:3072 sc1
L_sk_194:
    s_waitcnt vmcnt(0)
    v_max3_u32 v154, v40, v44, v48
    v_max_u32 v154, v154, v52
    v_cmp_eq_u32 vcc, -1, v154
    s_cbranch_vccnz L_lp_190
    s_branch L_ok_49
L_slow_52:
    s_mov_b32 s59, 0
L_lp_195:
    s_add_u32 s59, s59, 1
    s_cmp_gt_u32 s59, 0x40000
    s_cbranch_scc1 L_end
    v_cmp_eq_u32 vcc, -1, v56
    s_cbranch_vccz L_sk_196
    buffer_load_dwordx4 v[56:59], v5, s[24:27], s53 offen offset:0 sc1
L_sk_196:
    v_cmp_eq_u32 vcc, -1, v60
    s_cbranch_vccz L_sk_197
    buffer_load_dwordx4 v[60:63], v5, s[24:27], s53 offen offset:1024 sc1
L_sk_197:
    v_cmp_eq_u32 vcc, -1, v64
    s_cbranch_vccz L_sk_198
    buffer_load_dwordx4 v[64:67], v5, s[24:27], s53 offen offset:2048 sc1
L_sk_198:
    v_cmp_eq_u32 vcc, -1, v68
    s_cbranch_vccz L_sk_199
    buffer_load_dwordx4 v[68:71], v5, s[24:27], s53 offen offset:3072 sc1
L_sk_199:
    s_waitcnt vmcnt(0)
    v_max3_u32 v154, v56, v60, v64
    v_max_u32 v154, v154, v68
    v_cmp_eq_u32 vcc, -1, v154
    s_cbranch_vccnz L_lp_195
    s_branch L_ok_51
L_smax:
    s_nop 7
    s_nop 7
    s_mov_b32 s59, 0xff800000
    v_xor_b32 v136, s59, v136
    v_xor_b32 v137, s59, v137
    v_xor_b32 v138, s59, v138
    v_xor_b32 v139, s59, v139
    v_xor_b32 v140, s59, v140
    v_xor_b32 v141, s59, v141
    v_xor_b32 v142, s59, v142
    v_xor_b32 v143, s59, v143
    v_xor_b32 v144, s59, v144
    v_xor_b32 v145, s59, v145
    v_xor_b32 v146, s59, v146
    v_xor_b32 v147, s59, v147
    v_xor_b32 v148, s59, v148
    v_xor_b32 v149, s59, v149
    v_xor_b32 v150, s59, v150
    v_xor_b32 v151, s59, v151
    s_nop 1
    v_mfma_f32_32x32x16_bf16 v[152:167], v[104:107], v[112:115], v[136:151]
    s_nop 11
    v_max_f32 v248, v152, v153
    v_max3_f32 v248, v248, v154, v155
    v_max3_f32 v248, v248, v156, v157
    v_max3_f32 v248, v248, v158, v159
    v_max3_f32 v248, v248, v160, v161
    v_max3_f32 v248, v248, v162, v163
    v_max3_f32 v248, v248, v164, v165
    v_max3_f32 v248, v248, v166, v167
    s_nop 7
    v_xor_b32 v136, s59, v136
    v_xor_b32 v137, s59, v137
    v_xor_b32 v138, s59, v138
    v_xor_b32 v139, s59, v139
    v_xor_b32 v140, s59, v140
    v_xor_b32 v141, s59, v141
    v_xor_b32 v142, s59, v142
    v_xor_b32 v143, s59, v143
    v_xor_b32 v144, s59, v144
    v_xor_b32 v145, s59, v145
    v_xor_b32 v146, s59, v146
    v_xor_b32 v147, s59, v147
    v_xor_b32 v148, s59, v148
    v_xor_b32 v149, s59, v149
    v_xor_b32 v150, s59, v150
    v_xor_b32 v151, s59, v151
    s_cmp_lt_u32 s47, 1
    s_cbranch_scc1 L_td_200
    v_mfma_f32_32x32x16_bf16 v[152:167], v[88:91], v[112:115], 0
    s_nop 11
    v_max3_f32 v248, v248, v152, v153
    v_max3_f32 v248, v248, v154, v155
    v_max3_f32 v248, v248, v156, v157
    v_max3_f32 v248, v248, v158, v159
    v_max3_f32 v248, v248, v160, v161
    v_max3_f32 v248, v248, v162, v163
    v_max3_f32 v248, v248, v164, v165
    v_max3_f32 v248, v248, v166, v167
    s_nop 7
    s_cmp_lt_u32 s47, 1
    s_cbranch_scc1 L_td_200
    v_mfma_f32_32x32x16_bf16 v[152:167], v[92:95], v[112:115], 0
    s_nop 11
    v_max3_f32 v248, v248, v152, v153
    v_max3_f32 v248, v248, v154, v155
    v_max3_f32 v248, v248, v156, v157
    v_max3_f32 v248, v248, v158, v159
    v_max3_f32 v248, v248, v160, v161
    v_max3_f32 v248, v248, v162, v163
    v_max3_f32 v248, v248, v164, v165
    v_max3_f32 v248, v248, v166, v167
    s_nop 7
    s_cmp_lt_u32 s47, 2
    s_cbranch_scc1 L_td_200
    v_mfma_f32_32x32x16_bf16 v[152:167], v[96:99], v[112:115], 0
    s_nop 11
    v_max3_f32 v248, v248, v152, v153
    v_max3_f32 v248, v248, v154, v155
    v_max3_f32 v248, v248, v156, v157
    v_max3_f32 v248, v248, v158, v159
    v_max3_f32 v248, v248, v160, v161
    v_max3_f32 v248, v248, v162, v163
    v_max3_f32 v248, v248, v164, v165
    v_max3_f32 v248, v248, v166, v167
    s_nop 7
    s_cmp_lt_u32 s47, 2
    s_cbranch_scc1 L_td_200
    v_mfma_f32_32x32x16_bf16 v[152:167], v[100:103], v[112:115], 0
    s_nop 11
    v_max3_f32 v248, v248, v152, v153
    v_max3_f32 v248, v248, v154, v155
    v_max3_f32 v248, v248, v156, v157
    v_max3_f32 v248, v248, v158, v159
    v_max3_f32 v248, v248, v160, v161
    v_max3_f32 v248, v248, v162, v163
    v_max3_f32 v248, v248, v164, v165
    v_max3_f32 v248, v248, v166, v167
    s_nop 7
    s_cmp_lt_u32 s47, 3
    s_cbranch_scc1 L_td_200
    v_mfma_f32_32x32x16_bf16 v[152:167], v[120:123], v[112:115], 0
    s_nop 11
    v_max3_f32 v248, v248, v152, v153
    v_max3_f32 v248, v248, v154, v155
    v_max3_f32 v248, v248, v156, v157
    v_max3_f32 v248, v248, v158, v159
    v_max3_f32 v248, v248, v160, v161
    v_max3_f32 v248, v248, v162, v163
    v_max3_f32 v248, v248, v164, v165
    v_max3_f32 v248, v248, v166, v167
    s_nop 7
    s_cmp_lt_u32 s47, 3
    s_cbranch_scc1 L_td_200
    v_mfma_f32_32x32x16_bf16 v[152:167], v[124:127], v[112:115], 0
    s_nop 11
    v_max3_f32 v248, v248, v152, v153
    v_max3_f32 v248, v248, v154, v155
    v_max3_f32 v248, v248, v156, v157
    v_max3_f32 v248, v248, v158, v159
    v_max3_f32 v248, v248, v160, v161
    v_max3_f32 v248, v248, v162, v163
    v_max3_f32 v248, v248, v164, v165
    v_max3_f32 v248, v248, v166, v167
    s_nop 7
    s_cmp_lt_u32 s47, 4
    s_cbranch_scc1 L_td_200
    v_mfma_f32_32x32x16_bf16 v[152:167], v[128:131], v[112:115], 0
    s_nop 11
    v_max3_f32 v248, v248, v152, v153
    v_max3_f32 v248, v248, v154, v155
    v_max3_f32 v248, v248, v156, v157
    v_max3_f32 v248, v248, v158, v159
    v_max3_f32 v248, v248, v160, v161
    v_max3_f32 v248, v248, v162, v163
    v_max3_f32 v248, v248, v164, v165
    v_max3_f32 v248, v248, v166, v167
    s_nop 7
    s_cmp_lt_u32 s47, 4
    s_cbranch_scc1 L_td_200
    v_mfma_f32_32x32x16_bf16 v[152:167], v[132:135], v[112:115], v[136:151]
    s_nop 11
    v_max3_f32 v248, v248, v152, v153
    v_max3_f32 v248, v248, v154, v155
    v_max3_f32 v248, v248, v156, v157
    v_max3_f32 v248, v248, v158, v159
    v_max3_f32 v248, v248, v160, v161
    v_max3_f32 v248, v248, v162, v163
    v_max3_f32 v248, v248, v164, v165
    v_max3_f32 v248, v248, v166, v167
    s_nop 7
L_td_200:
    v_mov_b32 v249, v248
    s_nop 1
    v_permlane32_swap_b32 v248, v249
    v_max_f32 v248, v248, v249
    v_xor_b32 v136, s59, v136
    v_xor_b32 v137, s59, v137
    v_xor_b32 v138, s59, v138
    v_xor_b32 v139, s59, v139
    v_xor_b32 v140, s59, v140
    v_xor_b32 v141, s59, v141
    v_xor_b32 v142, s59, v142
    v_xor_b32 v143, s59, v143
    v_xor_b32 v144, s59, v144
    v_xor_b32 v145, s59, v145
    v_xor_b32 v146, s59, v146
    v_xor_b32 v147, s59, v147
    v_xor_b32 v148, s59, v148
    v_xor_b32 v149, s59, v149
    v_xor_b32 v150, s59, v150
    v_xor_b32 v151, s59, v151
    v_sub_f32 v168, v136, v248
    v_sub_f32 v169, v137, v248
    v_sub_f32 v170, v138, v248
    v_sub_f32 v171, v139, v248
    v_sub_f32 v172, v140, v248
    v_sub_f32 v173, v141, v248
    v_sub_f32 v174, v142, v248
    v_sub_f32 v175, v143, v248
    v_sub_f32 v176, v144, v248
    v_sub_f32 v177, v145, v248
    v_sub_f32 v178, v146, v248
    v_sub_f32 v179, v147, v248
    v_sub_f32 v180, v148, v248
    v_sub_f32 v181, v149, v248
    v_sub_f32 v182, v150, v248
    v_sub_f32 v183, v151, v248
    s_nop 1
    v_mfma_f32_32x32x16_bf16 v[152:167], v[104:107], v[112:115], v[168:183]
    s_nop 11
    v_exp_f32 v152, v152
    v_exp_f32 v153, v153
    v_exp_f32 v154, v154
    v_exp_f32 v155, v155
    v_exp_f32 v156, v156
    v_exp_f32 v157, v157
    v_exp_f32 v158, v158
    v_exp_f32 v159, v159
    v_exp_f32 v160, v160
    v_exp_f32 v161, v161
    v_exp_f32 v162, v162
    v_exp_f32 v163, v163
    v_exp_f32 v164, v164
    v_exp_f32 v165, v165
    v_exp_f32 v166, v166
    v_exp_f32 v167, v167
    v_cvt_pk_bf16_f32 v224, v152, v153
    v_cvt_pk_bf16_f32 v225, v154, v155
    v_cvt_pk_bf16_f32 v226, v160, v161
    v_cvt_pk_bf16_f32 v227, v162, v163
    v_cvt_pk_bf16_f32 v228, v156, v157
    v_cvt_pk_bf16_f32 v229, v158, v159
    v_cvt_pk_bf16_f32 v230, v164, v165
    v_cvt_pk_bf16_f32 v231, v166, v167
    v_mfma_f32_32x32x16_bf16 v[192:207], v[72:75], v[224:227], 0
    s_nop 0
    v_mfma_f32_32x32x16_bf16 v[192:207], v[76:79], v[228:231], v[192:207]
    s_nop 7
    s_nop 7
    v_xor_b32 v136, s59, v136
    v_xor_b32 v137, s59, v137
    v_xor_b32 v138, s59, v138
    v_xor_b32 v139, s59, v139
    v_xor_b32 v140, s59, v140
    v_xor_b32 v141, s59, v141
    v_xor_b32 v142, s59, v142
    v_xor_b32 v143, s59, v143
    v_xor_b32 v144, s59, v144
    v_xor_b32 v145, s59, v145
    v_xor_b32 v146, s59, v146
    v_xor_b32 v147, s59, v147
    v_xor_b32 v148, s59, v148
    v_xor_b32 v149, s59, v149
    v_xor_b32 v150, s59, v150
    v_xor_b32 v151, s59, v151
    s_cmp_lt_u32 s47, 1
    s_cbranch_scc1 L_td_201
    v_sub_f32 v168, 0, v248
    v_sub_f32 v169, 0, v248
    v_sub_f32 v170, 0, v248
    v_sub_f32 v171, 0, v248
    v_sub_f32 v172, 0, v248
    v_sub_f32 v173, 0, v248
    v_sub_f32 v174, 0, v248
    v_sub_f32 v175, 0, v248
    v_sub_f32 v176, 0, v248
    v_sub_f32 v177, 0, v248
    v_sub_f32 v178, 0, v248
    v_sub_f32 v179, 0, v248
    v_sub_f32 v180, 0, v248
    v_sub_f32 v181, 0, v248
    v_sub_f32 v182, 0, v248
    v_sub_f32 v183, 0, v248
    s_nop 1
    v_mfma_f32_32x32x16_bf16 v[152:167], v[88:91], v[112:115], v[168:183]
    s_nop 11
    v_exp_f32 v152, v152
    v_exp_f32 v153, v153
    v_exp_f32 v154, v154
    v_exp_f32 v155, v155
    v_exp_f32 v156, v156
    v_exp_f32 v157, v157
    v_exp_f32 v158, v158
    v_exp_f32 v159, v159
    v_exp_f32 v160, v160
    v_exp_f32 v161, v161
    v_exp_f32 v162, v162
    v_exp_f32 v163, v163
    v_exp_f32 v164, v164
    v_exp_f32 v165, v165
    v_exp_f32 v166, v166
    v_exp_f32 v167, v167
    v_cvt_pk_bf16_f32 v224, v152, v153
    v_cvt_pk_bf16_f32 v225, v154, v155
    v_cvt_pk_bf16_f32 v226, v160, v161
    v_cvt_pk_bf16_f32 v227, v162, v163
    v_cvt_pk_bf16_f32 v228, v156, v157
    v_cvt_pk_bf16_f32 v229, v158, v159
    v_cvt_pk_bf16_f32 v230, v164, v165
    v_cvt_pk_bf16_f32 v231, v166, v167
    v_mfma_f32_32x32x16_bf16 v[192:207], v[64:67], v[224:227], v[192:207]
    s_nop 0
    v_mfma_f32_32x32x16_bf16 v[192:207], v[68:71], v[228:231], v[192:207]
    s_nop 7
    s_nop 7
    s_cmp_lt_u32 s47, 1
    s_cbranch_scc1 L_td_201
    v_sub_f32 v168, 0, v248
    v_sub_f32 v169, 0, v248
    v_sub_f32 v170, 0, v248
    v_sub_f32 v171, 0, v248
    v_sub_f32 v172, 0, v248
    v_sub_f32 v173, 0, v248
    v_sub_f32 v174, 0, v248
    v_sub_f32 v175, 0, v248
    v_sub_f32 v176, 0, v248
    v_sub_f32 v177, 0, v248
    v_sub_f32 v178, 0, v248
    v_sub_f32 v179, 0, v248
    v_sub_f32 v180, 0, v248
    v_sub_f32 v181, 0, v248
    v_sub_f32 v182, 0, v248
    v_sub_f32 v183, 0, v248
    s_nop 1
    v_mfma_f32_32x32x16_bf16 v[152:167], v[92:95], v[112:115], v[168:183]
    s_nop 11
    v_exp_f32 v152, v152
    v_exp_f32 v153, v153
    v_exp_f32 v154, v154
    v_exp_f32 v155, v155
    v_exp_f32 v156, v156
    v_exp_f32 v157, v157
    v_exp_f32 v158, v158
    v_exp_f32 v159, v159
    v_exp_f32 v160, v160
    v_exp_f32 v161, v161
    v_exp_f32 v162, v162
    v_exp_f32 v163, v163
    v_exp_f32 v164, v164
    v_exp_f32 v165, v165
    v_exp_f32 v166, v166
    v_exp_f32 v167, v167
    v_cvt_pk_bf16_f32 v224, v152, v153
    v_cvt_pk_bf16_f32 v225, v154, v155
    v_cvt_pk_bf16_f32 v226, v160, v161
    v_cvt_pk_bf16_f32 v227, v162, v163
    v_cvt_pk_bf16_f32 v228, v156, v157
    v_cvt_pk_bf16_f32 v229, v158, v159
    v_cvt_pk_bf16_f32 v230, v164, v165
    v_cvt_pk_bf16_f32 v231, v166, v167
    v_mfma_f32_32x32x16_bf16 v[192:207], v[56:59], v[224:227], v[192:207]
    s_nop 0
    v_mfma_f32_32x32x16_bf16 v[192:207], v[60:63], v[228:231], v[192:207]
    s_nop 7
    s_nop 7
    s_cmp_lt_u32 s47, 2
    s_cbranch_scc1 L_td_201
    v_sub_f32 v168, 0, v248
    v_sub_f32 v169, 0, v248
    v_sub_f32 v170, 0, v248
    v_sub_f32 v171, 0, v248
    v_sub_f32 v172, 0, v248
    v_sub_f32 v173, 0, v248
    v_sub_f32 v174, 0, v248
    v_sub_f32 v175, 0, v248
    v_sub_f32 v176, 0, v248
    v_sub_f32 v177, 0, v248
    v_sub_f32 v178, 0, v248
    v_sub_f32 v179, 0, v248
    v_sub_f32 v180, 0, v248
    v_sub_f32 v181, 0, v248
    v_sub_f32 v182, 0, v248
    v_sub_f32 v183, 0, v248
    s_nop 1
    v_mfma_f32_32x32x16_bf16 v[152:167], v[96:99], v[112:115], v[168:183]
    s_nop 11
    v_exp_f32 v152, v152
    v_exp_f32 v153, v153
    v_exp_f32 v154, v154
    v_exp_f32 v155, v155
    v_exp_f32 v156, v156
    v_exp_f32 v157, v157
    v_exp_f32 v158, v158
    v_exp_f32 v159, v159
    v_exp_f32 v160, v160
    v_exp_f32 v161, v161
    v_exp_f32 v162, v162
    v_exp_f32 v163, v163
    v_exp_f32 v164, v164
    v_exp_f32 v165, v165
    v_exp_f32 v166, v166
    v_exp_f32 v167, v167
    v_cvt_pk_bf16_f32 v224, v152, v153
    v_cvt_pk_bf16_f32 v225, v154, v155
    v_cvt_pk_bf16_f32 v226, v160, v161
    v_cvt_pk_bf16_f32 v227, v162, v163
    v_cvt_pk_bf16_f32 v228, v156, v157
    v_cvt_pk_bf16_f32 v229, v158, v159
    v_cvt_pk_bf16_f32 v230, v164, v165
    v_cvt_pk_bf16_f32 v231, v166, v167
    v_mfma_f32_32x32x16_bf16 v[192:207], v[48:51], v[224:227], v[192:207]
    s_nop 0
    v_mfma_f32_32x32x16_bf16 v[192:207], v[52:55], v[228:231], v[192:207]
    s_nop 7
    s_nop 7
    s_cmp_lt_u32 s47, 2
    s_cbranch_scc1 L_td_201
    v_sub_f32 v168, 0, v248
    v_sub_f32 v169, 0, v248
    v_sub_f32 v170, 0, v248
    v_sub_f32 v171, 0, v248
    v_sub_f32 v172, 0, v248
    v_sub_f32 v173, 0, v248
    v_sub_f32 v174, 0, v248
    v_sub_f32 v175, 0, v248
    v_sub_f32 v176, 0, v248
    v_sub_f32 v177, 0, v248
    v_sub_f32 v178, 0, v248
    v_sub_f32 v179, 0, v248
    v_sub_f32 v180, 0, v248
    v_sub_f32 v181, 0, v248
    v_sub_f32 v182, 0, v248
    v_sub_f32 v183, 0, v248
    s_nop 1
    v_mfma_f32_32x32x16_bf16 v[152:167], v[100:103], v[112:115], v[168:183]
    s_nop 11
    v_exp_f32 v152, v152
    v_exp_f32 v153, v153
    v_exp_f32 v154, v154
    v_exp_f32 v155, v155
    v_exp_f32 v156, v156
    v_exp_f32 v157, v157
    v_exp_f32 v158, v158
    v_exp_f32 v159, v159
    v_exp_f32 v160, v160
    v_exp_f32 v161, v161
    v_exp_f32 v162, v162
    v_exp_f32 v163, v163
    v_exp_f32 v164, v164
    v_exp_f32 v165, v165
    v_exp_f32 v166, v166
    v_exp_f32 v167, v167
    v_cvt_pk_bf16_f32 v224, v152, v153
    v_cvt_pk_bf16_f32 v225, v154, v155
    v_cvt_pk_bf16_f32 v226, v160, v161
    v_cvt_pk_bf16_f32 v227, v162, v163
    v_cvt_pk_bf16_f32 v228, v156, v157
    v_cvt_pk_bf16_f32 v229, v158, v159
    v_cvt_pk_bf16_f32 v230, v164, v165
    v_cvt_pk_bf16_f32 v231, v166, v167
    v_mfma_f32_32x32x16_bf16 v[192:207], v[40:43], v[224:227], v[192:207]
    s_nop 0
    v_mfma_f32_32x32x16_bf16 v[192:207], v[44:47], v[228:231], v[192:207]
    s_nop 7
    s_nop 7
    s_cmp_lt_u32 s47, 3
    s_cbranch_scc1 L_td_201
    v_sub_f32 v168, 0, v248
    v_sub_f32 v169, 0, v248
    v_sub_f32 v170, 0, v248
    v_sub_f32 v171, 0, v248
    v_sub_f32 v172, 0, v248
    v_sub_f32 v173, 0, v248
    v_sub_f32 v174, 0, v248
    v_sub_f32 v175, 0, v248
    v_sub_f32 v176, 0, v248
    v_sub_f32 v177, 0, v248
    v_sub_f32 v178, 0, v248
    v_sub_f32 v179, 0, v248
    v_sub_f32 v180, 0, v248
    v_sub_f32 v181, 0, v248
    v_sub_f32 v182, 0, v248
    v_sub_f32 v183, 0, v248
    s_nop 1
    v_mfma_f32_32x32x16_bf16 v[152:167], v[120:123], v[112:115], v[168:183]
    s_nop 11
    v_exp_f32 v152, v152
    v_exp_f32 v153, v153
    v_exp_f32 v154, v154
    v_exp_f32 v155, v155
    v_exp_f32 v156, v156
    v_exp_f32 v157, v157
    v_exp_f32 v158, v158
    v_exp_f32 v159, v159
    v_exp_f32 v160, v160
    v_exp_f32 v161, v161
    v_exp_f32 v162, v162
    v_exp_f32 v163, v163
    v_exp_f32 v164, v164
    v_exp_f32 v165, v165
    v_exp_f32 v166, v166
    v_exp_f32 v167, v167
    v_cvt_pk_bf16_f32 v224, v152, v153
    v_cvt_pk_bf16_f32 v225, v154, v155
    v_cvt_pk_bf16_f32 v226, v160, v161
    v_cvt_pk_bf16_f32 v227, v162, v163
    v_cvt_pk_bf16_f32 v228, v156, v157
    v_cvt_pk_bf16_f32 v229, v158, v159
    v_cvt_pk_bf16_f32 v230, v164, v165
    v_cvt_pk_bf16_f32 v231, v166, v167
    v_mfma_f32_32x32x16_bf16 v[192:207], v[32:35], v[224:227], v[192:207]
    s_nop 0
    v_mfma_f32_32x32x16_bf16 v[192:207], v[36:39], v[228:231], v[192:207]
    s_nop 7
    s_nop 7
    s_cmp_lt_u32 s47, 3
    s_cbranch_scc1 L_td_201
    v_sub_f32 v168, 0, v248
    v_sub_f32 v169, 0, v248
    v_sub_f32 v170, 0, v248
    v_sub_f32 v171, 0, v248
    v_sub_f32 v172, 0, v248
    v_sub_f32 v173, 0, v248
    v_sub_f32 v174, 0, v248
    v_sub_f32 v175, 0, v248
    v_sub_f32 v176, 0, v248
    v_sub_f32 v177, 0, v248
    v_sub_f32 v178, 0, v248
    v_sub_f32 v179, 0, v248
    v_sub_f32 v180, 0, v248
    v_sub_f32 v181, 0, v248
    v_sub_f32 v182, 0, v248
    v_sub_f32 v183, 0, v248
    s_nop 1
    v_mfma_f32_32x32x16_bf16 v[152:167], v[124:127], v[112:115], v[168:183]
    s_nop 11
    v_exp_f32 v152, v152
    v_exp_f32 v153, v153
    v_exp_f32 v154, v154
    v_exp_f32 v155, v155
    v_exp_f32 v156, v156
    v_exp_f32 v157, v157
    v_exp_f32 v158, v158
    v_exp_f32 v159, v159
    v_exp_f32 v160, v160
    v_exp_f32 v161, v161
    v_exp_f32 v162, v162
    v_exp_f32 v163, v163
    v_exp_f32 v164, v164
    v_exp_f32 v165, v165
    v_exp_f32 v166, v166
    v_exp_f32 v167, v167
    v_cvt_pk_bf16_f32 v224, v152, v153
    v_cvt_pk_bf16_f32 v225, v154, v155
    v_cvt_pk_bf16_f32 v226, v160, v161
    v_cvt_pk_bf16_f32 v227, v162, v163
    v_cvt_pk_bf16_f32 v228, v156, v157
    v_cvt_pk_bf16_f32 v229, v158, v159
    v_cvt_pk_bf16_f32 v230, v164, v165
    v_cvt_pk_bf16_f32 v231, v166, v167
    v_mfma_f32_32x32x16_bf16 v[192:207], v[24:27], v[224:227], v[192:207]
    s_nop 0
    v_mfma_f32_32x32x16_bf16 v[192:207], v[28:31], v[228:231], v[192:207]
    s_nop 7
    s_nop 7
    s_cmp_lt_u32 s47, 4
    s_cbranch_scc1 L_td_201
    v_sub_f32 v168, 0, v248
    v_sub_f32 v169, 0, v248
    v_sub_f32 v170, 0, v248
    v_sub_f32 v171, 0, v248
    v_sub_f32 v172, 0, v248
    v_sub_f32 v173, 0, v248
    v_sub_f32 v174, 0, v248
    v_sub_f32 v175, 0, v248
    v_sub_f32 v176, 0, v248
    v_sub_f32 v177, 0, v248
    v_sub_f32 v178, 0, v248
    v_sub_f32 v179, 0, v248
    v_sub_f32 v180, 0, v248
    v_sub_f32 v181, 0, v248
    v_sub_f32 v182, 0, v248
    v_sub_f32 v183, 0, v248
    s_nop 1
    v_mfma_f32_32x32x16_bf16 v[152:167], v[128:131], v[112:115], v[168:183]
    s_nop 11
    v_exp_f32 v152, v152
    v_exp_f32 v153, v153
    v_exp_f32 v154, v154
    v_exp_f32 v155, v155
    v_exp_f32 v156, v156
    v_exp_f32 v157, v157
    v_exp_f32 v158, v158
    v_exp_f32 v159, v159
    v_exp_f32 v160, v160
    v_exp_f32 v161, v161
    v_exp_f32 v162, v162
    v_exp_f32 v163, v163
    v_exp_f32 v164, v164
    v_exp_f32 v165, v165
    v_exp_f32 v166, v166
    v_exp_f32 v167, v167
    v_cvt_pk_bf16_f32 v224, v152, v153
    v_cvt_pk_bf16_f32 v225, v154, v155
    v_cvt_pk_bf16_f32 v226, v160, v161
    v_cvt_pk_bf16_f32 v227, v162, v163
    v_cvt_pk_bf16_f32 v228, v156, v157
    v_cvt_pk_bf16_f32 v229, v158, v159
    v_cvt_pk_bf16_f32 v230, v164, v165
    v_cvt_pk_bf16_f32 v231, v166, v167
    v_mfma_f32_32x32x16_bf16 v[192:207], v[16:19], v[224:227], v[192:207]
    s_nop 0
    v_mfma_f32_32x32x16_bf16 v[192:207], v[20:23], v[228:231], v[192:207]
    s_nop 7
    s_nop 7
    s_cmp_lt_u32 s47, 4
    s_cbranch_scc1 L_td_201
    v_sub_f32 v168, v136, v248
    v_sub_f32 v169, v137, v248
    v_sub_f32 v170, v138, v248
    v_sub_f32 v171, v139, v248
    v_sub_f32 v172, v140, v248
    v_sub_f32 v173, v141, v248
    v_sub_f32 v174, v142, v248
    v_sub_f32 v175, v143, v248
    v_sub_f32 v176, v144, v248
    v_sub_f32 v177, v145, v248
    v_sub_f32 v178, v146, v248
    v_sub_f32 v179, v147, v248
    v_sub_f32 v180, v148, v248
    v_sub_f32 v181, v149, v248
    v_sub_f32 v182, v150, v248
    v_sub_f32 v183, v151, v248
    s_nop 1
    v_mfma_f32_32x32x16_bf16 v[152:167], v[132:135], v[112:115], v[168:183]
    s_nop 11
    v_exp_f32 v152, v152
    v_exp_f32 v153, v153
    v_exp_f32 v154, v154
    v_exp_f32 v155, v155
    v_exp_f32 v156, v156
    v_exp_f32 v157, v157
    v_exp_f32 v158, v158
    v_exp_f32 v159, v159
    v_exp_f32 v160, v160
    v_exp_f32 v161, v161
    v_exp_f32 v162, v162
    v_exp_f32 v163, v163
    v_exp_f32 v164, v164
    v_exp_f32 v165, v165
    v_exp_f32 v166, v166
    v_exp_f32 v167, v167
    v_cvt_pk_bf16_f32 v224, v152, v153
    v_cvt_pk_bf16_f32 v225, v154, v155
    v_cvt_pk_bf16_f32 v226, v160, v161
    v_cvt_pk_bf16_f32 v227, v162, v163
    v_cvt_pk_bf16_f32 v228, v156, v157
    v_cvt_pk_bf16_f32 v229, v158, v159
    v_cvt_pk_bf16_f32 v230, v164, v165
    v_cvt_pk_bf16_f32 v231, v166, v167
    v_mfma_f32_32x32x16_bf16 v[192:207], v[8:11], v[224:227], v[192:207]
    s_nop 0
    v_mfma_f32_32x32x16_bf16 v[192:207], v[12:15], v[228:231], v[192:207]
    s_nop 7
    s_nop 7
L_td_201:
    v_xor_b32 v136, s59, v136
    v_xor_b32 v137, s59, v137
    v_xor_b32 v138, s59, v138
    v_xor_b32 v139, s59, v139
    v_xor_b32 v140, s59, v140
    v_xor_b32 v141, s59, v141
    v_xor_b32 v142, s59, v142
    v_xor_b32 v143, s59, v143
    v_xor_b32 v144, s59, v144
    v_xor_b32 v145, s59, v145
    v_xor_b32 v146, s59, v146
    v_xor_b32 v147, s59, v147
    v_xor_b32 v148, s59, v148
    v_xor_b32 v149, s59, v149
    v_xor_b32 v150, s59, v150
    v_xor_b32 v151, s59, v151
    s_nop 1
    v_mfma_f32_32x32x16_bf16 v[152:167], v[108:111], v[116:119], v[136:151]
    s_nop 11
    v_max_f32 v248, v152, v153
    v_max3_f32 v248, v248, v154, v155
    v_max3_f32 v248, v248, v156, v157
    v_max3_f32 v248, v248, v158, v159
    v_max3_f32 v248, v248, v160, v161
    v_max3_f32 v248, v248, v162, v163
    v_max3_f32 v248, v248, v164, v165
    v_max3_f32 v248, v248, v166, v167
    s_nop 7
    v_xor_b32 v136, s59, v136
    v_xor_b32 v137, s59, v137
    v_xor_b32 v138, s59, v138
    v_xor_b32 v139, s59, v139
    v_xor_b32 v140, s59, v140
    v_xor_b32 v141, s59, v141
    v_xor_b32 v142, s59, v142
    v_xor_b32 v143, s59, v143
    v_xor_b32 v144, s59, v144
    v_xor_b32 v145, s59, v145
    v_xor_b32 v146, s59, v146
    v_xor_b32 v147, s59, v147
    v_xor_b32 v148, s59, v148
    v_xor_b32 v149, s59, v149
    v_xor_b32 v150, s59, v150
    v_xor_b32 v151, s59, v151
    v_mfma_f32_32x32x16_bf16 v[152:167], v[104:107], v[116:119], 0
    s_nop 11
    v_max3_f32 v248, v248, v152, v153
    v_max3_f32 v248, v248, v154, v155
    v_max3_f32 v248, v248, v156, v157
    v_max3_f32 v248, v248, v158, v159
    v_max3_f32 v248, v248, v160, v161
    v_max3_f32 v248, v248, v162, v163
    v_max3_f32 v248, v248, v164, v165
    v_max3_f32 v248, v248, v166, v167
    s_nop 7
    s_cmp_lt_u32 s47, 1
    s_cbranch_scc1 L_td_202
    v_mfma_f32_32x32x16_bf16 v[152:167], v[88:91], v[116:119], 0
    s_nop 11
    v_max3_f32 v248, v248, v152, v153
    v_max3_f32 v248, v248, v154, v155
    v_max3_f32 v248, v248, v156, v157
    v_max3_f32 v248, v248, v158, v159
    v_max3_f32 v248, v248, v160, v161
    v_max3_f32 v248, v248, v162, v163
    v_max3_f32 v248, v248, v164, v165
    v_max3_f32 v248, v248, v166, v167
    s_nop 7
    s_cmp_lt_u32 s47, 1
    s_cbranch_scc1 L_td_202
    v_mfma_f32_32x32x16_bf16 v[152:167], v[92:95], v[116:119], 0
    s_nop 11
    v_max3_f32 v248, v248, v152, v153
    v_max3_f32 v248, v248, v154, v155
    v_max3_f32 v248, v248, v156, v157
    v_max3_f32 v248, v248, v158, v159
    v_max3_f32 v248, v248, v160, v161
    v_max3_f32 v248, v248, v162, v163
    v_max3_f32 v248, v248, v164, v165
    v_max3_f32 v248, v248, v166, v167
    s_nop 7
    s_cmp_lt_u32 s47, 2
    s_cbranch_scc1 L_td_202
    v_mfma_f32_32x32x16_bf16 v[152:167], v[96:99], v[116:119], 0
    s_nop 11
    v_max3_f32 v248, v248, v152, v153
    v_max3_f32 v248, v248, v154, v155
    v_max3_f32 v248, v248, v156, v157
    v_max3_f32 v248, v248, v158, v159
    v_max3_f32 v248, v248, v160, v161
    v_max3_f32 v248, v248, v162, v163
    v_max3_f32 v248, v248, v164, v165
    v_max3_f32 v248, v248, v166, v167
    s_nop 7
    s_cmp_lt_u32 s47, 2
    s_cbranch_scc1 L_td_202
    v_mfma_f32_32x32x16_bf16 v[152:167], v[100:103], v[116:119], 0
    s_nop 11
    v_max3_f32 v248, v248, v152, v153
    v_max3_f32 v248, v248, v154, v155
    v_max3_f32 v248, v248, v156, v157
    v_max3_f32 v248, v248, v158, v159
    v_max3_f32 v248, v248, v160, v161
    v_max3_f32 v248, v248, v162, v163
    v_max3_f32 v248, v248, v164, v165
    v_max3_f32 v248, v248, v166, v167
    s_nop 7
    s_cmp_lt_u32 s47, 3
    s_cbranch_scc1 L_td_202
    v_mfma_f32_32x32x16_bf16 v[152:167], v[120:123], v[116:119], 0
    s_nop 11
    v_max3_f32 v248, v248, v152, v153
    v_max3_f32 v248, v248, v154, v155
    v_max3_f32 v248, v248, v156, v157
    v_max3_f32 v248, v248, v158, v159
    v_max3_f32 v248, v248, v160, v161
    v_max3_f32 v248, v248, v162, v163
    v_max3_f32 v248, v248, v164, v165
    v_max3_f32 v248, v248, v166, v167
    s_nop 7
    s_cmp_lt_u32 s47, 3
    s_cbranch_scc1 L_td_202
    v_mfma_f32_32x32x16_bf16 v[152:167], v[124:127], v[116:119], 0
    s_nop 11
    v_max3_f32 v248, v248, v152, v153
    v_max3_f32 v248, v248, v154, v155
    v_max3_f32 v248, v248, v156, v157
    v_max3_f32 v248, v248, v158, v159
    v_max3_f32 v248, v248, v160, v161
    v_max3_f32 v248, v248, v162, v163
    v_max3_f32 v248, v248, v164, v165
    v_max3_f32 v248, v248, v166, v167
    s_nop 7
    s_cmp_lt_u32 s47, 4
    s_cbranch_scc1 L_td_202
    v_mfma_f32_32x32x16_bf16 v[152:167], v[128:131], v[116:119], v[136:151]
    s_nop 11
    v_max3_f32 v248, v248, v152, v153
    v_max3_f32 v248, v248, v154, v155
    v_max3_f32 v248, v248, v156, v157
    v_max3_f32 v248, v248, v158, v159
    v_max3_f32 v248, v248, v160, v161
    v_max3_f32 v248, v248, v162, v163
    v_max3_f32 v248, v248, v164, v165
    v_max3_f32 v248, v248, v166, v167
    s_nop 7
L_td_202:
    v_mov_b32 v249, v248
    s_nop 1
    v_permlane32_swap_b32 v248, v249
    v_max_f32 v248, v248, v249
    v_xor_b32 v136, s59, v136
    v_xor_b32 v137, s59, v137
    v_xor_b32 v138, s59, v138
    v_xor_b32 v139, s59, v139
    v_xor_b32 v140, s59, v140
    v_xor_b32 v141, s59, v141
    v_xor_b32 v142, s59, v142
    v_xor_b32 v143, s59, v143
    v_xor_b32 v144, s59, v144
    v_xor_b32 v145, s59, v145
    v_xor_b32 v146, s59, v146
    v_xor_b32 v147, s59, v147
    v_xor_b32 v148, s59, v148
    v_xor_b32 v149, s59, v149
    v_xor_b32 v150, s59, v150
    v_xor_b32 v151, s59, v151
    v_sub_f32 v168, v136, v248
    v_sub_f32 v169, v137, v248
    v_sub_f32 v170, v138, v248
    v_sub_f32 v171, v139, v248
    v_sub_f32 v172, v140, v248
    v_sub_f32 v173, v141, v248
    v_sub_f32 v174, v142, v248
    v_sub_f32 v175, v143, v248
    v_sub_f32 v176, v144, v248
    v_sub_f32 v177, v145, v248
    v_sub_f32 v178, v146, v248
    v_sub_f32 v179, v147, v248
    v_sub_f32 v180, v148, v248
    v_sub_f32 v181, v149, v248
    v_sub_f32 v182, v150, v248
    v_sub_f32 v183, v151, v248
    s_nop 1
    v_mfma_f32_32x32x16_bf16 v[152:167], v[108:111], v[116:119], v[168:183]
    s_nop 11
    v_exp_f32 v152, v152
    v_exp_f32 v153, v153
    v_exp_f32 v154, v154
    v_exp_f32 v155, v155
    v_exp_f32 v156, v156
    v_exp_f32 v157, v157
    v_exp_f32 v158, v158
    v_exp_f32 v159, v159
    v_exp_f32 v160, v160
    v_exp_f32 v161, v161
    v_exp_f32 v162, v162
    v_exp_f32 v163, v163
    v_exp_f32 v164, v164
    v_exp_f32 v165, v165
    v_exp_f32 v166, v166
    v_exp_f32 v167, v167
    v_cvt_pk_bf16_f32 v224, v152, v153
    v_cvt_pk_bf16_f32 v225, v154, v155
    v_cvt_pk_bf16_f32 v226, v160, v161
    v_cvt_pk_bf16_f32 v227, v162, v163
    v_cvt_pk_bf16_f32 v228, v156, v157
    v_cvt_pk_bf16_f32 v229, v158, v159
    v_cvt_pk_bf16_f32 v230, v164, v165
    v_cvt_pk_bf16_f32 v231, v166, v167
    v_mfma_f32_32x32x16_bf16 v[208:223], v[80:83], v[224:227], 0
    s_nop 0
    v_mfma_f32_32x32x16_bf16 v[208:223], v[84:87], v[228:231], v[208:223]
    s_nop 7
    s_nop 7
    v_xor_b32 v136, s59, v136
    v_xor_b32 v137, s59, v137
    v_xor_b32 v138, s59, v138
    v_xor_b32 v139, s59, v139
    v_xor_b32 v140, s59, v140
    v_xor_b32 v141, s59, v141
    v_xor_b32 v142, s59, v142
    v_xor_b32 v143, s59, v143
    v_xor_b32 v144, s59, v144
    v_xor_b32 v145, s59, v145
    v_xor_b32 v146, s59, v146
    v_xor_b32 v147, s59, v147
    v_xor_b32 v148, s59, v148
    v_xor_b32 v149, s59, v149
    v_xor_b32 v150, s59, v150
    v_xor_b32 v151, s59, v151
    v_sub_f32 v168, 0, v248
    v_sub_f32 v169, 0, v248
    v_sub_f32 v170, 0, v248
    v_sub_f32 v171, 0, v248
    v_sub_f32 v172, 0, v248
    v_sub_f32 v173, 0, v248
    v_sub_f32 v174, 0, v248
    v_sub_f32 v175, 0, v248
    v_sub_f32 v176, 0, v248
    v_sub_f32 v177, 0, v248
    v_sub_f32 v178, 0, v248
    v_sub_f32 v179, 0, v248
    v_sub_f32 v180, 0, v248
    v_sub_f32 v181, 0, v248
    v_sub_f32 v182, 0, v248
    v_sub_f32 v183, 0, v248
    s_nop 1
    v_mfma_f32_32x32x16_bf16 v[152:167], v[104:107], v[116:119], v[168:183]
    s_nop 11
    v_exp_f32 v152, v152
    v_exp_f32 v153, v153
    v_exp_f32 v154, v154
    v_exp_f32 v155, v155
    v_exp_f32 v156, v156
    v_exp_f32 v157, v157
    v_exp_f32 v158, v158
    v_exp_f32 v159, v159
    v_exp_f32 v160, v160
    v_exp_f32 v161, v161
    v_exp_f32 v162, v162
    v_exp_f32 v163, v163
    v_exp_f32 v164, v164
    v_exp_f32 v165, v165
    v_exp_f32 v166, v166
    v_exp_f32 v167, v167
    v_cvt_pk_bf16_f32 v224, v152, v153
    v_cvt_pk_bf16_f32 v225, v154, v155
    v_cvt_pk_bf16_f32 v226, v160, v161
    v_cvt_pk_bf16_f32 v227, v162, v163
    v_cvt_pk_bf16_f32 v228, v156, v157
    v_cvt_pk_bf16_f32 v229, v158, v159
    v_cvt_pk_bf16_f32 v230, v164, v165
    v_cvt_pk_bf16_f32 v231, v166, v167
    v_mfma_f32_32x32x16_bf16 v[208:223], v[72:75], v[224:227], v[208:223]
    s_nop 0
    v_mfma_f32_32x32x16_bf16 v[208:223], v[76:79], v[228:231], v[208:223]
    s_nop 7
    s_nop 7
    s_cmp_lt_u32 s47, 1
    s_cbranch_scc1 L_td_203
    v_sub_f32 v168, 0, v248
    v_sub_f32 v169, 0, v248
    v_sub_f32 v170, 0, v248
    v_sub_f32 v171, 0, v248
    v_sub_f32 v172, 0, v248
    v_sub_f32 v173, 0, v248
    v_sub_f32 v174, 0, v248
    v_sub_f32 v175, 0, v248
    v_sub_f32 v176, 0, v248
    v_sub_f32 v177, 0, v248
    v_sub_f32 v178, 0, v248
    v_sub_f32 v179, 0, v248
    v_sub_f32 v180, 0, v248
    v_sub_f32 v181, 0, v248
    v_sub_f32 v182, 0, v248
    v_sub_f32 v183, 0, v248
    s_nop 1
    v_mfma_f32_32x32x16_bf16 v[152:167], v[88:91], v[116:119], v[168:183]
    s_nop 11
    v_exp_f32 v152, v152
    v_exp_f32 v153, v153
    v_exp_f32 v154, v154
    v_exp_f32 v155, v155
    v_exp_f32 v156, v156
    v_exp_f32 v157, v157
    v_exp_f32 v158, v158
    v_exp_f32 v159, v159
    v_exp_f32 v160, v160
    v_exp_f32 v161, v161
    v_exp_f32 v162, v162
    v_exp_f32 v163, v163
    v_exp_f32 v164, v164
    v_exp_f32 v165, v165
    v_exp_f32 v166, v166
    v_exp_f32 v167, v167
    v_cvt_pk_bf16_f32 v224, v152, v153
    v_cvt_pk_bf16_f32 v225, v154, v155
    v_cvt_pk_bf16_f32 v226, v160, v161
    v_cvt_pk_bf16_f32 v227, v162, v163
    v_cvt_pk_bf16_f32 v228, v156, v157
    v_cvt_pk_bf16_f32 v229, v158, v159
    v_cvt_pk_bf16_f32 v230, v164, v165
    v_cvt_pk_bf16_f32 v231, v166, v167
    v_mfma_f32_32x32x16_bf16 v[208:223], v[64:67], v[224:227], v[208:223]
    s_nop 0
    v_mfma_f32_32x32x16_bf16 v[208:223], v[68:71], v[228:231], v[208:223]
    s_nop 7
    s_nop 7
    s_cmp_lt_u32 s47, 1
    s_cbranch_scc1 L_td_203
    v_sub_f32 v168, 0, v248
    v_sub_f32 v169, 0, v248
    v_sub_f32 v170, 0, v248
    v_sub_f32 v171, 0, v248
    v_sub_f32 v172, 0, v248
    v_sub_f32 v173, 0, v248
    v_sub_f32 v174, 0, v248
    v_sub_f32 v175, 0, v248
    v_sub_f32 v176, 0, v248
    v_sub_f32 v177, 0, v248
    v_sub_f32 v178, 0, v248
    v_sub_f32 v179, 0, v248
    v_sub_f32 v180, 0, v248
    v_sub_f32 v181, 0, v248
    v_sub_f32 v182, 0, v248
    v_sub_f32 v183, 0, v248
    s_nop 1
    v_mfma_f32_32x32x16_bf16 v[152:167], v[92:95], v[116:119], v[168:183]
    s_nop 11
    v_exp_f32 v152, v152
    v_exp_f32 v153, v153
    v_exp_f32 v154, v154
    v_exp_f32 v155, v155
    v_exp_f32 v156, v156
    v_exp_f32 v157, v157
    v_exp_f32 v158, v158
    v_exp_f32 v159, v159
    v_exp_f32 v160, v160
    v_exp_f32 v161, v161
    v_exp_f32 v162, v162
    v_exp_f32 v163, v163
    v_exp_f32 v164, v164
    v_exp_f32 v165, v165
    v_exp_f32 v166, v166
    v_exp_f32 v167, v167
    v_cvt_pk_bf16_f32 v224, v152, v153
    v_cvt_pk_bf16_f32 v225, v154, v155
    v_cvt_pk_bf16_f32 v226, v160, v161
    v_cvt_pk_bf16_f32 v227, v162, v163
    v_cvt_pk_bf16_f32 v228, v156, v157
    v_cvt_pk_bf16_f32 v229, v158, v159
    v_cvt_pk_bf16_f32 v230, v164, v165
    v_cvt_pk_bf16_f32 v231, v166, v167
    v_mfma_f32_32x32x16_bf16 v[208:223], v[56:59], v[224:227], v[208:223]
    s_nop 0
    v_mfma_f32_32x32x16_bf16 v[208:223], v[60:63], v[228:231], v[208:223]
    s_nop 7
    s_nop 7
    s_cmp_lt_u32 s47, 2
    s_cbranch_scc1 L_td_203
    v_sub_f32 v168, 0, v248
    v_sub_f32 v169, 0, v248
    v_sub_f32 v170, 0, v248
    v_sub_f32 v171, 0, v248
    v_sub_f32 v172, 0, v248
    v_sub_f32 v173, 0, v248
    v_sub_f32 v174, 0, v248
    v_sub_f32 v175, 0, v248
    v_sub_f32 v176, 0, v248
    v_sub_f32 v177, 0, v248
    v_sub_f32 v178, 0, v248
    v_sub_f32 v179, 0, v248
    v_sub_f32 v180, 0, v248
    v_sub_f32 v181, 0, v248
    v_sub_f32 v182, 0, v248
    v_sub_f32 v183, 0, v248
    s_nop 1
    v_mfma_f32_32x32x16_bf16 v[152:167], v[96:99], v[116:119], v[168:183]
    s_nop 11
    v_exp_f32 v152, v152
    v_exp_f32 v153, v153
    v_exp_f32 v154, v154
    v_exp_f32 v155, v155
    v_exp_f32 v156, v156
    v_exp_f32 v157, v157
    v_exp_f32 v158, v158
    v_exp_f32 v159, v159
    v_exp_f32 v160, v160
    v_exp_f32 v161, v161
    v_exp_f32 v162, v162
    v_exp_f32 v163, v163
    v_exp_f32 v164, v164
    v_exp_f32 v165, v165
    v_exp_f32 v166, v166
    v_exp_f32 v167, v167
    v_cvt_pk_bf16_f32 v224, v152, v153
    v_cvt_pk_bf16_f32 v225, v154, v155
    v_cvt_pk_bf16_f32 v226, v160, v161
    v_cvt_pk_bf16_f32 v227, v162, v163
    v_cvt_pk_bf16_f32 v228, v156, v157
    v_cvt_pk_bf16_f32 v229, v158, v159
    v_cvt_pk_bf16_f32 v230, v164, v165
    v_cvt_pk_bf16_f32 v231, v166, v167
    v_mfma_f32_32x32x16_bf16 v[208:223], v[48:51], v[224:227], v[208:223]
    s_nop 0
    v_mfma_f32_32x32x16_bf16 v[208:223], v[52:55], v[228:231], v[208:223]
    s_nop 7
    s_nop 7
    s_cmp_lt_u32 s47, 2
    s_cbranch_scc1 L_td_203
    v_sub_f32 v168, 0, v248
    v_sub_f32 v169, 0, v248
    v_sub_f32 v170, 0, v248
    v_sub_f32 v171, 0, v248
    v_sub_f32 v172, 0, v248
    v_sub_f32 v173, 0, v248
    v_sub_f32 v174, 0, v248
    v_sub_f32 v175, 0, v248
    v_sub_f32 v176, 0, v248
    v_sub_f32 v177, 0, v248
    v_sub_f32 v178, 0, v248
    v_sub_f32 v179, 0, v248
    v_sub_f32 v180, 0, v248
    v_sub_f32 v181, 0, v248
    v_sub_f32 v182, 0, v248
    v_sub_f32 v183, 0, v248
    s_nop 1
    v_mfma_f32_32x32x16_bf16 v[152:167], v[100:103], v[116:119], v[168:183]
    s_nop 11
    v_exp_f32 v152, v152
    v_exp_f32 v153, v153
    v_exp_f32 v154, v154
    v_exp_f32 v155, v155
    v_exp_f32 v156, v156
    v_exp_f32 v157, v157
    v_exp_f32 v158, v158
    v_exp_f32 v159, v159
    v_exp_f32 v160, v160
    v_exp_f32 v161, v161
    v_exp_f32 v162, v162
    v_exp_f32 v163, v163
    v_exp_f32 v164, v164
    v_exp_f32 v165, v165
    v_exp_f32 v166, v166
    v_exp_f32 v167, v167
    v_cvt_pk_bf16_f32 v224, v152, v153
    v_cvt_pk_bf16_f32 v225, v154, v155
    v_cvt_pk_bf16_f32 v226, v160, v161
    v_cvt_pk_bf16_f32 v227, v162, v163
    v_cvt_pk_bf16_f32 v228, v156, v157
    v_cvt_pk_bf16_f32 v229, v158, v159
    v_cvt_pk_bf16_f32 v230, v164, v165
    v_cvt_pk_bf16_f32 v231, v166, v167
    v_mfma_f32_32x32x16_bf16 v[208:223], v[40:43], v[224:227], v[208:223]
    s_nop 0
    v_mfma_f32_32x32x16_bf16 v[208:223], v[44:47], v[228:231], v[208:223]
    s_nop 7
    s_nop 7
    s_cmp_lt_u32 s47, 3
    s_cbranch_scc1 L_td_203
    v_sub_f32 v168, 0, v248
    v_sub_f32 v169, 0, v248
    v_sub_f32 v170, 0, v248
    v_sub_f32 v171, 0, v248
    v_sub_f32 v172, 0, v248
    v_sub_f32 v173, 0, v248
    v_sub_f32 v174, 0, v248
    v_sub_f32 v175, 0, v248
    v_sub_f32 v176, 0, v248
    v_sub_f32 v177, 0, v248
    v_sub_f32 v178, 0, v248
    v_sub_f32 v179, 0, v248
    v_sub_f32 v180, 0, v248
    v_sub_f32 v181, 0, v248
    v_sub_f32 v182, 0, v248
    v_sub_f32 v183, 0, v248
    s_nop 1
    v_mfma_f32_32x32x16_bf16 v[152:167], v[120:123], v[116:119], v[168:183]
    s_nop 11
    v_exp_f32 v152, v152
    v_exp_f32 v153, v153
    v_exp_f32 v154, v154
    v_exp_f32 v155, v155
    v_exp_f32 v156, v156
    v_exp_f32 v157, v157
    v_exp_f32 v158, v158
    v_exp_f32 v159, v159
    v_exp_f32 v160, v160
    v_exp_f32 v161, v161
    v_exp_f32 v162, v162
    v_exp_f32 v163, v163
    v_exp_f32 v164, v164
    v_exp_f32 v165, v165
    v_exp_f32 v166, v166
    v_exp_f32 v167, v167
    v_cvt_pk_bf16_f32 v224, v152, v153
    v_cvt_pk_bf16_f32 v225, v154, v155
    v_cvt_pk_bf16_f32 v226, v160, v161
    v_cvt_pk_bf16_f32 v227, v162, v163
    v_cvt_pk_bf16_f32 v228, v156, v157
    v_cvt_pk_bf16_f32 v229, v158, v159
    v_cvt_pk_bf16_f32 v230, v164, v165
    v_cvt_pk_bf16_f32 v231, v166, v167
    v_mfma_f32_32x32x16_bf16 v[208:223], v[32:35], v[224:227], v[208:223]
    s_nop 0
    v_mfma_f32_32x32x16_bf16 v[208:223], v[36:39], v[228:231], v[208:223]
    s_nop 7
    s_nop 7
    s_cmp_lt_u32 s47, 3
    s_cbranch_scc1 L_td_203
    v_sub_f32 v168, 0, v248
    v_sub_f32 v169, 0, v248
    v_sub_f32 v170, 0, v248
    v_sub_f32 v171, 0, v248
    v_sub_f32 v172, 0, v248
    v_sub_f32 v173, 0, v248
    v_sub_f32 v174, 0, v248
    v_sub_f32 v175, 0, v248
    v_sub_f32 v176, 0, v248
    v_sub_f32 v177, 0, v248
    v_sub_f32 v178, 0, v248
    v_sub_f32 v179, 0, v248
    v_sub_f32 v180, 0, v248
    v_sub_f32 v181, 0, v248
    v_sub_f32 v182, 0, v248
    v_sub_f32 v183, 0, v248
    s_nop 1
    v_mfma_f32_32x32x16_bf16 v[152:167], v[124:127], v[116:119], v[168:183]
    s_nop 11
    v_exp_f32 v152, v152
    v_exp_f32 v153, v153
    v_exp_f32 v154, v154
    v_exp_f32 v155, v155
    v_exp_f32 v156, v156
    v_exp_f32 v157, v157
    v_exp_f32 v158, v158
    v_exp_f32 v159, v159
    v_exp_f32 v160, v160
    v_exp_f32 v161, v161
    v_exp_f32 v162, v162
    v_exp_f32 v163, v163
    v_exp_f32 v164, v164
    v_exp_f32 v165, v165
    v_exp_f32 v166, v166
    v_exp_f32 v167, v167
    v_cvt_pk_bf16_f32 v224, v152, v153
    v_cvt_pk_bf16_f32 v225, v154, v155
    v_cvt_pk_bf16_f32 v226, v160, v161
    v_cvt_pk_bf16_f32 v227, v162, v163
    v_cvt_pk_bf16_f32 v228, v156, v157
    v_cvt_pk_bf16_f32 v229, v158, v159
    v_cvt_pk_bf16_f32 v230, v164, v165
    v_cvt_pk_bf16_f32 v231, v166, v167
    v_mfma_f32_32x32x16_bf16 v[208:223], v[24:27], v[224:227], v[208:223]
    s_nop 0
    v_mfma_f32_32x32x16_bf16 v[208:223], v[28:31], v[228:231], v[208:223]
    s_nop 7
    s_nop 7
    s_cmp_lt_u32 s47, 4
    s_cbranch_scc1 L_td_203
    v_sub_f32 v168, v136, v248
    v_sub_f32 v169, v137, v248
    v_sub_f32 v170, v138, v248
    v_sub_f32 v171, v139, v248
    v_sub_f32 v172, v140, v248
    v_sub_f32 v173, v141, v248
    v_sub_f32 v174, v142, v248
    v_sub_f32 v175, v143, v248
    v_sub_f32 v176, v144, v248
    v_sub_f32 v177, v145, v248
    v_sub_f32 v178, v146, v248
    v_sub_f32 v179, v147, v248
    v_sub_f32 v180, v148, v248
    v_sub_f32 v181, v149, v248
    v_sub_f32 v182, v150, v248
    v_sub_f32 v183, v151, v248
    s_nop 1
    v_mfma_f32_32x32x16_bf16 v[152:167], v[128:131], v[116:119], v[168:183]
    s_nop 11
    v_exp_f32 v152, v152
    v_exp_f32 v153, v153
    v_exp_f32 v154, v154
    v_exp_f32 v155, v155
    v_exp_f32 v156, v156
    v_exp_f32 v157, v157
    v_exp_f32 v158, v158
    v_exp_f32 v159, v159
    v_exp_f32 v160, v160
    v_exp_f32 v161, v161
    v_exp_f32 v162, v162
    v_exp_f32 v163, v163
    v_exp_f32 v164, v164
    v_exp_f32 v165, v165
    v_exp_f32 v166, v166
    v_exp_f32 v167, v167
    v_cvt_pk_bf16_f32 v224, v152, v153
    v_cvt_pk_bf16_f32 v225, v154, v155
    v_cvt_pk_bf16_f32 v226, v160, v161
    v_cvt_pk_bf16_f32 v227, v162, v163
    v_cvt_pk_bf16_f32 v228, v156, v157
    v_cvt_pk_bf16_f32 v229, v158, v159
    v_cvt_pk_bf16_f32 v230, v164, v165
    v_cvt_pk_bf16_f32 v231, v166, v167
    v_mfma_f32_32x32x16_bf16 v[208:223], v[16:19], v[224:227], v[208:223]
    s_nop 0
    v_mfma_f32_32x32x16_bf16 v[208:223], v[20:23], v[228:231], v[208:223]
    s_nop 7
    s_nop 7
L_td_203:
    s_nop 7
    s_nop 7
    s_setpc_b64 s[10:11]
L_gen_tw:
    s_lshl_b32 s50, s46, 4
    v_add_u32 v148, s50, v2
    v_cvt_f32_u32 v148, v148
    v_mul_f32 v148, 0x3a000000, v148
    v_lshlrev_b32 v149, 2, v3
    v_cvt_f32_u32 v149, v149
    v_mul_f32 v149, v149, v148
    v_cos_f32 v150, v149
    v_sin_f32_e64 v151, -v149
    v_add_f32 v149, v149, v148
    v_accvgpr_write_b32 a192, v150
    v_accvgpr_write_b32 a200, v151
    v_cos_f32 v150, v149
    v_sin_f32_e64 v151, -v149
    v_add_f32 v149, v149, v148
    v_accvgpr_write_b32 a193, v150
    v_accvgpr_write_b32 a201, v151
    v_cos_f32 v150, v149
    v_sin_f32_e64 v151, -v149
    v_add_f32 v149, v149, v148
    v_accvgpr_write_b32 a194, v150
    v_accvgpr_write_b32 a202, v151
    v_cos_f32 v150, v149
    v_sin_f32_e64 v151, -v149
    v_mov_b32 v152, 0x41500000
    v_fma_f32 v149, v152, v148, v149
    v_accvgpr_write_b32 a195, v150
    v_accvgpr_write_b32 a203, v151
    v_cos_f32 v150, v149
    v_sin_f32_e64 v151, -v149
    v_add_f32 v149, v149, v148
    v_accvgpr_write_b32 a196, v150
    v_accvgpr_write_b32 a204, v151
    v_cos_f32 v150, v149
    v_sin_f32_e64 v151, -v149
    v_add_f32 v149, v149, v148
    v_accvgpr_write_b32 a197, v150
    v_accvgpr_write_b32 a205, v151
    v_cos_f32 v150, v149
    v_sin_f32_e64 v151, -v149
    v_add_f32 v149, v149, v148
    v_accvgpr_write_b32 a198, v150
    v_accvgpr_write_b32 a206, v151
    v_cos_f32 v150, v149
    v_sin_f32_e64 v151, -v149
    v_accvgpr_write_b32 a199, v150
    v_accvgpr_write_b32 a207, v151
    s_mov_b32 s51, 0x3a000000
    v_add_u32 v148, 0, v2
    v_cvt_f32_u32 v148, v148
    v_mul_f32 v148, s51, v148
    v_lshl_add_u32 v149, v3, 2, s50
    v_cvt_f32_u32 v149, v149
    v_mul_f32 v149, v149, v148
    v_cos_f32 v150, v149
    v_sin_f32_e64 v151, -v149
    v_add_f32 v149, v149, v148
    v_mul_f32 v150, s51, v150
    v_mul_f32 v151, s51, v151
    v_accvgpr_write_b32 a208, v150
    v_accvgpr_write_b32 a216, v151
    v_cos_f32 v150, v149
    v_sin_f32_e64 v151, -v149
    v_add_f32 v149, v149, v148
    v_mul_f32 v150, s51, v150
    v_mul_f32 v151, s51, v151
    v_accvgpr_write_b32 a209, v150
    v_accvgpr_write_b32 a217, v151
    v_cos_f32 v150, v149
    v_sin_f32_e64 v151, -v149
    v_add_f32 v149, v149, v148
    v_mul_f32 v150, s51, v150
    v_mul_f32 v151, s51, v151
    v_accvgpr_write_b32 a210, v150
    v_accvgpr_write_b32 a218, v151
    v_cos_f32 v150, v149
    v_sin_f32_e64 v151, -v149
    v_mul_f32 v150, s51, v150
    v_mul_f32 v151, s51, v151
    v_accvgpr_write_b32 a211, v150
    v_accvgpr_write_b32 a219, v151
    v_add_u32 v148, 16, v2
    v_cvt_f32_u32 v148, v148
    v_mul_f32 v148, s51, v148
    v_lshl_add_u32 v149, v3, 2, s50
    v_cvt_f32_u32 v149, v149
    v_mul_f32 v149, v149, v148
    v_cos_f32 v150, v149
    v_sin_f32_e64 v151, -v149
    v_add_f32 v149, v149, v148
    v_mul_f32 v150, s51, v150
    v_mul_f32 v151, s51, v151
    v_accvgpr_write_b32 a212, v150
    v_accvgpr_write_b32 a220, v151
    v_cos_f32 v150, v149
    v_sin_f32_e64 v151, -v149
    v_add_f32 v149, v149, v148
    v_mul_f32 v150, s51, v150
    v_mul_f32 v151, s51, v151
    v_accvgpr_write_b32 a213, v150
    v_accvgpr_write_b32 a221, v151
    v_cos_f32 v150, v149
    v_sin_f32_e64 v151, -v149
    v_add_f32 v149, v149, v148
    v_mul_f32 v150, s51, v150
    v_mul_f32 v151, s51, v151
    v_accvgpr_write_b32 a214, v150
    v_accvgpr_write_b32 a222, v151
    v_cos_f32 v150, v149
    v_sin_f32_e64 v151, -v149
    v_mul_f32 v150, s51, v150
    v_mul_f32 v151, s51, v151
    v_accvgpr_write_b32 a215, v150
    v_accvgpr_write_b32 a223, v151
    s_nop 1
    s_setpc_b64 s[60:61]
L_gen_f12:
    s_lshl_b32 s50, s46, 4
    v_add_u32 v56, s50, v2
    v_cvt_f32_u32 v56, v56
    v_mul_f32 v56, 0x3c800000, v56
    v_lshlrev_b32 v58, 3, v3
    v_cvt_f32_u32 v58, v58
    v_mul_f32 v58, v58, v56
    v_mov_b32 v44, 0x00000000
    v_fma_f32 v57, v44, v56, v58
    v_cos_f32 v44, v57
    v_add_f32 v57, v57, v56
    v_cos_f32 v51, v56
    v_cos_f32 v45, v57
    v_add_f32 v57, v51, v51
    v_fma_f32 v46, v57, v45, -v44
    v_fma_f32 v47, v57, v46, -v45
    v_fma_f32 v48, v57, v47, -v46
    v_fma_f32 v49, v57, v48, -v47
    v_fma_f32 v50, v57, v49, -v48
    v_fma_f32 v51, v57, v50, -v49
    v_cvt_pk_bf16_f32 v52, v44, v45
    v_cvt_pk_bf16_f32 v53, v46, v47
    v_cvt_pk_bf16_f32 v54, v48, v49
    v_cvt_pk_bf16_f32 v55, v50, v51
    v_accvgpr_write_b32 a240, v52
    v_accvgpr_write_b32 a241, v53
    v_accvgpr_write_b32 a242, v54
    v_accvgpr_write_b32 a243, v55
    v_mov_b32 v44, 0x42000000
    v_fma_f32 v57, v44, v56, v58
    v_cos_f32 v44, v57
    v_add_f32 v57, v57, v56
    v_cos_f32 v51, v56
    v_cos_f32 v45, v57
    v_add_f32 v57, v51, v51
    v_fma_f32 v46, v57, v45, -v44
    v_fma_f32 v47, v57, v46, -v45
    v_fma_f32 v48, v57, v47, -v46
    v_fma_f32 v49, v57, v48, -v47
    v_fma_f32 v50, v57, v49, -v48
    v_fma_f32 v51, v57, v50, -v49
    v_cvt_pk_bf16_f32 v52, v44, v45
    v_cvt_pk_bf16_f32 v53, v46, v47
    v_cvt_pk_bf16_f32 v54, v48, v49
    v_cvt_pk_bf16_f32 v55, v50, v51
    v_accvgpr_write_b32 a244, v52
    v_accvgpr_write_b32 a245, v53
    v_accvgpr_write_b32 a246, v54
    v_accvgpr_write_b32 a247, v55
    v_mov_b32 v44, 0x00000000
    v_fma_f32 v57, v44, v56, v58
    v_add_f32 v57, 0xbe800000, v57
    v_cos_f32 v44, v57
    v_add_f32 v57, v57, v56
    v_cos_f32 v51, v56
    v_cos_f32 v45, v57
    v_add_f32 v57, v51, v51
    v_fma_f32 v46, v57, v45, -v44
    v_fma_f32 v47, v57, v46, -v45
    v_fma_f32 v48, v57, v47, -v46
    v_fma_f32 v49, v57, v48, -v47
    v_fma_f32 v50, v57, v49, -v48
    v_fma_f32 v51, v57, v50, -v49
    v_cvt_pk_bf16_f32 v52, v44, v45
    v_cvt_pk_bf16_f32 v53, v46, v47
    v_cvt_pk_bf16_f32 v54, v48, v49
    v_cvt_pk_bf16_f32 v55, v50, v51
    v_accvgpr_write_b32 a248, v52
    v_accvgpr_write_b32 a249, v53
    v_accvgpr_write_b32 a250, v54
    v_accvgpr_write_b32 a251, v55
    v_mov_b32 v44, 0x42000000
    v_fma_f32 v57, v44, v56, v58
    v_add_f32 v57, 0xbe800000, v57
    v_cos_f32 v44, v57
    v_add_f32 v57, v57, v56
    v_cos_f32 v51, v56
    v_cos_f32 v45, v57
    v_add_f32 v57, v51, v51
    v_fma_f32 v46, v57, v45, -v44
    v_fma_f32 v47, v57, v46, -v45
    v_fma_f32 v48, v57, v47, -v46
    v_fma_f32 v49, v57, v48, -v47
    v_fma_f32 v50, v57, v49, -v48
    v_fma_f32 v51, v57, v50, -v49
    v_cvt_pk_bf16_f32 v52, v44, v45
    v_cvt_pk_bf16_f32 v53, v46, v47
    v_cvt_pk_bf16_f32 v54, v48, v49
    v_cvt_pk_bf16_f32 v55, v50, v51
    v_accvgpr_write_b32 a252, v52
    v_accvgpr_write_b32 a253, v53
    v_accvgpr_write_b32 a254, v54
    v_accvgpr_write_b32 a255, v55
    s_lshr_b32 s50, s46, 1
    s_lshl_b32 s50, s50, 4
    v_add_u32 v56, s50, v2
    v_cvt_f32_u32 v56, v56
    v_mul_f32 v56, 0x3d000000, v56
    s_and_b32 s50, s46, 1
    s_lshl_b32 s50, s50, 4
    v_lshl_add_u32 v58, v3, 2, s50
    v_cvt_f32_u32 v58, v58
    v_mul_f32 v57, v58, v56
    v_add_f32 v58, 0xbe800000, v57
    v_cos_f32 v44, v57
    v_add_f32 v57, v57, v56
    v_cos_f32 v45, v57
    v_add_f32 v57, v57, v56
    v_cos_f32 v46, v57
    v_add_f32 v57, v57, v56
    v_cos_f32 v47, v57
    v_cvt_pk_bf16_f32 v52, v44, v45
    v_cvt_pk_bf16_f32 v53, v46, v47
    v_cos_f32 v44, v58
    v_add_f32 v58, v58, v56
    v_cos_f32 v45, v58
    v_add_f32 v58, v58, v56
    v_cos_f32 v46, v58
    v_add_f32 v58, v58, v56
    v_cos_f32 v47, v58
    v_cvt_pk_bf16_f32 v54, v44, v45
    v_cvt_pk_bf16_f32 v55, v46, v47
    v_add_u32 v57, 131072, v4
    ds_write_b128 v57, v[52:55]
    s_nop 1
    s_setpc_b64 s[60:61]
L_end:
    s_endpgm
.section .rodata,"a"
.p2align 6
.amdhsa_kernel interleave_layers__spectral_gfnet__sliding_block__prompt_kernel
  .amdhsa_next_free_vgpr 512
  .amdhsa_next_free_sgpr 102
  .amdhsa_accum_offset 256
  .amdhsa_group_segment_fixed_size 0
  .amdhsa_kernarg_size 72
  .amdhsa_user_sgpr_count 2
  .amdhsa_user_sgpr_kernarg_segment_ptr 1
  .amdhsa_system_sgpr_workgroup_id_x 1
.end_amdhsa_kernel
```
